```python
import torch

def _softmax(x, axis=-1):
    return torch.softmax(x, dim=axis)
def _gelu(x):
    return torch.nn.functional.gelu(x, approximate="tanh")
def _silu(x):
    return torch.nn.functional.silu(x)
def _sigmoid(x):
    return torch.sigmoid(x)
def _layernorm(x, axis=-1, eps=1e-5):
    m = x.mean(dim=axis, keepdim=True)
    v = x.var(dim=axis, keepdim=True, unbiased=False)
    return (x - m) / torch.sqrt(v + eps)
def _scatter_add(tgt, idx, src, axis=0):
    return tgt.clone().index_add_(axis, idx, src)
def _segment_sum(src, seg, n):
    out = torch.zeros((n,) + src.shape[1:], dtype=src.dtype)
    return out.index_add_(0, seg, src)
def _pad(x, pw):
    flat = tuple(v for pair in reversed(pw) for v in pair)
    return torch.nn.functional.pad(x, flat)

kernel_name = 'sequential_preLN__softmax_full_mha__glu_gated_bilinear__prompt'

def setup_inputs():

    _w = (lambda a: (lambda t: t.to(torch.bfloat16) if t.is_floating_point() else t)(torch.as_tensor(a)))
    def _A_setup():
        B, S, D = 1, 2048, 1024
        return {
            "x": _w((lambda *s: torch.randn(*s, dtype=torch.bfloat16) * 0.05)(B, S, D)),
            "wqkv": _w((lambda *s: torch.randn(*s, dtype=torch.bfloat16) * 0.05)(D, 3 * D)),
            "wo": _w((lambda *s: torch.randn(*s, dtype=torch.bfloat16) * 0.05)(D, D)),
        }
    _A_in = _A_setup()

    def _B_setup():
        B, S, D, F = 1, 2048, 1024, 3584
        return {
            "x": _w((lambda *s: torch.randn(*s, dtype=torch.bfloat16) * 0.05)(B, S, D)),
            "w_gate": _w((lambda *s: torch.randn(*s, dtype=torch.bfloat16) * 0.8)(D, F) * (D ** -0.5)),
            "w_up": _w((lambda *s: torch.randn(*s, dtype=torch.bfloat16) * 0.8)(D, F) * (D ** -0.5)),
            "w_down": _w((lambda *s: torch.randn(*s, dtype=torch.bfloat16) * 0.8)(F, D) * (F ** -0.5)),
        }
    _B_in = _B_setup()

    return {
        "A_x": _A_in["x"],
        "A_wqkv": _A_in["wqkv"],
        "A_wo": _A_in["wo"],
        "B_x": _B_in["x"],
        "B_w_gate": _B_in["w_gate"],
        "B_w_up": _B_in["w_up"],
        "B_w_down": _B_in["w_down"],
    }

def reference(A_x, A_wqkv, A_wo, B_x, B_w_gate, B_w_up, B_w_down):
    def _A_ref(x, wqkv, wo):
        B, S, D = x.shape
        H = 32; Dh = D // H
        qkv = (lambda x, *d: x.permute(*d))((x @ wqkv).reshape(B, S, 3, H, Dh), 2, 0, 3, 1, 4)
        q, k, v = qkv[0], qkv[1], qkv[2]
        scale = Dh ** -0.5
        scores = torch.einsum("bhqd,bhkd->bhqk", q, k) * scale
        p = _softmax(scores, axis=-1)
        o = torch.einsum("bhqk,bhkd->bhqd", p, v)
        return (lambda x, *d: x.permute(*d))(o, 0, 2, 1, 3).reshape(B, S, D) @ wo

    def _B_ref(x, w_gate, w_up, w_down):
        g = torch.einsum("bsd,df->bsf", x, w_gate)
        u = torch.einsum("bsd,df->bsf", x, w_up)
        h = g * u
        return torch.einsum("bsf,fd->bsd", h, w_down)

    x = A_x
    h = x + _A_ref(_layernorm(x, axis=-1), A_wqkv, A_wo)
    h2 = h + _B_ref(_layernorm(h, axis=-1), B_w_gate, B_w_up, B_w_down)
    return h2
```

```asm
; @launch grid=(256,1,1) block=(256,1,1) lds=163840
.amdgcn_target "amdgcn-amd-amdhsa--gfx950"
.text
.globl sequential_preLN__softmax_full_mha__glu_gated_bilinear__prompt_kernel
.p2align 8
.type sequential_preLN__softmax_full_mha__glu_gated_bilinear__prompt_kernel,@function
sequential_preLN__softmax_full_mha__glu_gated_bilinear__prompt_kernel:
    s_cmp_ge_u32 s2, 256
    s_cbranch_scc1 all_done
    s_load_dwordx16 s[48:63], s[0:1], 0
    s_load_dwordx4 s[36:39], s[0:1], 64
    v_lshrrev_b32 v224, 6, v0
    v_and_b32 v240, 63, v0
    s_and_b32 s23, s2, 7
    v_readfirstlane_b32 s21, v224
    s_lshl_b32 s23, s23, 1
    s_lshr_b32 s3, s2, 7
    s_add_u32 s23, s23, s3
    s_bfe_u32 s22, s2, 0x40003
    s_lshr_b32 s33, s21, 1
    s_and_b32 s34, s21, 1
    v_lshlrev_b32 v241, 4, v240
    s_lshl_b32 s3, s22, 7
    s_lshl_b32 s4, s23, 3
    s_add_u32 s3, s3, s4
    s_lshl_b32 s4, s21, 1
    s_add_u32 s3, s3, s4
    v_lshrrev_b32 v224, 5, v240
    v_add_u32 v225, s3, v224
    v_and_b32 v224, 31, v240
    v_lshlrev_b32 v226, 11, v225
    v_lshl_add_u32 v226, v224, 4, v226
    v_lshrrev_b32 v227, 3, v240
    s_lshl_b32 s3, s21, 5
    v_add_u32 v228, s3, v227
    v_lshlrev_b32 v228, 11, v228
    v_lshrrev_b32 v229, 4, v240
    v_and_b32 v230, 7, v240
    v_xor_b32 v230, v230, v229
    v_lshl_add_u32 v124, v230, 4, v228
    v_xor_b32 v230, 64, v124
    v_add_u32 v125, 15360, v230
    v_add_u32 v126, 30720, v124
    v_add_u32 v127, 46080, v230
    v_and_b32 v228, 3, v227
    v_lshrrev_b32 v230, 5, v240
    v_lshl_add_u32 v228, v230, 3, v228
    s_lshl_b32 s3, s21, 4
    v_add_u32 v228, s3, v228
    v_mul_u32_u24 v228, 6144, v228
    v_bfe_u32 v230, v240, 1, 2
    v_xor_b32 v230, v230, v229
    v_lshl_add_u32 v228, v230, 5, v228
    v_and_b32 v230, 1, v240
    v_lshl_add_u32 v128, v230, 4, v228
    v_add_u32 v129, 23552, v128
    s_lshl_b32 s24, s22, 18
    s_lshl_b32 s25, s23, 7
    s_add_u32 s26, s25, 2048
    s_add_u32 s27, s25, 4096
    s_lshl_b32 s31, s21, 12
    s_lshl_b32 s32, s21, 11
    s_add_u32 s32, s32, 16384
    s_waitcnt lgkmcnt(0)
    s_mov_b32 s16, s48
    s_mov_b32 s17, s49
    s_mov_b32 s18, 0x400000
    s_mov_b32 s19, 0x00020000
    s_mov_b32 s12, s50
    s_mov_b32 s13, s51
    s_mov_b32 s14, 0x600000
    s_mov_b32 s15, 0x00020000
    s_mov_b32 s8, s38
    s_mov_b32 s9, s39
    s_mov_b32 s10, 0x2700000
    s_mov_b32 s11, 0x00020000
    s_mov_b32 s40, s36
    s_mov_b32 s41, s37
    s_mov_b32 s42, 0x100
    s_mov_b32 s43, 0x00020000
    v_mov_b32 v232, 0x7ffffff0
    v_mov_b32 v233, 0
    v_cmp_eq_u32 vcc, 0, v0
    s_cmp_lg_u32 s2, 0
    s_nop 0
    v_cndmask_b32 v246, v232, v233, vcc
    v_cmp_eq_u32 vcc, 0, v240
    s_nop 1
    v_cndmask_b32 v248, v232, v233, vcc
    s_cbranch_scc1 tag_done
    s_memrealtime s[4:5]
    s_waitcnt lgkmcnt(0)
    s_or_b32 s4, s4, 1
    v_mov_b32 v247, s4
    buffer_store_dword v247, v246, s[40:43], 0 offen sc1
tag_done:
    s_and_b32 s4, s2, 3
    s_cmp_eq_u32 s4, 9
    s_cselect_b32 s4, 24, 12
    s_lshr_b32 s3, s2, 3
    s_lshl_b32 s3, s3, 2
    s_add_u32 s3, s3, s21
    s_mul_i32 s3, s3, s4
    v_add_u32 v227, s3, v240
    v_mul_u32_u24 v228, 10923, v227
    v_lshrrev_b32 v228, 16, v228
    v_mul_u32_u24 v230, 6, v228
    v_sub_u32 v230, v227, v230
    v_mul_u32_u24 v251, 6144, v228
    v_lshrrev_b32 v231, 1, v230
    v_lshl_add_u32 v251, v231, 11, v251
    v_and_b32 v231, 1, v230
    v_lshl_add_u32 v251, v231, 7, v251
    s_and_b32 s5, s2, 7
    s_lshl_b32 s5, s5, 8
    v_add_u32 v251, s5, v251
    s_cmp_lt_u32 s3, 1536
    s_cselect_b32 s4, s4, 0
    v_cmp_gt_u32 vcc, s4, v240
    v_mov_b32 v227, 0x70000000
    s_nop 0
    v_cndmask_b32 v251, v227, v251, vcc
    s_add_u32 m0, s31, 0
    s_nop 0
    buffer_load_dwordx4 v124, s[16:19], s24 offen offset:0 lds
    buffer_load_dwordx4 v125, s[16:19], s24 offen offset:1024 lds
    buffer_load_dwordx4 v126, s[16:19], s24 offen offset:2048 lds
    buffer_load_dwordx4 v127, s[16:19], s24 offen offset:3072 lds
    s_add_u32 m0, s32, 0
    s_nop 0
    buffer_load_dwordx4 v128, s[12:15], s25 offen offset:0 lds
    buffer_load_dwordx4 v129, s[12:15], s25 offen offset:1024 lds
    s_add_u32 m0, s32, 8192
    s_nop 0
    buffer_load_dwordx4 v128, s[12:15], s26 offen offset:0 lds
    buffer_load_dwordx4 v129, s[12:15], s26 offen offset:1024 lds
    s_add_u32 m0, s32, 16384
    s_nop 0
    buffer_load_dwordx4 v128, s[12:15], s27 offen offset:0 lds
    buffer_load_dwordx4 v129, s[12:15], s27 offen offset:1024 lds
    s_add_u32 s24, s24, 128
    s_add_u32 s25, s25, 393216
    s_add_u32 s26, s26, 393216
    s_add_u32 s27, s27, 393216
    s_add_u32 m0, s31, 40960
    s_nop 0
    buffer_load_dwordx4 v124, s[16:19], s24 offen offset:0 lds
    buffer_load_dwordx4 v125, s[16:19], s24 offen offset:1024 lds
    buffer_load_dwordx4 v126, s[16:19], s24 offen offset:2048 lds
    buffer_load_dwordx4 v127, s[16:19], s24 offen offset:3072 lds
    s_add_u32 m0, s32, 40960
    s_nop 0
    buffer_load_dwordx4 v128, s[12:15], s25 offen offset:0 lds
    buffer_load_dwordx4 v129, s[12:15], s25 offen offset:1024 lds
    s_add_u32 m0, s32, 49152
    s_nop 0
    buffer_load_dwordx4 v128, s[12:15], s26 offen offset:0 lds
    buffer_load_dwordx4 v129, s[12:15], s26 offen offset:1024 lds
    s_add_u32 m0, s32, 57344
    s_nop 0
    buffer_load_dwordx4 v128, s[12:15], s27 offen offset:0 lds
    buffer_load_dwordx4 v129, s[12:15], s27 offen offset:1024 lds
    s_add_u32 s24, s24, 128
    s_add_u32 s25, s25, 393216
    s_add_u32 s26, s26, 393216
    s_add_u32 s27, s27, 393216
    s_cmp_lg_u32 s21, 3
    s_cbranch_scc1 code_done
    s_getpc_b64 s[4:5]
code_here:
    s_lshr_b32 s3, s2, 3
    s_lshl_b32 s3, s3, 4
    v_and_b32 v252, 15, v240
    v_add_u32 v252, s3, v252
    v_lshlrev_b32 v252, 7, v252
    v_min_u32 v252, code_end-code_here-4, v252
    global_load_dword v244, v252, s[4:5]
code_done:
    buffer_load_dwordx4 v[164:167], v226, s[16:19], 0 offen offset:0
    buffer_load_dwordx4 v[168:171], v226, s[16:19], 0 offen offset:512
    buffer_load_dwordx4 v[172:175], v226, s[16:19], 0 offen offset:1024
    buffer_load_dwordx4 v[176:179], v226, s[16:19], 0 offen offset:1536
    buffer_load_dword v247, v233, s[40:43], 0 offen sc1
    s_add_u32 m0, s31, 81920
    s_nop 0
    buffer_load_dwordx4 v124, s[16:19], s24 offen offset:0 lds
    buffer_load_dwordx4 v125, s[16:19], s24 offen offset:1024 lds
    buffer_load_dwordx4 v126, s[16:19], s24 offen offset:2048 lds
    buffer_load_dwordx4 v127, s[16:19], s24 offen offset:3072 lds
    s_add_u32 m0, s32, 81920
    s_nop 0
    buffer_load_dwordx4 v128, s[12:15], s25 offen offset:0 lds
    buffer_load_dwordx4 v129, s[12:15], s25 offen offset:1024 lds
    v_add_u32 v251, 1572864, v251
    buffer_load_dword v244, v251, s[12:15], 0 offen
    v_add_u32 v251, 1572864, v251
    buffer_load_dword v244, v251, s[12:15], 0 offen
    v_add_u32 v251, 1572864, v251
    buffer_load_dword v244, v251, s[12:15], 0 offen
    v_and_b32 v227, 15, v240
    s_lshl_b32 s3, s33, 6
    v_add_u32 v228, s3, v227
    v_lshlrev_b32 v228, 7, v228
    v_lshrrev_b32 v230, 1, v227
    v_xor_b32 v230, v230, v229
    v_lshl_add_u32 v130, v230, 4, v228
    v_xor_b32 v131, 64, v130
    v_bfe_u32 v228, v240, 2, 3
    v_lshrrev_b32 v230, 1, v228
    v_lshrrev_b32 v231, 5, v240
    v_lshl_add_u32 v228, v231, 4, v228
    v_lshlrev_b32 v228, 7, v228
    v_and_b32 v231, 3, v240
    v_lshl_add_u32 v228, v231, 3, v228
    v_add_u32 v228, 16384, v228
    s_lshl_b32 s3, s34, 1
    s_add_u32 s3, s3, s33
    v_xor_b32 v230, s3, v230
    v_lshl_add_u32 v138, v230, 5, v228
    v_xor_b32 v139, 32, v138
    v_add_u32 v132, 40960, v130
    v_add_u32 v140, 40960, v138
    v_add_u32 v133, 40960, v131
    v_add_u32 v141, 40960, v139
    v_add_u32 v134, 81920, v130
    v_add_u32 v142, 81920, v138
    v_add_u32 v135, 81920, v131
    v_add_u32 v143, 81920, v139
    s_lshl_b32 s3, s22, 13
    s_lshl_b32 s4, s33, 12
    s_add_u32 s3, s3, s4
    s_add_u32 s6, s3, 40108032
    v_lshrrev_b32 v228, 1, v240
    v_lshlrev_b32 v228, 7, v228
    v_and_b32 v230, 1, v240
    v_lshl_add_u32 v146, v230, 4, v228
    s_lshl_b32 s3, s21, 12
    s_add_u32 s3, s3, 122880
    v_lshl_add_u32 v147, v240, 2, s3
    v_lshl_add_u32 v148, v227, 2, s3
    v_lshl_add_u32 v149, v229, 4, s3
    v_mov_b32 v120, 0x3f803f80
    v_mov_b32 v121, 0x3f803f80
    v_mov_b32 v122, 0x3f803f80
    v_mov_b32 v123, 0x3f803f80
    s_lshl_b32 s35, s23, 1
    s_add_u32 s35, s35, s34
    v_and_b32 v212, 3, v240
    v_bfe_u32 v213, v240, 2, 1
    v_bfe_u32 v214, v240, 4, 1
    v_xor_b32 v213, v213, v214
    v_or_b32 v212, v212, v213
    v_mov_b32 v213, 0x3f803f80
    v_cmp_eq_u32 vcc, 0, v212
    s_nop 1
    v_cndmask_b32 v212, 0, v213, vcc
    v_accvgpr_write_b32 a112, v212
    v_accvgpr_write_b32 a113, v212
    v_accvgpr_write_b32 a114, v212
    v_accvgpr_write_b32 a115, v212
    s_cmp_eq_u32 s21, 1
    s_cselect_b32 s44, s58, s56
    s_cselect_b32 s45, s59, s57
    s_cmp_eq_u32 s21, 2
    s_cselect_b32 s44, s60, s44
    s_cselect_b32 s45, s61, s45
    s_mov_b32 s46, 7340032
    s_cmp_eq_u32 s21, 3
    s_cselect_b32 s44, s52, s44
    s_cselect_b32 s45, s53, s45
    s_cselect_b32 s46, 0x200000, s46
    s_mov_b32 s47, 0x00020000
    s_lshl_b32 s3, s2, 4
    v_and_b32 v243, 15, v240
    v_add_u32 v243, s3, v243
    v_lshlrev_b32 v243, 7, v243
    v_cmp_gt_u32 vcc, 16, v240
    v_mov_b32 v212, 0x7f7ffff0
    s_nop 0
    v_cndmask_b32 v243, v212, v243, vcc
    s_lshl_b32 s3, s23, 4
    s_add_u32 s4, s3, s22
    s_lshl_b32 s4, s4, 7
    s_add_u32 s7, s4, 40370176
    s_lshl_b32 s3, s3, 7
    s_add_u32 s100, s3, 40370176
    v_and_b32 v245, 15, v240
    v_lshlrev_b32 v245, 7, v245
    s_lshl_b32 s3, s21, 4
    v_lshrrev_b32 v212, 3, v240
    v_add_u32 v212, s3, v212
    v_bfe_u32 v213, v212, 1, 2
    v_bfe_u32 v214, v240, 1, 2
    v_xor_b32 v213, v213, v214
    v_lshlrev_b32 v213, 5, v213
    v_and_b32 v214, 1, v240
    v_lshl_add_u32 v213, v214, 4, v213
    v_lshl_add_u32 v249, v212, 11, v213
    v_add_u32 v250, 15360, v249
    s_bfe_u32 s30, s2, 0x40003
    s_lshl_b32 s30, s30, 7
    s_waitcnt vmcnt(24)
    s_barrier
    ds_read_b64_tr_b16 a[0:1], v138 offset:0
    ds_read_b64_tr_b16 a[2:3], v138 offset:1024
    ds_read_b128 a[48:51], v130 offset:0
    ds_read_b128 a[52:55], v130 offset:2048
    ds_read_b128 a[56:59], v130 offset:4096
    ds_read_b128 a[60:63], v130 offset:6144
    ds_read_b64_tr_b16 a[4:5], v139 offset:0
    ds_read_b64_tr_b16 a[6:7], v139 offset:1024
    ds_read_b64_tr_b16 a[8:9], v138 offset:8192
    ds_read_b64_tr_b16 a[10:11], v138 offset:9216
    ds_read_b64_tr_b16 a[12:13], v139 offset:8192
    ds_read_b64_tr_b16 a[14:15], v139 offset:9216
    ds_read_b64_tr_b16 a[16:17], v138 offset:16384
    ds_read_b64_tr_b16 a[18:19], v138 offset:17408
    ds_read_b64_tr_b16 a[20:21], v139 offset:16384
    ds_read_b64_tr_b16 a[22:23], v139 offset:17408
    s_waitcnt lgkmcnt(0)
    v_mfma_f32_16x16x32_bf16 v[0:3], a[0:3], a[48:51], 0
    ds_read_b64_tr_b16 a[24:25], v138 offset:4096
    s_add_u32 m0, s32, 90112
    v_mfma_f32_16x16x32_bf16 v[4:7], a[0:3], a[52:55], 0
    ds_read_b64_tr_b16 a[26:27], v138 offset:5120
    v_mfma_f32_16x16x32_bf16 v[8:11], a[0:3], a[56:59], 0
    buffer_load_dwordx4 v128, s[12:15], s26 offen offset:0 lds
    v_mfma_f32_16x16x32_bf16 v[12:15], a[0:3], a[60:63], 0
    ds_read_b128 a[64:67], v131 offset:0
    v_mfma_f32_16x16x32_bf16 v[96:99], a[0:3], v[120:123], 0
    ds_read_b128 a[68:71], v131 offset:2048
    v_mfma_f32_16x16x32_bf16 v[28:31], a[4:7], a[60:63], 0
    buffer_load_dwordx4 v129, s[12:15], s26 offen offset:1024 lds
    ds_read_b128 a[72:75], v131 offset:4096
    v_mfma_f32_16x16x32_bf16 v[24:27], a[4:7], a[56:59], 0
    s_add_u32 m0, s32, 98304
    v_mfma_f32_16x16x32_bf16 v[20:23], a[4:7], a[52:55], 0
    ds_read_b128 a[76:79], v131 offset:6144
    v_mfma_f32_16x16x32_bf16 v[16:19], a[4:7], a[48:51], 0
    ds_read_b64_tr_b16 a[28:29], v139 offset:4096
    v_mfma_f32_16x16x32_bf16 v[32:35], a[8:11], a[48:51], 0
    buffer_load_dwordx4 v128, s[12:15], s27 offen offset:0 lds
    v_mfma_f32_16x16x32_bf16 v[36:39], a[8:11], a[52:55], 0
    ds_read_b64_tr_b16 a[30:31], v139 offset:5120
    v_mfma_f32_16x16x32_bf16 v[40:43], a[8:11], a[56:59], 0
    ds_read_b64_tr_b16 a[32:33], v138 offset:12288
    buffer_load_dwordx4 v129, s[12:15], s27 offen offset:1024 lds
    v_mfma_f32_16x16x32_bf16 v[44:47], a[8:11], a[60:63], 0
    ds_read_b64_tr_b16 a[34:35], v138 offset:13312
    v_mfma_f32_16x16x32_bf16 v[100:103], a[8:11], v[120:123], 0
    s_add_u32 s24, s24, 128
    v_mfma_f32_16x16x32_bf16 v[60:63], a[12:15], a[60:63], 0
    ds_read_b64_tr_b16 a[36:37], v139 offset:12288
    v_mfma_f32_16x16x32_bf16 v[56:59], a[12:15], a[56:59], 0
    ds_read_b64_tr_b16 a[38:39], v139 offset:13312
    v_mfma_f32_16x16x32_bf16 v[52:55], a[12:15], a[52:55], 0
    s_add_u32 s25, s25, 393216
    ds_read_b64_tr_b16 a[40:41], v138 offset:20480
    v_mfma_f32_16x16x32_bf16 v[48:51], a[12:15], a[48:51], 0
    s_add_u32 s26, s26, 393216
    v_mfma_f32_16x16x32_bf16 v[64:67], a[48:51], a[16:19], 0
    ds_read_b64_tr_b16 a[42:43], v138 offset:21504
    v_mfma_f32_16x16x32_bf16 v[68:71], a[52:55], a[16:19], 0
    ds_read_b64_tr_b16 a[44:45], v139 offset:20480
    v_mfma_f32_16x16x32_bf16 v[72:75], a[56:59], a[16:19], 0
    s_add_u32 s27, s27, 393216
    v_mfma_f32_16x16x32_bf16 v[76:79], a[60:63], a[16:19], 0
    ds_read_b64_tr_b16 a[46:47], v139 offset:21504
    v_mfma_f32_16x16x32_bf16 v[104:107], v[120:123], a[16:19], 0
    v_mfma_f32_16x16x32_bf16 v[92:95], a[60:63], a[20:23], 0
    v_mfma_f32_16x16x32_bf16 v[88:91], a[56:59], a[20:23], 0
    v_mfma_f32_16x16x32_bf16 v[84:87], a[52:55], a[20:23], 0
    v_mfma_f32_16x16x32_bf16 v[80:83], a[48:51], a[20:23], 0
    s_waitcnt vmcnt(18) lgkmcnt(0)
    s_barrier
    v_mfma_f32_16x16x32_bf16 v[0:3], a[24:27], a[64:67], v[0:3]
    ds_read_b64_tr_b16 a[0:1], v140 offset:0
    s_add_u32 m0, s31, 0
    v_mfma_f32_16x16x32_bf16 v[4:7], a[24:27], a[68:71], v[4:7]
    ds_read_b64_tr_b16 a[2:3], v140 offset:1024
    v_mfma_f32_16x16x32_bf16 v[8:11], a[24:27], a[72:75], v[8:11]
    ds_read_b128 a[48:51], v132 offset:0
    v_mfma_f32_16x16x32_bf16 v[12:15], a[24:27], a[76:79], v[12:15]
    buffer_load_dwordx4 v124, s[16:19], s24 offen offset:0 lds
    v_mfma_f32_16x16x32_bf16 v[96:99], a[24:27], v[120:123], v[96:99]
    ds_read_b128 a[52:55], v132 offset:2048
    v_mfma_f32_16x16x32_bf16 v[28:31], a[28:31], a[76:79], v[28:31]
    ds_read_b128 a[56:59], v132 offset:4096
    v_mfma_f32_16x16x32_bf16 v[24:27], a[28:31], a[72:75], v[24:27]
    buffer_load_dwordx4 v125, s[16:19], s24 offen offset:1024 lds
    v_mfma_f32_16x16x32_bf16 v[20:23], a[28:31], a[68:71], v[20:23]
    ds_read_b128 a[60:63], v132 offset:6144
    v_mfma_f32_16x16x32_bf16 v[16:19], a[28:31], a[64:67], v[16:19]
    ds_read_b64_tr_b16 a[4:5], v141 offset:0
    v_mfma_f32_16x16x32_bf16 v[32:35], a[32:35], a[64:67], v[32:35]
    buffer_load_dwordx4 v126, s[16:19], s24 offen offset:2048 lds
    v_mfma_f32_16x16x32_bf16 v[36:39], a[32:35], a[68:71], v[36:39]
    ds_read_b64_tr_b16 a[6:7], v141 offset:1024
    v_mfma_f32_16x16x32_bf16 v[40:43], a[32:35], a[72:75], v[40:43]
    ds_read_b64_tr_b16 a[8:9], v140 offset:8192
    buffer_load_dwordx4 v127, s[16:19], s24 offen offset:3072 lds
    v_mfma_f32_16x16x32_bf16 v[44:47], a[32:35], a[76:79], v[44:47]
    ds_read_b64_tr_b16 a[10:11], v140 offset:9216
    v_mfma_f32_16x16x32_bf16 v[100:103], a[32:35], v[120:123], v[100:103]
    ds_read_b64_tr_b16 a[12:13], v141 offset:8192
    v_mfma_f32_16x16x32_bf16 v[60:63], a[36:39], a[76:79], v[60:63]
    s_add_u32 m0, s32, 0
    v_mfma_f32_16x16x32_bf16 v[56:59], a[36:39], a[72:75], v[56:59]
    ds_read_b64_tr_b16 a[14:15], v141 offset:9216
    v_mfma_f32_16x16x32_bf16 v[52:55], a[36:39], a[68:71], v[52:55]
    ds_read_b64_tr_b16 a[16:17], v140 offset:16384
    v_mfma_f32_16x16x32_bf16 v[48:51], a[36:39], a[64:67], v[48:51]
    buffer_load_dwordx4 v128, s[12:15], s25 offen offset:0 lds
    v_mfma_f32_16x16x32_bf16 v[64:67], a[64:67], a[40:43], v[64:67]
    ds_read_b64_tr_b16 a[18:19], v140 offset:17408
    v_mfma_f32_16x16x32_bf16 v[68:71], a[68:71], a[40:43], v[68:71]
    ds_read_b64_tr_b16 a[20:21], v141 offset:16384
    v_mfma_f32_16x16x32_bf16 v[72:75], a[72:75], a[40:43], v[72:75]
    buffer_load_dwordx4 v129, s[12:15], s25 offen offset:1024 lds
    v_mfma_f32_16x16x32_bf16 v[76:79], a[76:79], a[40:43], v[76:79]
    ds_read_b64_tr_b16 a[22:23], v141 offset:17408
    v_mfma_f32_16x16x32_bf16 v[104:107], v[120:123], a[40:43], v[104:107]
    v_mfma_f32_16x16x32_bf16 v[92:95], a[76:79], a[44:47], v[92:95]
    v_mfma_f32_16x16x32_bf16 v[88:91], a[72:75], a[44:47], v[88:91]
    v_mfma_f32_16x16x32_bf16 v[84:87], a[68:71], a[44:47], v[84:87]
    v_mfma_f32_16x16x32_bf16 v[80:83], a[64:67], a[44:47], v[80:83]
    s_waitcnt lgkmcnt(0)
    v_mfma_f32_16x16x32_bf16 v[0:3], a[0:3], a[48:51], v[0:3]
    ds_read_b64_tr_b16 a[24:25], v140 offset:4096
    s_add_u32 m0, s32, 8192
    v_mfma_f32_16x16x32_bf16 v[4:7], a[0:3], a[52:55], v[4:7]
    ds_read_b64_tr_b16 a[26:27], v140 offset:5120
    v_mfma_f32_16x16x32_bf16 v[8:11], a[0:3], a[56:59], v[8:11]
    buffer_load_dwordx4 v128, s[12:15], s26 offen offset:0 lds
    v_mfma_f32_16x16x32_bf16 v[12:15], a[0:3], a[60:63], v[12:15]
    ds_read_b128 a[64:67], v133 offset:0
    v_mfma_f32_16x16x32_bf16 v[96:99], a[0:3], v[120:123], v[96:99]
    ds_read_b128 a[68:71], v133 offset:2048
    v_mfma_f32_16x16x32_bf16 v[28:31], a[4:7], a[60:63], v[28:31]
    buffer_load_dwordx4 v129, s[12:15], s26 offen offset:1024 lds
    ds_read_b128 a[72:75], v133 offset:4096
    v_mfma_f32_16x16x32_bf16 v[24:27], a[4:7], a[56:59], v[24:27]
    s_add_u32 m0, s32, 16384
    v_mfma_f32_16x16x32_bf16 v[20:23], a[4:7], a[52:55], v[20:23]
    ds_read_b128 a[76:79], v133 offset:6144
    v_mfma_f32_16x16x32_bf16 v[16:19], a[4:7], a[48:51], v[16:19]
    ds_read_b64_tr_b16 a[28:29], v141 offset:4096
    v_mfma_f32_16x16x32_bf16 v[32:35], a[8:11], a[48:51], v[32:35]
    buffer_load_dwordx4 v128, s[12:15], s27 offen offset:0 lds
    v_mfma_f32_16x16x32_bf16 v[36:39], a[8:11], a[52:55], v[36:39]
    ds_read_b64_tr_b16 a[30:31], v141 offset:5120
    v_mfma_f32_16x16x32_bf16 v[40:43], a[8:11], a[56:59], v[40:43]
    ds_read_b64_tr_b16 a[32:33], v140 offset:12288
    buffer_load_dwordx4 v129, s[12:15], s27 offen offset:1024 lds
    v_mfma_f32_16x16x32_bf16 v[44:47], a[8:11], a[60:63], v[44:47]
    ds_read_b64_tr_b16 a[34:35], v140 offset:13312
    v_mfma_f32_16x16x32_bf16 v[100:103], a[8:11], v[120:123], v[100:103]
    s_add_u32 s24, s24, 128
    v_mfma_f32_16x16x32_bf16 v[60:63], a[12:15], a[60:63], v[60:63]
    ds_read_b64_tr_b16 a[36:37], v141 offset:12288
    v_mfma_f32_16x16x32_bf16 v[56:59], a[12:15], a[56:59], v[56:59]
    ds_read_b64_tr_b16 a[38:39], v141 offset:13312
    v_mfma_f32_16x16x32_bf16 v[52:55], a[12:15], a[52:55], v[52:55]
    s_add_u32 s25, s25, 393216
    ds_read_b64_tr_b16 a[40:41], v140 offset:20480
    v_mfma_f32_16x16x32_bf16 v[48:51], a[12:15], a[48:51], v[48:51]
    s_add_u32 s26, s26, 393216
    v_mfma_f32_16x16x32_bf16 v[64:67], a[48:51], a[16:19], v[64:67]
    ds_read_b64_tr_b16 a[42:43], v140 offset:21504
    v_mfma_f32_16x16x32_bf16 v[68:71], a[52:55], a[16:19], v[68:71]
    ds_read_b64_tr_b16 a[44:45], v141 offset:20480
    v_mfma_f32_16x16x32_bf16 v[72:75], a[56:59], a[16:19], v[72:75]
    s_add_u32 s27, s27, 393216
    v_mfma_f32_16x16x32_bf16 v[76:79], a[60:63], a[16:19], v[76:79]
    ds_read_b64_tr_b16 a[46:47], v141 offset:21504
    v_mfma_f32_16x16x32_bf16 v[104:107], v[120:123], a[16:19], v[104:107]
    v_mfma_f32_16x16x32_bf16 v[92:95], a[60:63], a[20:23], v[92:95]
    v_mfma_f32_16x16x32_bf16 v[88:91], a[56:59], a[20:23], v[88:91]
    v_mfma_f32_16x16x32_bf16 v[84:87], a[52:55], a[20:23], v[84:87]
    v_mfma_f32_16x16x32_bf16 v[80:83], a[48:51], a[20:23], v[80:83]
    s_waitcnt vmcnt(23)
    v_readfirstlane_b32 s29, v247
    s_cmp_lg_u32 s29, 0
    s_cbranch_scc1 tagwait_ok
    s_mov_b32 s4, 0
tagwait:
    buffer_load_dword v247, v233, s[40:43], 0 offen sc1
    s_add_u32 s4, s4, 1
    s_waitcnt vmcnt(0)
    v_readfirstlane_b32 s29, v247
    s_cmp_lg_u32 s29, 0
    s_cbranch_scc1 tagwait_ok
    s_cmp_lt_u32 s4, 2097152
    s_cbranch_scc1 tagwait
tagwait_ok:
    v_lshlrev_b32 v180, 16, v164
    v_and_b32 v181, 0xffff0000, v164
    v_lshlrev_b32 v182, 16, v165
    v_and_b32 v183, 0xffff0000, v165
    v_lshlrev_b32 v184, 16, v166
    v_and_b32 v185, 0xffff0000, v166
    v_lshlrev_b32 v186, 16, v167
    v_and_b32 v187, 0xffff0000, v167
    v_lshlrev_b32 v188, 16, v168
    v_and_b32 v189, 0xffff0000, v168
    v_lshlrev_b32 v190, 16, v169
    v_and_b32 v191, 0xffff0000, v169
    v_lshlrev_b32 v192, 16, v170
    v_and_b32 v193, 0xffff0000, v170
    v_lshlrev_b32 v194, 16, v171
    v_and_b32 v195, 0xffff0000, v171
    v_lshlrev_b32 v196, 16, v172
    v_and_b32 v197, 0xffff0000, v172
    v_lshlrev_b32 v198, 16, v173
    v_and_b32 v199, 0xffff0000, v173
    v_lshlrev_b32 v200, 16, v174
    v_and_b32 v201, 0xffff0000, v174
    v_lshlrev_b32 v202, 16, v175
    v_and_b32 v203, 0xffff0000, v175
    v_lshlrev_b32 v204, 16, v176
    v_and_b32 v205, 0xffff0000, v176
    v_lshlrev_b32 v206, 16, v177
    v_and_b32 v207, 0xffff0000, v177
    v_lshlrev_b32 v208, 16, v178
    v_and_b32 v209, 0xffff0000, v178
    v_lshlrev_b32 v210, 16, v179
    v_and_b32 v211, 0xffff0000, v179
    v_pk_add_f32 v[236:237], v[180:181], v[182:183]
    v_pk_add_f32 v[236:237], v[236:237], v[184:185]
    v_pk_add_f32 v[236:237], v[236:237], v[186:187]
    v_pk_add_f32 v[236:237], v[236:237], v[188:189]
    v_pk_add_f32 v[236:237], v[236:237], v[190:191]
    v_pk_add_f32 v[236:237], v[236:237], v[192:193]
    v_pk_add_f32 v[236:237], v[236:237], v[194:195]
    v_pk_add_f32 v[236:237], v[236:237], v[196:197]
    v_pk_add_f32 v[236:237], v[236:237], v[198:199]
    v_pk_add_f32 v[236:237], v[236:237], v[200:201]
    v_pk_add_f32 v[236:237], v[236:237], v[202:203]
    v_pk_add_f32 v[236:237], v[236:237], v[204:205]
    v_pk_add_f32 v[236:237], v[236:237], v[206:207]
    v_pk_add_f32 v[236:237], v[236:237], v[208:209]
    v_pk_add_f32 v[236:237], v[236:237], v[210:211]
    v_add_f32 v236, v236, v237
    s_nop 1
    v_add_f32_dpp v236, v236, v236 row_ror:8 row_mask:0xf bank_mask:0xf
    s_nop 1
    v_add_f32_dpp v236, v236, v236 row_ror:4 row_mask:0xf bank_mask:0xf
    s_nop 1
    v_add_f32_dpp v236, v236, v236 row_ror:2 row_mask:0xf bank_mask:0xf
    s_nop 1
    v_add_f32_dpp v236, v236, v236 row_ror:1 row_mask:0xf bank_mask:0xf
    v_mov_b32 v237, v236
    s_nop 1
    v_permlane16_swap_b32 v236, v237
    v_add_f32 v236, v236, v237
    v_mul_f32 v236, 0x3a800000, v236
    v_pk_add_f32 v[180:181], v[180:181], v[236:237] op_sel_hi:[1,0] neg_lo:[0,1] neg_hi:[0,1]
    v_pk_add_f32 v[182:183], v[182:183], v[236:237] op_sel_hi:[1,0] neg_lo:[0,1] neg_hi:[0,1]
    v_pk_add_f32 v[184:185], v[184:185], v[236:237] op_sel_hi:[1,0] neg_lo:[0,1] neg_hi:[0,1]
    v_pk_add_f32 v[186:187], v[186:187], v[236:237] op_sel_hi:[1,0] neg_lo:[0,1] neg_hi:[0,1]
    v_pk_add_f32 v[188:189], v[188:189], v[236:237] op_sel_hi:[1,0] neg_lo:[0,1] neg_hi:[0,1]
    v_pk_add_f32 v[190:191], v[190:191], v[236:237] op_sel_hi:[1,0] neg_lo:[0,1] neg_hi:[0,1]
    v_pk_add_f32 v[192:193], v[192:193], v[236:237] op_sel_hi:[1,0] neg_lo:[0,1] neg_hi:[0,1]
    v_pk_add_f32 v[194:195], v[194:195], v[236:237] op_sel_hi:[1,0] neg_lo:[0,1] neg_hi:[0,1]
    v_pk_add_f32 v[196:197], v[196:197], v[236:237] op_sel_hi:[1,0] neg_lo:[0,1] neg_hi:[0,1]
    v_pk_add_f32 v[198:199], v[198:199], v[236:237] op_sel_hi:[1,0] neg_lo:[0,1] neg_hi:[0,1]
    v_pk_add_f32 v[200:201], v[200:201], v[236:237] op_sel_hi:[1,0] neg_lo:[0,1] neg_hi:[0,1]
    v_pk_add_f32 v[202:203], v[202:203], v[236:237] op_sel_hi:[1,0] neg_lo:[0,1] neg_hi:[0,1]
    v_pk_add_f32 v[204:205], v[204:205], v[236:237] op_sel_hi:[1,0] neg_lo:[0,1] neg_hi:[0,1]
    v_pk_add_f32 v[206:207], v[206:207], v[236:237] op_sel_hi:[1,0] neg_lo:[0,1] neg_hi:[0,1]
    v_pk_add_f32 v[208:209], v[208:209], v[236:237] op_sel_hi:[1,0] neg_lo:[0,1] neg_hi:[0,1]
    v_pk_add_f32 v[210:211], v[210:211], v[236:237] op_sel_hi:[1,0] neg_lo:[0,1] neg_hi:[0,1]
    v_pk_mul_f32 v[238:239], v[180:181], v[180:181]
    v_pk_fma_f32 v[238:239], v[182:183], v[182:183], v[238:239]
    v_pk_fma_f32 v[238:239], v[184:185], v[184:185], v[238:239]
    v_pk_fma_f32 v[238:239], v[186:187], v[186:187], v[238:239]
    v_pk_fma_f32 v[238:239], v[188:189], v[188:189], v[238:239]
    v_pk_fma_f32 v[238:239], v[190:191], v[190:191], v[238:239]
    v_pk_fma_f32 v[238:239], v[192:193], v[192:193], v[238:239]
    v_pk_fma_f32 v[238:239], v[194:195], v[194:195], v[238:239]
    v_pk_fma_f32 v[238:239], v[196:197], v[196:197], v[238:239]
    v_pk_fma_f32 v[238:239], v[198:199], v[198:199], v[238:239]
    v_pk_fma_f32 v[238:239], v[200:201], v[200:201], v[238:239]
    v_pk_fma_f32 v[238:239], v[202:203], v[202:203], v[238:239]
    v_pk_fma_f32 v[238:239], v[204:205], v[204:205], v[238:239]
    v_pk_fma_f32 v[238:239], v[206:207], v[206:207], v[238:239]
    v_pk_fma_f32 v[238:239], v[208:209], v[208:209], v[238:239]
    v_pk_fma_f32 v[238:239], v[210:211], v[210:211], v[238:239]
    v_add_f32 v238, v238, v239
    s_nop 1
    v_add_f32_dpp v238, v238, v238 row_ror:8 row_mask:0xf bank_mask:0xf
    s_nop 1
    v_add_f32_dpp v238, v238, v238 row_ror:4 row_mask:0xf bank_mask:0xf
    s_nop 1
    v_add_f32_dpp v238, v238, v238 row_ror:2 row_mask:0xf bank_mask:0xf
    s_nop 1
    v_add_f32_dpp v238, v238, v238 row_ror:1 row_mask:0xf bank_mask:0xf
    v_mov_b32 v239, v238
    s_nop 1
    v_permlane16_swap_b32 v238, v239
    v_add_f32 v238, v238, v239
    v_mov_b32 v237, 0x3727c5ac
    v_fmac_f32 v237, 0x3a800000, v238
    v_rsq_f32 v237, v237
    v_lshrrev_b32 v228, 1, v225
    v_lshlrev_b32 v228, 7, v228
    v_and_b32 v230, 1, v225
    v_lshl_add_u32 v228, v230, 4, v228
    v_cmp_eq_u32 vcc, 0, v224
    v_mov_b32 v238, v247
    v_mov_b32 v239, 0
    v_cndmask_b32 v228, v232, v228, vcc
    s_mov_b32 s3, 40108032
    buffer_store_dwordx4 v[236:239], v228, s[8:11], s3 offen sc1
    s_waitcnt vmcnt(11) lgkmcnt(0)
    s_barrier
    v_mfma_f32_16x16x32_bf16 v[0:3], a[24:27], a[64:67], v[0:3]
    ds_read_b64_tr_b16 a[0:1], v142 offset:0
    s_add_u32 m0, s31, 40960
    v_mfma_f32_16x16x32_bf16 v[4:7], a[24:27], a[68:71], v[4:7]
    ds_read_b64_tr_b16 a[2:3], v142 offset:1024
    v_mfma_f32_16x16x32_bf16 v[8:11], a[24:27], a[72:75], v[8:11]
    ds_read_b128 a[48:51], v134 offset:0
    v_mfma_f32_16x16x32_bf16 v[12:15], a[24:27], a[76:79], v[12:15]
    buffer_load_dwordx4 v124, s[16:19], s24 offen offset:0 lds
    v_mfma_f32_16x16x32_bf16 v[96:99], a[24:27], v[120:123], v[96:99]
    ds_read_b128 a[52:55], v134 offset:2048
    v_mfma_f32_16x16x32_bf16 v[28:31], a[28:31], a[76:79], v[28:31]
    ds_read_b128 a[56:59], v134 offset:4096
    v_mfma_f32_16x16x32_bf16 v[24:27], a[28:31], a[72:75], v[24:27]
    buffer_load_dwordx4 v125, s[16:19], s24 offen offset:1024 lds
    v_mfma_f32_16x16x32_bf16 v[20:23], a[28:31], a[68:71], v[20:23]
    ds_read_b128 a[60:63], v134 offset:6144
    v_mfma_f32_16x16x32_bf16 v[16:19], a[28:31], a[64:67], v[16:19]
    ds_read_b64_tr_b16 a[4:5], v143 offset:0
    v_mfma_f32_16x16x32_bf16 v[32:35], a[32:35], a[64:67], v[32:35]
    buffer_load_dwordx4 v126, s[16:19], s24 offen offset:2048 lds
    v_mfma_f32_16x16x32_bf16 v[36:39], a[32:35], a[68:71], v[36:39]
    ds_read_b64_tr_b16 a[6:7], v143 offset:1024
    v_mfma_f32_16x16x32_bf16 v[40:43], a[32:35], a[72:75], v[40:43]
    ds_read_b64_tr_b16 a[8:9], v142 offset:8192
    buffer_load_dwordx4 v127, s[16:19], s24 offen offset:3072 lds
    v_mfma_f32_16x16x32_bf16 v[44:47], a[32:35], a[76:79], v[44:47]
    ds_read_b64_tr_b16 a[10:11], v142 offset:9216
    v_mfma_f32_16x16x32_bf16 v[100:103], a[32:35], v[120:123], v[100:103]
    ds_read_b64_tr_b16 a[12:13], v143 offset:8192
    v_mfma_f32_16x16x32_bf16 v[60:63], a[36:39], a[76:79], v[60:63]
    s_add_u32 m0, s32, 40960
    v_mfma_f32_16x16x32_bf16 v[56:59], a[36:39], a[72:75], v[56:59]
    ds_read_b64_tr_b16 a[14:15], v143 offset:9216
    v_mfma_f32_16x16x32_bf16 v[52:55], a[36:39], a[68:71], v[52:55]
    ds_read_b64_tr_b16 a[16:17], v142 offset:16384
    v_mfma_f32_16x16x32_bf16 v[48:51], a[36:39], a[64:67], v[48:51]
    buffer_load_dwordx4 v128, s[12:15], s25 offen offset:0 lds
    v_mfma_f32_16x16x32_bf16 v[64:67], a[64:67], a[40:43], v[64:67]
    ds_read_b64_tr_b16 a[18:19], v142 offset:17408
    v_mfma_f32_16x16x32_bf16 v[68:71], a[68:71], a[40:43], v[68:71]
    ds_read_b64_tr_b16 a[20:21], v143 offset:16384
    v_mfma_f32_16x16x32_bf16 v[72:75], a[72:75], a[40:43], v[72:75]
    buffer_load_dwordx4 v129, s[12:15], s25 offen offset:1024 lds
    v_mfma_f32_16x16x32_bf16 v[76:79], a[76:79], a[40:43], v[76:79]
    ds_read_b64_tr_b16 a[22:23], v143 offset:17408
    v_mfma_f32_16x16x32_bf16 v[104:107], v[120:123], a[40:43], v[104:107]
    v_mfma_f32_16x16x32_bf16 v[92:95], a[76:79], a[44:47], v[92:95]
    v_mfma_f32_16x16x32_bf16 v[88:91], a[72:75], a[44:47], v[88:91]
    v_mfma_f32_16x16x32_bf16 v[84:87], a[68:71], a[44:47], v[84:87]
    v_mfma_f32_16x16x32_bf16 v[80:83], a[64:67], a[44:47], v[80:83]
    s_mov_b32 s20, 3
.p2align 6
qkv_loop:
    s_waitcnt lgkmcnt(0)
    v_mfma_f32_16x16x32_bf16 v[0:3], a[0:3], a[48:51], v[0:3]
    ds_read_b64_tr_b16 a[24:25], v142 offset:4096
    s_add_u32 m0, s32, 49152
    v_mfma_f32_16x16x32_bf16 v[4:7], a[0:3], a[52:55], v[4:7]
    ds_read_b64_tr_b16 a[26:27], v142 offset:5120
    v_mfma_f32_16x16x32_bf16 v[8:11], a[0:3], a[56:59], v[8:11]
    buffer_load_dwordx4 v128, s[12:15], s26 offen offset:0 lds
    v_mfma_f32_16x16x32_bf16 v[12:15], a[0:3], a[60:63], v[12:15]
    ds_read_b128 a[64:67], v135 offset:0
    v_mfma_f32_16x16x32_bf16 v[96:99], a[0:3], v[120:123], v[96:99]
    ds_read_b128 a[68:71], v135 offset:2048
    v_mfma_f32_16x16x32_bf16 v[28:31], a[4:7], a[60:63], v[28:31]
    buffer_load_dwordx4 v129, s[12:15], s26 offen offset:1024 lds
    ds_read_b128 a[72:75], v135 offset:4096
    v_mfma_f32_16x16x32_bf16 v[24:27], a[4:7], a[56:59], v[24:27]
    s_add_u32 m0, s32, 57344
    v_mfma_f32_16x16x32_bf16 v[20:23], a[4:7], a[52:55], v[20:23]
    ds_read_b128 a[76:79], v135 offset:6144
    v_mfma_f32_16x16x32_bf16 v[16:19], a[4:7], a[48:51], v[16:19]
    ds_read_b64_tr_b16 a[28:29], v143 offset:4096
    v_mfma_f32_16x16x32_bf16 v[32:35], a[8:11], a[48:51], v[32:35]
    buffer_load_dwordx4 v128, s[12:15], s27 offen offset:0 lds
    v_mfma_f32_16x16x32_bf16 v[36:39], a[8:11], a[52:55], v[36:39]
    ds_read_b64_tr_b16 a[30:31], v143 offset:5120
    v_mfma_f32_16x16x32_bf16 v[40:43], a[8:11], a[56:59], v[40:43]
    ds_read_b64_tr_b16 a[32:33], v142 offset:12288
    buffer_load_dwordx4 v129, s[12:15], s27 offen offset:1024 lds
    v_mfma_f32_16x16x32_bf16 v[44:47], a[8:11], a[60:63], v[44:47]
    ds_read_b64_tr_b16 a[34:35], v142 offset:13312
    v_mfma_f32_16x16x32_bf16 v[100:103], a[8:11], v[120:123], v[100:103]
    s_add_u32 s24, s24, 128
    v_mfma_f32_16x16x32_bf16 v[60:63], a[12:15], a[60:63], v[60:63]
    ds_read_b64_tr_b16 a[36:37], v143 offset:12288
    v_mfma_f32_16x16x32_bf16 v[56:59], a[12:15], a[56:59], v[56:59]
    ds_read_b64_tr_b16 a[38:39], v143 offset:13312
    v_mfma_f32_16x16x32_bf16 v[52:55], a[12:15], a[52:55], v[52:55]
    s_add_u32 s25, s25, 393216
    ds_read_b64_tr_b16 a[40:41], v142 offset:20480
    v_mfma_f32_16x16x32_bf16 v[48:51], a[12:15], a[48:51], v[48:51]
    s_add_u32 s26, s26, 393216
    v_mfma_f32_16x16x32_bf16 v[64:67], a[48:51], a[16:19], v[64:67]
    ds_read_b64_tr_b16 a[42:43], v142 offset:21504
    v_mfma_f32_16x16x32_bf16 v[68:71], a[52:55], a[16:19], v[68:71]
    ds_read_b64_tr_b16 a[44:45], v143 offset:20480
    v_mfma_f32_16x16x32_bf16 v[72:75], a[56:59], a[16:19], v[72:75]
    s_add_u32 s27, s27, 393216
    v_mfma_f32_16x16x32_bf16 v[76:79], a[60:63], a[16:19], v[76:79]
    ds_read_b64_tr_b16 a[46:47], v143 offset:21504
    v_mfma_f32_16x16x32_bf16 v[104:107], v[120:123], a[16:19], v[104:107]
    v_mfma_f32_16x16x32_bf16 v[92:95], a[60:63], a[20:23], v[92:95]
    v_mfma_f32_16x16x32_bf16 v[88:91], a[56:59], a[20:23], v[88:91]
    v_mfma_f32_16x16x32_bf16 v[84:87], a[52:55], a[20:23], v[84:87]
    v_mfma_f32_16x16x32_bf16 v[80:83], a[48:51], a[20:23], v[80:83]
    s_waitcnt vmcnt(10) lgkmcnt(0)
    s_barrier
    v_mfma_f32_16x16x32_bf16 v[0:3], a[24:27], a[64:67], v[0:3]
    ds_read_b64_tr_b16 a[0:1], v138 offset:0
    s_add_u32 m0, s31, 81920
    v_mfma_f32_16x16x32_bf16 v[4:7], a[24:27], a[68:71], v[4:7]
    ds_read_b64_tr_b16 a[2:3], v138 offset:1024
    v_mfma_f32_16x16x32_bf16 v[8:11], a[24:27], a[72:75], v[8:11]
    ds_read_b128 a[48:51], v130 offset:0
    v_mfma_f32_16x16x32_bf16 v[12:15], a[24:27], a[76:79], v[12:15]
    buffer_load_dwordx4 v124, s[16:19], s24 offen offset:0 lds
    v_mfma_f32_16x16x32_bf16 v[96:99], a[24:27], v[120:123], v[96:99]
    ds_read_b128 a[52:55], v130 offset:2048
    v_mfma_f32_16x16x32_bf16 v[28:31], a[28:31], a[76:79], v[28:31]
    ds_read_b128 a[56:59], v130 offset:4096
    v_mfma_f32_16x16x32_bf16 v[24:27], a[28:31], a[72:75], v[24:27]
    buffer_load_dwordx4 v125, s[16:19], s24 offen offset:1024 lds
    v_mfma_f32_16x16x32_bf16 v[20:23], a[28:31], a[68:71], v[20:23]
    ds_read_b128 a[60:63], v130 offset:6144
    v_mfma_f32_16x16x32_bf16 v[16:19], a[28:31], a[64:67], v[16:19]
    ds_read_b64_tr_b16 a[4:5], v139 offset:0
    v_mfma_f32_16x16x32_bf16 v[32:35], a[32:35], a[64:67], v[32:35]
    buffer_load_dwordx4 v126, s[16:19], s24 offen offset:2048 lds
    v_mfma_f32_16x16x32_bf16 v[36:39], a[32:35], a[68:71], v[36:39]
    ds_read_b64_tr_b16 a[6:7], v139 offset:1024
    v_mfma_f32_16x16x32_bf16 v[40:43], a[32:35], a[72:75], v[40:43]
    ds_read_b64_tr_b16 a[8:9], v138 offset:8192
    buffer_load_dwordx4 v127, s[16:19], s24 offen offset:3072 lds
    v_mfma_f32_16x16x32_bf16 v[44:47], a[32:35], a[76:79], v[44:47]
    ds_read_b64_tr_b16 a[10:11], v138 offset:9216
    v_mfma_f32_16x16x32_bf16 v[100:103], a[32:35], v[120:123], v[100:103]
    ds_read_b64_tr_b16 a[12:13], v139 offset:8192
    v_mfma_f32_16x16x32_bf16 v[60:63], a[36:39], a[76:79], v[60:63]
    s_add_u32 m0, s32, 81920
    v_mfma_f32_16x16x32_bf16 v[56:59], a[36:39], a[72:75], v[56:59]
    ds_read_b64_tr_b16 a[14:15], v139 offset:9216
    v_mfma_f32_16x16x32_bf16 v[52:55], a[36:39], a[68:71], v[52:55]
    ds_read_b64_tr_b16 a[16:17], v138 offset:16384
    v_mfma_f32_16x16x32_bf16 v[48:51], a[36:39], a[64:67], v[48:51]
    buffer_load_dwordx4 v128, s[12:15], s25 offen offset:0 lds
    v_mfma_f32_16x16x32_bf16 v[64:67], a[64:67], a[40:43], v[64:67]
    ds_read_b64_tr_b16 a[18:19], v138 offset:17408
    v_mfma_f32_16x16x32_bf16 v[68:71], a[68:71], a[40:43], v[68:71]
    ds_read_b64_tr_b16 a[20:21], v139 offset:16384
    v_mfma_f32_16x16x32_bf16 v[72:75], a[72:75], a[40:43], v[72:75]
    buffer_load_dwordx4 v129, s[12:15], s25 offen offset:1024 lds
    v_mfma_f32_16x16x32_bf16 v[76:79], a[76:79], a[40:43], v[76:79]
    ds_read_b64_tr_b16 a[22:23], v139 offset:17408
    v_mfma_f32_16x16x32_bf16 v[104:107], v[120:123], a[40:43], v[104:107]
    v_mfma_f32_16x16x32_bf16 v[92:95], a[76:79], a[44:47], v[92:95]
    v_mfma_f32_16x16x32_bf16 v[88:91], a[72:75], a[44:47], v[88:91]
    v_mfma_f32_16x16x32_bf16 v[84:87], a[68:71], a[44:47], v[84:87]
    v_mfma_f32_16x16x32_bf16 v[80:83], a[64:67], a[44:47], v[80:83]
    s_waitcnt lgkmcnt(0)
    v_mfma_f32_16x16x32_bf16 v[0:3], a[0:3], a[48:51], v[0:3]
    ds_read_b64_tr_b16 a[24:25], v138 offset:4096
    s_add_u32 m0, s32, 90112
    v_mfma_f32_16x16x32_bf16 v[4:7], a[0:3], a[52:55], v[4:7]
    ds_read_b64_tr_b16 a[26:27], v138 offset:5120
    v_mfma_f32_16x16x32_bf16 v[8:11], a[0:3], a[56:59], v[8:11]
    buffer_load_dwordx4 v128, s[12:15], s26 offen offset:0 lds
    v_mfma_f32_16x16x32_bf16 v[12:15], a[0:3], a[60:63], v[12:15]
    ds_read_b128 a[64:67], v131 offset:0
    v_mfma_f32_16x16x32_bf16 v[96:99], a[0:3], v[120:123], v[96:99]
    ds_read_b128 a[68:71], v131 offset:2048
    v_mfma_f32_16x16x32_bf16 v[28:31], a[4:7], a[60:63], v[28:31]
    buffer_load_dwordx4 v129, s[12:15], s26 offen offset:1024 lds
    ds_read_b128 a[72:75], v131 offset:4096
    v_mfma_f32_16x16x32_bf16 v[24:27], a[4:7], a[56:59], v[24:27]
    s_add_u32 m0, s32, 98304
    v_mfma_f32_16x16x32_bf16 v[20:23], a[4:7], a[52:55], v[20:23]
    ds_read_b128 a[76:79], v131 offset:6144
    v_mfma_f32_16x16x32_bf16 v[16:19], a[4:7], a[48:51], v[16:19]
    ds_read_b64_tr_b16 a[28:29], v139 offset:4096
    v_mfma_f32_16x16x32_bf16 v[32:35], a[8:11], a[48:51], v[32:35]
    buffer_load_dwordx4 v128, s[12:15], s27 offen offset:0 lds
    v_mfma_f32_16x16x32_bf16 v[36:39], a[8:11], a[52:55], v[36:39]
    ds_read_b64_tr_b16 a[30:31], v139 offset:5120
    v_mfma_f32_16x16x32_bf16 v[40:43], a[8:11], a[56:59], v[40:43]
    ds_read_b64_tr_b16 a[32:33], v138 offset:12288
    buffer_load_dwordx4 v129, s[12:15], s27 offen offset:1024 lds
    v_mfma_f32_16x16x32_bf16 v[44:47], a[8:11], a[60:63], v[44:47]
    ds_read_b64_tr_b16 a[34:35], v138 offset:13312
    v_mfma_f32_16x16x32_bf16 v[100:103], a[8:11], v[120:123], v[100:103]
    s_add_u32 s24, s24, 128
    v_mfma_f32_16x16x32_bf16 v[60:63], a[12:15], a[60:63], v[60:63]
    ds_read_b64_tr_b16 a[36:37], v139 offset:12288
    v_mfma_f32_16x16x32_bf16 v[56:59], a[12:15], a[56:59], v[56:59]
    ds_read_b64_tr_b16 a[38:39], v139 offset:13312
    v_mfma_f32_16x16x32_bf16 v[52:55], a[12:15], a[52:55], v[52:55]
    s_add_u32 s25, s25, 393216
    ds_read_b64_tr_b16 a[40:41], v138 offset:20480
    v_mfma_f32_16x16x32_bf16 v[48:51], a[12:15], a[48:51], v[48:51]
    s_add_u32 s26, s26, 393216
    v_mfma_f32_16x16x32_bf16 v[64:67], a[48:51], a[16:19], v[64:67]
    ds_read_b64_tr_b16 a[42:43], v138 offset:21504
    v_mfma_f32_16x16x32_bf16 v[68:71], a[52:55], a[16:19], v[68:71]
    ds_read_b64_tr_b16 a[44:45], v139 offset:20480
    v_mfma_f32_16x16x32_bf16 v[72:75], a[56:59], a[16:19], v[72:75]
    s_add_u32 s27, s27, 393216
    v_mfma_f32_16x16x32_bf16 v[76:79], a[60:63], a[16:19], v[76:79]
    ds_read_b64_tr_b16 a[46:47], v139 offset:21504
    v_mfma_f32_16x16x32_bf16 v[104:107], v[120:123], a[16:19], v[104:107]
    v_mfma_f32_16x16x32_bf16 v[92:95], a[60:63], a[20:23], v[92:95]
    v_mfma_f32_16x16x32_bf16 v[88:91], a[56:59], a[20:23], v[88:91]
    v_mfma_f32_16x16x32_bf16 v[84:87], a[52:55], a[20:23], v[84:87]
    v_mfma_f32_16x16x32_bf16 v[80:83], a[48:51], a[20:23], v[80:83]
    s_waitcnt vmcnt(10) lgkmcnt(0)
    s_barrier
    v_mfma_f32_16x16x32_bf16 v[0:3], a[24:27], a[64:67], v[0:3]
    ds_read_b64_tr_b16 a[0:1], v140 offset:0
    s_add_u32 m0, s31, 0
    v_mfma_f32_16x16x32_bf16 v[4:7], a[24:27], a[68:71], v[4:7]
    ds_read_b64_tr_b16 a[2:3], v140 offset:1024
    v_mfma_f32_16x16x32_bf16 v[8:11], a[24:27], a[72:75], v[8:11]
    ds_read_b128 a[48:51], v132 offset:0
    v_mfma_f32_16x16x32_bf16 v[12:15], a[24:27], a[76:79], v[12:15]
    buffer_load_dwordx4 v124, s[16:19], s24 offen offset:0 lds
    v_mfma_f32_16x16x32_bf16 v[96:99], a[24:27], v[120:123], v[96:99]
    ds_read_b128 a[52:55], v132 offset:2048
    v_mfma_f32_16x16x32_bf16 v[28:31], a[28:31], a[76:79], v[28:31]
    ds_read_b128 a[56:59], v132 offset:4096
    v_mfma_f32_16x16x32_bf16 v[24:27], a[28:31], a[72:75], v[24:27]
    buffer_load_dwordx4 v125, s[16:19], s24 offen offset:1024 lds
    v_mfma_f32_16x16x32_bf16 v[20:23], a[28:31], a[68:71], v[20:23]
    ds_read_b128 a[60:63], v132 offset:6144
    v_mfma_f32_16x16x32_bf16 v[16:19], a[28:31], a[64:67], v[16:19]
    ds_read_b64_tr_b16 a[4:5], v141 offset:0
    v_mfma_f32_16x16x32_bf16 v[32:35], a[32:35], a[64:67], v[32:35]
    buffer_load_dwordx4 v126, s[16:19], s24 offen offset:2048 lds
    v_mfma_f32_16x16x32_bf16 v[36:39], a[32:35], a[68:71], v[36:39]
    ds_read_b64_tr_b16 a[6:7], v141 offset:1024
    v_mfma_f32_16x16x32_bf16 v[40:43], a[32:35], a[72:75], v[40:43]
    ds_read_b64_tr_b16 a[8:9], v140 offset:8192
    buffer_load_dwordx4 v127, s[16:19], s24 offen offset:3072 lds
    v_mfma_f32_16x16x32_bf16 v[44:47], a[32:35], a[76:79], v[44:47]
    ds_read_b64_tr_b16 a[10:11], v140 offset:9216
    v_mfma_f32_16x16x32_bf16 v[100:103], a[32:35], v[120:123], v[100:103]
    ds_read_b64_tr_b16 a[12:13], v141 offset:8192
    v_mfma_f32_16x16x32_bf16 v[60:63], a[36:39], a[76:79], v[60:63]
    s_add_u32 m0, s32, 0
    v_mfma_f32_16x16x32_bf16 v[56:59], a[36:39], a[72:75], v[56:59]
    ds_read_b64_tr_b16 a[14:15], v141 offset:9216
    v_mfma_f32_16x16x32_bf16 v[52:55], a[36:39], a[68:71], v[52:55]
    ds_read_b64_tr_b16 a[16:17], v140 offset:16384
    v_mfma_f32_16x16x32_bf16 v[48:51], a[36:39], a[64:67], v[48:51]
    buffer_load_dwordx4 v128, s[12:15], s25 offen offset:0 lds
    v_mfma_f32_16x16x32_bf16 v[64:67], a[64:67], a[40:43], v[64:67]
    ds_read_b64_tr_b16 a[18:19], v140 offset:17408
    v_mfma_f32_16x16x32_bf16 v[68:71], a[68:71], a[40:43], v[68:71]
    ds_read_b64_tr_b16 a[20:21], v141 offset:16384
    v_mfma_f32_16x16x32_bf16 v[72:75], a[72:75], a[40:43], v[72:75]
    buffer_load_dwordx4 v129, s[12:15], s25 offen offset:1024 lds
    v_mfma_f32_16x16x32_bf16 v[76:79], a[76:79], a[40:43], v[76:79]
    ds_read_b64_tr_b16 a[22:23], v141 offset:17408
    v_mfma_f32_16x16x32_bf16 v[104:107], v[120:123], a[40:43], v[104:107]
    v_mfma_f32_16x16x32_bf16 v[92:95], a[76:79], a[44:47], v[92:95]
    v_mfma_f32_16x16x32_bf16 v[88:91], a[72:75], a[44:47], v[88:91]
    v_mfma_f32_16x16x32_bf16 v[84:87], a[68:71], a[44:47], v[84:87]
    v_mfma_f32_16x16x32_bf16 v[80:83], a[64:67], a[44:47], v[80:83]
    s_waitcnt lgkmcnt(0)
    v_mfma_f32_16x16x32_bf16 v[0:3], a[0:3], a[48:51], v[0:3]
    ds_read_b64_tr_b16 a[24:25], v140 offset:4096
    s_add_u32 m0, s32, 8192
    v_mfma_f32_16x16x32_bf16 v[4:7], a[0:3], a[52:55], v[4:7]
    ds_read_b64_tr_b16 a[26:27], v140 offset:5120
    v_mfma_f32_16x16x32_bf16 v[8:11], a[0:3], a[56:59], v[8:11]
    buffer_load_dwordx4 v128, s[12:15], s26 offen offset:0 lds
    v_mfma_f32_16x16x32_bf16 v[12:15], a[0:3], a[60:63], v[12:15]
    ds_read_b128 a[64:67], v133 offset:0
    v_mfma_f32_16x16x32_bf16 v[96:99], a[0:3], v[120:123], v[96:99]
    ds_read_b128 a[68:71], v133 offset:2048
    v_mfma_f32_16x16x32_bf16 v[28:31], a[4:7], a[60:63], v[28:31]
    buffer_load_dwordx4 v129, s[12:15], s26 offen offset:1024 lds
    ds_read_b128 a[72:75], v133 offset:4096
    v_mfma_f32_16x16x32_bf16 v[24:27], a[4:7], a[56:59], v[24:27]
    s_add_u32 m0, s32, 16384
    v_mfma_f32_16x16x32_bf16 v[20:23], a[4:7], a[52:55], v[20:23]
    ds_read_b128 a[76:79], v133 offset:6144
    v_mfma_f32_16x16x32_bf16 v[16:19], a[4:7], a[48:51], v[16:19]
    ds_read_b64_tr_b16 a[28:29], v141 offset:4096
    v_mfma_f32_16x16x32_bf16 v[32:35], a[8:11], a[48:51], v[32:35]
    buffer_load_dwordx4 v128, s[12:15], s27 offen offset:0 lds
    v_mfma_f32_16x16x32_bf16 v[36:39], a[8:11], a[52:55], v[36:39]
    ds_read_b64_tr_b16 a[30:31], v141 offset:5120
    v_mfma_f32_16x16x32_bf16 v[40:43], a[8:11], a[56:59], v[40:43]
    ds_read_b64_tr_b16 a[32:33], v140 offset:12288
    buffer_load_dwordx4 v129, s[12:15], s27 offen offset:1024 lds
    v_mfma_f32_16x16x32_bf16 v[44:47], a[8:11], a[60:63], v[44:47]
    ds_read_b64_tr_b16 a[34:35], v140 offset:13312
    v_mfma_f32_16x16x32_bf16 v[100:103], a[8:11], v[120:123], v[100:103]
    s_add_u32 s24, s24, 128
    v_mfma_f32_16x16x32_bf16 v[60:63], a[12:15], a[60:63], v[60:63]
    ds_read_b64_tr_b16 a[36:37], v141 offset:12288
    v_mfma_f32_16x16x32_bf16 v[56:59], a[12:15], a[56:59], v[56:59]
    ds_read_b64_tr_b16 a[38:39], v141 offset:13312
    v_mfma_f32_16x16x32_bf16 v[52:55], a[12:15], a[52:55], v[52:55]
    s_add_u32 s25, s25, 393216
    ds_read_b64_tr_b16 a[40:41], v140 offset:20480
    v_mfma_f32_16x16x32_bf16 v[48:51], a[12:15], a[48:51], v[48:51]
    s_add_u32 s26, s26, 393216
    v_mfma_f32_16x16x32_bf16 v[64:67], a[48:51], a[16:19], v[64:67]
    ds_read_b64_tr_b16 a[42:43], v140 offset:21504
    v_mfma_f32_16x16x32_bf16 v[68:71], a[52:55], a[16:19], v[68:71]
    ds_read_b64_tr_b16 a[44:45], v141 offset:20480
    v_mfma_f32_16x16x32_bf16 v[72:75], a[56:59], a[16:19], v[72:75]
    s_add_u32 s27, s27, 393216
    v_mfma_f32_16x16x32_bf16 v[76:79], a[60:63], a[16:19], v[76:79]
    ds_read_b64_tr_b16 a[46:47], v141 offset:21504
    v_mfma_f32_16x16x32_bf16 v[104:107], v[120:123], a[16:19], v[104:107]
    v_mfma_f32_16x16x32_bf16 v[92:95], a[60:63], a[20:23], v[92:95]
    v_mfma_f32_16x16x32_bf16 v[88:91], a[56:59], a[20:23], v[88:91]
    v_mfma_f32_16x16x32_bf16 v[84:87], a[52:55], a[20:23], v[84:87]
    v_mfma_f32_16x16x32_bf16 v[80:83], a[48:51], a[20:23], v[80:83]
    s_waitcnt vmcnt(10) lgkmcnt(0)
    s_barrier
    v_mfma_f32_16x16x32_bf16 v[0:3], a[24:27], a[64:67], v[0:3]
    ds_read_b64_tr_b16 a[0:1], v142 offset:0
    s_add_u32 m0, s31, 40960
    v_mfma_f32_16x16x32_bf16 v[4:7], a[24:27], a[68:71], v[4:7]
    ds_read_b64_tr_b16 a[2:3], v142 offset:1024
    v_mfma_f32_16x16x32_bf16 v[8:11], a[24:27], a[72:75], v[8:11]
    ds_read_b128 a[48:51], v134 offset:0
    v_mfma_f32_16x16x32_bf16 v[12:15], a[24:27], a[76:79], v[12:15]
    buffer_load_dwordx4 v124, s[16:19], s24 offen offset:0 lds
    v_mfma_f32_16x16x32_bf16 v[96:99], a[24:27], v[120:123], v[96:99]
    ds_read_b128 a[52:55], v134 offset:2048
    v_mfma_f32_16x16x32_bf16 v[28:31], a[28:31], a[76:79], v[28:31]
    ds_read_b128 a[56:59], v134 offset:4096
    v_mfma_f32_16x16x32_bf16 v[24:27], a[28:31], a[72:75], v[24:27]
    buffer_load_dwordx4 v125, s[16:19], s24 offen offset:1024 lds
    v_mfma_f32_16x16x32_bf16 v[20:23], a[28:31], a[68:71], v[20:23]
    ds_read_b128 a[60:63], v134 offset:6144
    v_mfma_f32_16x16x32_bf16 v[16:19], a[28:31], a[64:67], v[16:19]
    ds_read_b64_tr_b16 a[4:5], v143 offset:0
    v_mfma_f32_16x16x32_bf16 v[32:35], a[32:35], a[64:67], v[32:35]
    buffer_load_dwordx4 v126, s[16:19], s24 offen offset:2048 lds
    v_mfma_f32_16x16x32_bf16 v[36:39], a[32:35], a[68:71], v[36:39]
    ds_read_b64_tr_b16 a[6:7], v143 offset:1024
    v_mfma_f32_16x16x32_bf16 v[40:43], a[32:35], a[72:75], v[40:43]
    ds_read_b64_tr_b16 a[8:9], v142 offset:8192
    buffer_load_dwordx4 v127, s[16:19], s24 offen offset:3072 lds
    v_mfma_f32_16x16x32_bf16 v[44:47], a[32:35], a[76:79], v[44:47]
    ds_read_b64_tr_b16 a[10:11], v142 offset:9216
    v_mfma_f32_16x16x32_bf16 v[100:103], a[32:35], v[120:123], v[100:103]
    ds_read_b64_tr_b16 a[12:13], v143 offset:8192
    v_mfma_f32_16x16x32_bf16 v[60:63], a[36:39], a[76:79], v[60:63]
    s_add_u32 m0, s32, 40960
    v_mfma_f32_16x16x32_bf16 v[56:59], a[36:39], a[72:75], v[56:59]
    ds_read_b64_tr_b16 a[14:15], v143 offset:9216
    v_mfma_f32_16x16x32_bf16 v[52:55], a[36:39], a[68:71], v[52:55]
    ds_read_b64_tr_b16 a[16:17], v142 offset:16384
    v_mfma_f32_16x16x32_bf16 v[48:51], a[36:39], a[64:67], v[48:51]
    buffer_load_dwordx4 v128, s[12:15], s25 offen offset:0 lds
    v_mfma_f32_16x16x32_bf16 v[64:67], a[64:67], a[40:43], v[64:67]
    ds_read_b64_tr_b16 a[18:19], v142 offset:17408
    v_mfma_f32_16x16x32_bf16 v[68:71], a[68:71], a[40:43], v[68:71]
    ds_read_b64_tr_b16 a[20:21], v143 offset:16384
    v_mfma_f32_16x16x32_bf16 v[72:75], a[72:75], a[40:43], v[72:75]
    buffer_load_dwordx4 v129, s[12:15], s25 offen offset:1024 lds
    v_mfma_f32_16x16x32_bf16 v[76:79], a[76:79], a[40:43], v[76:79]
    ds_read_b64_tr_b16 a[22:23], v143 offset:17408
    v_mfma_f32_16x16x32_bf16 v[104:107], v[120:123], a[40:43], v[104:107]
    v_mfma_f32_16x16x32_bf16 v[92:95], a[76:79], a[44:47], v[92:95]
    v_mfma_f32_16x16x32_bf16 v[88:91], a[72:75], a[44:47], v[88:91]
    v_mfma_f32_16x16x32_bf16 v[84:87], a[68:71], a[44:47], v[84:87]
    s_sub_u32 s20, s20, 1
    v_mfma_f32_16x16x32_bf16 v[80:83], a[64:67], a[44:47], v[80:83]
    s_cmp_lg_u32 s20, 0
    s_cbranch_scc1 qkv_loop
    s_waitcnt lgkmcnt(0)
    v_mfma_f32_16x16x32_bf16 v[0:3], a[0:3], a[48:51], v[0:3]
    ds_read_b64_tr_b16 a[24:25], v142 offset:4096
    s_add_u32 m0, s32, 49152
    v_mfma_f32_16x16x32_bf16 v[4:7], a[0:3], a[52:55], v[4:7]
    ds_read_b64_tr_b16 a[26:27], v142 offset:5120
    v_mfma_f32_16x16x32_bf16 v[8:11], a[0:3], a[56:59], v[8:11]
    buffer_load_dwordx4 v128, s[12:15], s26 offen offset:0 lds
    v_mfma_f32_16x16x32_bf16 v[12:15], a[0:3], a[60:63], v[12:15]
    ds_read_b128 a[64:67], v135 offset:0
    v_mfma_f32_16x16x32_bf16 v[96:99], a[0:3], v[120:123], v[96:99]
    ds_read_b128 a[68:71], v135 offset:2048
    v_mfma_f32_16x16x32_bf16 v[28:31], a[4:7], a[60:63], v[28:31]
    buffer_load_dwordx4 v129, s[12:15], s26 offen offset:1024 lds
    ds_read_b128 a[72:75], v135 offset:4096
    v_mfma_f32_16x16x32_bf16 v[24:27], a[4:7], a[56:59], v[24:27]
    s_add_u32 m0, s32, 57344
    v_mfma_f32_16x16x32_bf16 v[20:23], a[4:7], a[52:55], v[20:23]
    ds_read_b128 a[76:79], v135 offset:6144
    v_mfma_f32_16x16x32_bf16 v[16:19], a[4:7], a[48:51], v[16:19]
    ds_read_b64_tr_b16 a[28:29], v143 offset:4096
    v_mfma_f32_16x16x32_bf16 v[32:35], a[8:11], a[48:51], v[32:35]
    buffer_load_dwordx4 v128, s[12:15], s27 offen offset:0 lds
    v_mfma_f32_16x16x32_bf16 v[36:39], a[8:11], a[52:55], v[36:39]
    ds_read_b64_tr_b16 a[30:31], v143 offset:5120
    v_mfma_f32_16x16x32_bf16 v[40:43], a[8:11], a[56:59], v[40:43]
    ds_read_b64_tr_b16 a[32:33], v142 offset:12288
    buffer_load_dwordx4 v129, s[12:15], s27 offen offset:1024 lds
    v_mfma_f32_16x16x32_bf16 v[44:47], a[8:11], a[60:63], v[44:47]
    ds_read_b64_tr_b16 a[34:35], v142 offset:13312
    v_mfma_f32_16x16x32_bf16 v[100:103], a[8:11], v[120:123], v[100:103]
    s_add_u32 s24, s24, 128
    v_mfma_f32_16x16x32_bf16 v[60:63], a[12:15], a[60:63], v[60:63]
    ds_read_b64_tr_b16 a[36:37], v143 offset:12288
    v_mfma_f32_16x16x32_bf16 v[56:59], a[12:15], a[56:59], v[56:59]
    ds_read_b64_tr_b16 a[38:39], v143 offset:13312
    v_mfma_f32_16x16x32_bf16 v[52:55], a[12:15], a[52:55], v[52:55]
    s_add_u32 s25, s25, 393216
    ds_read_b64_tr_b16 a[40:41], v142 offset:20480
    v_mfma_f32_16x16x32_bf16 v[48:51], a[12:15], a[48:51], v[48:51]
    s_add_u32 s26, s26, 393216
    v_mfma_f32_16x16x32_bf16 v[64:67], a[48:51], a[16:19], v[64:67]
    ds_read_b64_tr_b16 a[42:43], v142 offset:21504
    v_mfma_f32_16x16x32_bf16 v[68:71], a[52:55], a[16:19], v[68:71]
    ds_read_b64_tr_b16 a[44:45], v143 offset:20480
    v_mfma_f32_16x16x32_bf16 v[72:75], a[56:59], a[16:19], v[72:75]
    s_add_u32 s27, s27, 393216
    v_mfma_f32_16x16x32_bf16 v[76:79], a[60:63], a[16:19], v[76:79]
    ds_read_b64_tr_b16 a[46:47], v143 offset:21504
    v_mfma_f32_16x16x32_bf16 v[104:107], v[120:123], a[16:19], v[104:107]
    v_mfma_f32_16x16x32_bf16 v[92:95], a[60:63], a[20:23], v[92:95]
    v_mfma_f32_16x16x32_bf16 v[88:91], a[56:59], a[20:23], v[88:91]
    v_mfma_f32_16x16x32_bf16 v[84:87], a[52:55], a[20:23], v[84:87]
    v_mfma_f32_16x16x32_bf16 v[80:83], a[48:51], a[20:23], v[80:83]
    s_waitcnt vmcnt(10) lgkmcnt(0)
    s_barrier
    v_mfma_f32_16x16x32_bf16 v[0:3], a[24:27], a[64:67], v[0:3]
    ds_read_b64_tr_b16 a[0:1], v138 offset:0
    s_add_u32 m0, s31, 81920
    v_mfma_f32_16x16x32_bf16 v[4:7], a[24:27], a[68:71], v[4:7]
    ds_read_b64_tr_b16 a[2:3], v138 offset:1024
    v_mfma_f32_16x16x32_bf16 v[8:11], a[24:27], a[72:75], v[8:11]
    ds_read_b128 a[48:51], v130 offset:0
    v_mfma_f32_16x16x32_bf16 v[12:15], a[24:27], a[76:79], v[12:15]
    buffer_load_dwordx4 v124, s[16:19], s24 offen offset:0 lds
    v_mfma_f32_16x16x32_bf16 v[96:99], a[24:27], v[120:123], v[96:99]
    ds_read_b128 a[52:55], v130 offset:2048
    v_mfma_f32_16x16x32_bf16 v[28:31], a[28:31], a[76:79], v[28:31]
    ds_read_b128 a[56:59], v130 offset:4096
    v_mfma_f32_16x16x32_bf16 v[24:27], a[28:31], a[72:75], v[24:27]
    buffer_load_dwordx4 v125, s[16:19], s24 offen offset:1024 lds
    v_mfma_f32_16x16x32_bf16 v[20:23], a[28:31], a[68:71], v[20:23]
    ds_read_b128 a[60:63], v130 offset:6144
    v_mfma_f32_16x16x32_bf16 v[16:19], a[28:31], a[64:67], v[16:19]
    ds_read_b64_tr_b16 a[4:5], v139 offset:0
    v_mfma_f32_16x16x32_bf16 v[32:35], a[32:35], a[64:67], v[32:35]
    buffer_load_dwordx4 v126, s[16:19], s24 offen offset:2048 lds
    v_mfma_f32_16x16x32_bf16 v[36:39], a[32:35], a[68:71], v[36:39]
    ds_read_b64_tr_b16 a[6:7], v139 offset:1024
    v_mfma_f32_16x16x32_bf16 v[40:43], a[32:35], a[72:75], v[40:43]
    ds_read_b64_tr_b16 a[8:9], v138 offset:8192
    buffer_load_dwordx4 v127, s[16:19], s24 offen offset:3072 lds
    v_mfma_f32_16x16x32_bf16 v[44:47], a[32:35], a[76:79], v[44:47]
    ds_read_b64_tr_b16 a[10:11], v138 offset:9216
    v_mfma_f32_16x16x32_bf16 v[100:103], a[32:35], v[120:123], v[100:103]
    ds_read_b64_tr_b16 a[12:13], v139 offset:8192
    v_mfma_f32_16x16x32_bf16 v[60:63], a[36:39], a[76:79], v[60:63]
    s_add_u32 m0, s32, 81920
    v_mfma_f32_16x16x32_bf16 v[56:59], a[36:39], a[72:75], v[56:59]
    ds_read_b64_tr_b16 a[14:15], v139 offset:9216
    v_mfma_f32_16x16x32_bf16 v[52:55], a[36:39], a[68:71], v[52:55]
    ds_read_b64_tr_b16 a[16:17], v138 offset:16384
    v_mfma_f32_16x16x32_bf16 v[48:51], a[36:39], a[64:67], v[48:51]
    buffer_load_dwordx4 v128, s[12:15], s25 offen offset:0 lds
    v_mfma_f32_16x16x32_bf16 v[64:67], a[64:67], a[40:43], v[64:67]
    ds_read_b64_tr_b16 a[18:19], v138 offset:17408
    v_mfma_f32_16x16x32_bf16 v[68:71], a[68:71], a[40:43], v[68:71]
    ds_read_b64_tr_b16 a[20:21], v139 offset:16384
    v_mfma_f32_16x16x32_bf16 v[72:75], a[72:75], a[40:43], v[72:75]
    buffer_load_dwordx4 v129, s[12:15], s25 offen offset:1024 lds
    v_mfma_f32_16x16x32_bf16 v[76:79], a[76:79], a[40:43], v[76:79]
    ds_read_b64_tr_b16 a[22:23], v139 offset:17408
    v_mfma_f32_16x16x32_bf16 v[104:107], v[120:123], a[40:43], v[104:107]
    v_mfma_f32_16x16x32_bf16 v[92:95], a[76:79], a[44:47], v[92:95]
    v_mfma_f32_16x16x32_bf16 v[88:91], a[72:75], a[44:47], v[88:91]
    v_mfma_f32_16x16x32_bf16 v[84:87], a[68:71], a[44:47], v[84:87]
    v_mfma_f32_16x16x32_bf16 v[80:83], a[64:67], a[44:47], v[80:83]
    s_waitcnt lgkmcnt(0)
    v_mfma_f32_16x16x32_bf16 v[0:3], a[0:3], a[48:51], v[0:3]
    ds_read_b64_tr_b16 a[24:25], v138 offset:4096
    s_add_u32 m0, s32, 90112
    v_mfma_f32_16x16x32_bf16 v[4:7], a[0:3], a[52:55], v[4:7]
    ds_read_b64_tr_b16 a[26:27], v138 offset:5120
    v_mfma_f32_16x16x32_bf16 v[8:11], a[0:3], a[56:59], v[8:11]
    buffer_load_dwordx4 v128, s[12:15], s26 offen offset:0 lds
    v_mfma_f32_16x16x32_bf16 v[12:15], a[0:3], a[60:63], v[12:15]
    ds_read_b128 a[64:67], v131 offset:0
    v_mfma_f32_16x16x32_bf16 v[96:99], a[0:3], v[120:123], v[96:99]
    buffer_load_dwordx4 v129, s[12:15], s26 offen offset:1024 lds
    ds_read_b128 a[68:71], v131 offset:2048
    v_mfma_f32_16x16x32_bf16 v[28:31], a[4:7], a[60:63], v[28:31]
    ds_read_b128 a[72:75], v131 offset:4096
    v_mfma_f32_16x16x32_bf16 v[24:27], a[4:7], a[56:59], v[24:27]
    s_add_u32 m0, s32, 98304
    v_mfma_f32_16x16x32_bf16 v[20:23], a[4:7], a[52:55], v[20:23]
    ds_read_b128 a[76:79], v131 offset:6144
    v_mfma_f32_16x16x32_bf16 v[16:19], a[4:7], a[48:51], v[16:19]
    buffer_load_dwordx4 v128, s[12:15], s27 offen offset:0 lds
    ds_read_b64_tr_b16 a[28:29], v139 offset:4096
    v_mfma_f32_16x16x32_bf16 v[32:35], a[8:11], a[48:51], v[32:35]
    ds_read_b64_tr_b16 a[30:31], v139 offset:5120
    v_mfma_f32_16x16x32_bf16 v[36:39], a[8:11], a[52:55], v[36:39]
    buffer_load_dwordx4 v129, s[12:15], s27 offen offset:1024 lds
    v_mfma_f32_16x16x32_bf16 v[40:43], a[8:11], a[56:59], v[40:43]
    ds_read_b64_tr_b16 a[32:33], v138 offset:12288
    v_mfma_f32_16x16x32_bf16 v[44:47], a[8:11], a[60:63], v[44:47]
    s_add_u32 s24, s24, 128
    v_mfma_f32_16x16x32_bf16 v[100:103], a[8:11], v[120:123], v[100:103]
    ds_read_b64_tr_b16 a[34:35], v138 offset:13312
    ds_read_b64_tr_b16 a[36:37], v139 offset:12288
    v_mfma_f32_16x16x32_bf16 v[60:63], a[12:15], a[60:63], v[60:63]
    s_add_u32 s25, s25, 393216
    v_mfma_f32_16x16x32_bf16 v[56:59], a[12:15], a[56:59], v[56:59]
    ds_read_b64_tr_b16 a[38:39], v139 offset:13312
    v_mfma_f32_16x16x32_bf16 v[52:55], a[12:15], a[52:55], v[52:55]
    s_add_u32 s26, s26, 393216
    v_mfma_f32_16x16x32_bf16 v[48:51], a[12:15], a[48:51], v[48:51]
    ds_read_b64_tr_b16 a[40:41], v138 offset:20480
    ds_read_b64_tr_b16 a[42:43], v138 offset:21504
    v_mfma_f32_16x16x32_bf16 v[64:67], a[48:51], a[16:19], v[64:67]
    s_add_u32 s27, s27, 393216
    v_mfma_f32_16x16x32_bf16 v[68:71], a[52:55], a[16:19], v[68:71]
    ds_read_b64_tr_b16 a[44:45], v139 offset:20480
    v_mfma_f32_16x16x32_bf16 v[72:75], a[56:59], a[16:19], v[72:75]
    buffer_load_dwordx4 v[152:155], v146, s[8:11], s6 offen sc1
    v_mfma_f32_16x16x32_bf16 v[76:79], a[60:63], a[16:19], v[76:79]
    ds_read_b64_tr_b16 a[46:47], v139 offset:21504
    v_mfma_f32_16x16x32_bf16 v[104:107], v[120:123], a[16:19], v[104:107]
    v_mfma_f32_16x16x32_bf16 v[92:95], a[60:63], a[20:23], v[92:95]
    v_mfma_f32_16x16x32_bf16 v[88:91], a[56:59], a[20:23], v[88:91]
    v_mfma_f32_16x16x32_bf16 v[84:87], a[52:55], a[20:23], v[84:87]
    v_mfma_f32_16x16x32_bf16 v[80:83], a[48:51], a[20:23], v[80:83]
    s_waitcnt vmcnt(11) lgkmcnt(0)
    s_barrier
    v_mfma_f32_16x16x32_bf16 v[0:3], a[24:27], a[64:67], v[0:3]
    ds_read_b64_tr_b16 a[0:1], v140 offset:0
    s_add_u32 m0, s31, 0
    v_mfma_f32_16x16x32_bf16 v[4:7], a[24:27], a[68:71], v[4:7]
    ds_read_b64_tr_b16 a[2:3], v140 offset:1024
    v_mfma_f32_16x16x32_bf16 v[8:11], a[24:27], a[72:75], v[8:11]
    ds_read_b128 a[48:51], v132 offset:0
    v_mfma_f32_16x16x32_bf16 v[12:15], a[24:27], a[76:79], v[12:15]
    buffer_load_dwordx4 v124, s[16:19], s24 offen offset:0 lds
    v_mfma_f32_16x16x32_bf16 v[96:99], a[24:27], v[120:123], v[96:99]
    ds_read_b128 a[52:55], v132 offset:2048
    v_mfma_f32_16x16x32_bf16 v[28:31], a[28:31], a[76:79], v[28:31]
    ds_read_b128 a[56:59], v132 offset:4096
    v_mfma_f32_16x16x32_bf16 v[24:27], a[28:31], a[72:75], v[24:27]
    buffer_load_dwordx4 v125, s[16:19], s24 offen offset:1024 lds
    v_mfma_f32_16x16x32_bf16 v[20:23], a[28:31], a[68:71], v[20:23]
    ds_read_b128 a[60:63], v132 offset:6144
    v_mfma_f32_16x16x32_bf16 v[16:19], a[28:31], a[64:67], v[16:19]
    ds_read_b64_tr_b16 a[4:5], v141 offset:0
    v_mfma_f32_16x16x32_bf16 v[32:35], a[32:35], a[64:67], v[32:35]
    buffer_load_dwordx4 v126, s[16:19], s24 offen offset:2048 lds
    v_mfma_f32_16x16x32_bf16 v[36:39], a[32:35], a[68:71], v[36:39]
    ds_read_b64_tr_b16 a[6:7], v141 offset:1024
    v_mfma_f32_16x16x32_bf16 v[40:43], a[32:35], a[72:75], v[40:43]
    ds_read_b64_tr_b16 a[8:9], v140 offset:8192
    buffer_load_dwordx4 v127, s[16:19], s24 offen offset:3072 lds
    v_mfma_f32_16x16x32_bf16 v[44:47], a[32:35], a[76:79], v[44:47]
    ds_read_b64_tr_b16 a[10:11], v140 offset:9216
    v_mfma_f32_16x16x32_bf16 v[100:103], a[32:35], v[120:123], v[100:103]
    ds_read_b64_tr_b16 a[12:13], v141 offset:8192
    v_mfma_f32_16x16x32_bf16 v[60:63], a[36:39], a[76:79], v[60:63]
    s_add_u32 m0, s32, 0
    v_mfma_f32_16x16x32_bf16 v[56:59], a[36:39], a[72:75], v[56:59]
    ds_read_b64_tr_b16 a[14:15], v141 offset:9216
    v_mfma_f32_16x16x32_bf16 v[52:55], a[36:39], a[68:71], v[52:55]
    ds_read_b64_tr_b16 a[16:17], v140 offset:16384
    v_mfma_f32_16x16x32_bf16 v[48:51], a[36:39], a[64:67], v[48:51]
    buffer_load_dwordx4 v128, s[12:15], s25 offen offset:0 lds
    v_mfma_f32_16x16x32_bf16 v[64:67], a[64:67], a[40:43], v[64:67]
    ds_read_b64_tr_b16 a[18:19], v140 offset:17408
    v_mfma_f32_16x16x32_bf16 v[68:71], a[68:71], a[40:43], v[68:71]
    ds_read_b64_tr_b16 a[20:21], v141 offset:16384
    v_mfma_f32_16x16x32_bf16 v[72:75], a[72:75], a[40:43], v[72:75]
    buffer_load_dwordx4 v129, s[12:15], s25 offen offset:1024 lds
    v_mfma_f32_16x16x32_bf16 v[76:79], a[76:79], a[40:43], v[76:79]
    ds_read_b64_tr_b16 a[22:23], v141 offset:17408
    v_mfma_f32_16x16x32_bf16 v[104:107], v[120:123], a[40:43], v[104:107]
    v_mfma_f32_16x16x32_bf16 v[92:95], a[76:79], a[44:47], v[92:95]
    v_mfma_f32_16x16x32_bf16 v[88:91], a[72:75], a[44:47], v[88:91]
    v_mfma_f32_16x16x32_bf16 v[84:87], a[68:71], a[44:47], v[84:87]
    v_mfma_f32_16x16x32_bf16 v[80:83], a[64:67], a[44:47], v[80:83]
    s_waitcnt lgkmcnt(0)
    v_mfma_f32_16x16x32_bf16 v[0:3], a[0:3], a[48:51], v[0:3]
    ds_read_b64_tr_b16 a[24:25], v140 offset:4096
    s_add_u32 m0, s32, 8192
    v_mfma_f32_16x16x32_bf16 v[4:7], a[0:3], a[52:55], v[4:7]
    ds_read_b64_tr_b16 a[26:27], v140 offset:5120
    v_mfma_f32_16x16x32_bf16 v[8:11], a[0:3], a[56:59], v[8:11]
    buffer_load_dwordx4 v128, s[12:15], s26 offen offset:0 lds
    v_mfma_f32_16x16x32_bf16 v[12:15], a[0:3], a[60:63], v[12:15]
    ds_read_b128 a[64:67], v133 offset:0
    v_mfma_f32_16x16x32_bf16 v[96:99], a[0:3], v[120:123], v[96:99]
    ds_read_b128 a[68:71], v133 offset:2048
    v_mfma_f32_16x16x32_bf16 v[28:31], a[4:7], a[60:63], v[28:31]
    buffer_load_dwordx4 v129, s[12:15], s26 offen offset:1024 lds
    ds_read_b128 a[72:75], v133 offset:4096
    v_mfma_f32_16x16x32_bf16 v[24:27], a[4:7], a[56:59], v[24:27]
    s_add_u32 m0, s32, 16384
    v_mfma_f32_16x16x32_bf16 v[20:23], a[4:7], a[52:55], v[20:23]
    ds_read_b128 a[76:79], v133 offset:6144
    v_mfma_f32_16x16x32_bf16 v[16:19], a[4:7], a[48:51], v[16:19]
    ds_read_b64_tr_b16 a[28:29], v141 offset:4096
    v_mfma_f32_16x16x32_bf16 v[32:35], a[8:11], a[48:51], v[32:35]
    buffer_load_dwordx4 v128, s[12:15], s27 offen offset:0 lds
    v_mfma_f32_16x16x32_bf16 v[36:39], a[8:11], a[52:55], v[36:39]
    ds_read_b64_tr_b16 a[30:31], v141 offset:5120
    v_mfma_f32_16x16x32_bf16 v[40:43], a[8:11], a[56:59], v[40:43]
    ds_read_b64_tr_b16 a[32:33], v140 offset:12288
    buffer_load_dwordx4 v129, s[12:15], s27 offen offset:1024 lds
    v_mfma_f32_16x16x32_bf16 v[44:47], a[8:11], a[60:63], v[44:47]
    ds_read_b64_tr_b16 a[34:35], v140 offset:13312
    v_mfma_f32_16x16x32_bf16 v[100:103], a[8:11], v[120:123], v[100:103]
    s_add_u32 s24, s24, 128
    v_mfma_f32_16x16x32_bf16 v[60:63], a[12:15], a[60:63], v[60:63]
    ds_read_b64_tr_b16 a[36:37], v141 offset:12288
    v_mfma_f32_16x16x32_bf16 v[56:59], a[12:15], a[56:59], v[56:59]
    ds_read_b64_tr_b16 a[38:39], v141 offset:13312
    v_mfma_f32_16x16x32_bf16 v[52:55], a[12:15], a[52:55], v[52:55]
    s_add_u32 s25, s25, 393216
    ds_read_b64_tr_b16 a[40:41], v140 offset:20480
    v_mfma_f32_16x16x32_bf16 v[48:51], a[12:15], a[48:51], v[48:51]
    s_add_u32 s26, s26, 393216
    v_mfma_f32_16x16x32_bf16 v[64:67], a[48:51], a[16:19], v[64:67]
    ds_read_b64_tr_b16 a[42:43], v140 offset:21504
    v_mfma_f32_16x16x32_bf16 v[68:71], a[52:55], a[16:19], v[68:71]
    ds_read_b64_tr_b16 a[44:45], v141 offset:20480
    v_mfma_f32_16x16x32_bf16 v[72:75], a[56:59], a[16:19], v[72:75]
    s_add_u32 s27, s27, 393216
    v_mfma_f32_16x16x32_bf16 v[76:79], a[60:63], a[16:19], v[76:79]
    ds_read_b64_tr_b16 a[46:47], v141 offset:21504
    v_mfma_f32_16x16x32_bf16 v[104:107], v[120:123], a[16:19], v[104:107]
    v_mfma_f32_16x16x32_bf16 v[92:95], a[60:63], a[20:23], v[92:95]
    v_mfma_f32_16x16x32_bf16 v[88:91], a[56:59], a[20:23], v[88:91]
    v_mfma_f32_16x16x32_bf16 v[84:87], a[52:55], a[20:23], v[84:87]
    v_mfma_f32_16x16x32_bf16 v[80:83], a[48:51], a[20:23], v[80:83]
    s_waitcnt vmcnt(10) lgkmcnt(0)
    s_barrier
    v_cmp_ne_u32 vcc, s29, v154
    s_cbranch_vccz statwait_ok
    s_mov_b32 s4, 0
statwait:
    buffer_load_dwordx4 v[152:155], v146, s[8:11], s6 offen sc1
    s_add_u32 s4, s4, 1
    s_waitcnt vmcnt(0)
    v_cmp_ne_u32 vcc, s29, v154
    s_cbranch_vccz statwait_ok
    s_cmp_lt_u32 s4, 2097152
    s_cbranch_scc1 statwait
statwait_ok:
    v_mfma_f32_16x16x32_bf16 v[0:3], a[24:27], a[64:67], v[0:3]
    ds_read_b64_tr_b16 a[0:1], v142 offset:0
    v_mfma_f32_16x16x32_bf16 v[4:7], a[24:27], a[68:71], v[4:7]
    ds_write_b32 v147, v152
    v_mfma_f32_16x16x32_bf16 v[8:11], a[24:27], a[72:75], v[8:11]
    ds_read_b64_tr_b16 a[2:3], v142 offset:1024
    v_mfma_f32_16x16x32_bf16 v[12:15], a[24:27], a[76:79], v[12:15]
    ds_read_b128 a[48:51], v134 offset:0
    v_mfma_f32_16x16x32_bf16 v[96:99], a[24:27], v[120:123], v[96:99]
    ds_read_b128 a[52:55], v134 offset:2048
    v_mfma_f32_16x16x32_bf16 v[28:31], a[28:31], a[76:79], v[28:31]
    v_mfma_f32_16x16x32_bf16 v[24:27], a[28:31], a[72:75], v[24:27]
    ds_read_b128 a[56:59], v134 offset:4096
    v_mfma_f32_16x16x32_bf16 v[20:23], a[28:31], a[68:71], v[20:23]
    ds_read_b128 a[60:63], v134 offset:6144
    v_mfma_f32_16x16x32_bf16 v[16:19], a[28:31], a[64:67], v[16:19]
    ds_read_b64_tr_b16 a[4:5], v143 offset:0
    v_mfma_f32_16x16x32_bf16 v[32:35], a[32:35], a[64:67], v[32:35]
    ds_read_b64_tr_b16 a[6:7], v143 offset:1024
    v_mfma_f32_16x16x32_bf16 v[36:39], a[32:35], a[68:71], v[36:39]
    v_mfma_f32_16x16x32_bf16 v[40:43], a[32:35], a[72:75], v[40:43]
    ds_read_b64_tr_b16 a[8:9], v142 offset:8192
    v_mfma_f32_16x16x32_bf16 v[44:47], a[32:35], a[76:79], v[44:47]
    ds_write_b32 v147, v153 offset:256
    v_mfma_f32_16x16x32_bf16 v[100:103], a[32:35], v[120:123], v[100:103]
    ds_read_b64_tr_b16 a[10:11], v142 offset:9216
    v_mfma_f32_16x16x32_bf16 v[60:63], a[36:39], a[76:79], v[60:63]
    ds_read_b64_tr_b16 a[12:13], v143 offset:8192
    v_mfma_f32_16x16x32_bf16 v[56:59], a[36:39], a[72:75], v[56:59]
    ds_read_b64_tr_b16 a[14:15], v143 offset:9216
    v_mfma_f32_16x16x32_bf16 v[52:55], a[36:39], a[68:71], v[52:55]
    v_mfma_f32_16x16x32_bf16 v[48:51], a[36:39], a[64:67], v[48:51]
    ds_read_b64_tr_b16 a[16:17], v142 offset:16384
    v_mfma_f32_16x16x32_bf16 v[64:67], a[64:67], a[40:43], v[64:67]
    ds_read_b64_tr_b16 a[18:19], v142 offset:17408
    v_mfma_f32_16x16x32_bf16 v[68:71], a[68:71], a[40:43], v[68:71]
    ds_read_b64_tr_b16 a[20:21], v143 offset:16384
    v_mfma_f32_16x16x32_bf16 v[72:75], a[72:75], a[40:43], v[72:75]
    ds_read_b64_tr_b16 a[22:23], v143 offset:17408
    v_mfma_f32_16x16x32_bf16 v[76:79], a[76:79], a[40:43], v[76:79]
    v_mfma_f32_16x16x32_bf16 v[104:107], v[120:123], a[40:43], v[104:107]
    v_mfma_f32_16x16x32_bf16 v[92:95], a[76:79], a[44:47], v[92:95]
    v_mfma_f32_16x16x32_bf16 v[88:91], a[72:75], a[44:47], v[88:91]
    v_mfma_f32_16x16x32_bf16 v[84:87], a[68:71], a[44:47], v[84:87]
    v_mfma_f32_16x16x32_bf16 v[80:83], a[64:67], a[44:47], v[80:83]
    s_waitcnt lgkmcnt(0)
    v_mfma_f32_16x16x32_bf16 v[0:3], a[0:3], a[48:51], v[0:3]
    ds_read_b64_tr_b16 a[24:25], v142 offset:4096
    ds_read2_b32 v[156:157], v148 offset0:0 offset1:64
    v_mfma_f32_16x16x32_bf16 v[4:7], a[0:3], a[52:55], v[4:7]
    s_lshl_b32 s3, s2, 2
    v_mfma_f32_16x16x32_bf16 v[8:11], a[0:3], a[56:59], v[8:11]
    ds_read_b64_tr_b16 a[26:27], v142 offset:5120
    v_mfma_f32_16x16x32_bf16 v[12:15], a[0:3], a[60:63], v[12:15]
    ds_read_b128 a[64:67], v135 offset:0
    s_add_u32 s3, s3, s21
    v_mfma_f32_16x16x32_bf16 v[96:99], a[0:3], v[120:123], v[96:99]
    ds_read_b128 a[68:71], v135 offset:2048
    v_mfma_f32_16x16x32_bf16 v[28:31], a[4:7], a[60:63], v[28:31]
    ds_read_b128 a[72:75], v135 offset:4096
    v_mfma_f32_16x16x32_bf16 v[24:27], a[4:7], a[56:59], v[24:27]
    ds_read2_b32 v[158:159], v148 offset0:16 offset1:80
    v_mfma_f32_16x16x32_bf16 v[20:23], a[4:7], a[52:55], v[20:23]
    s_lshl_b32 s3, s3, 11
    ds_read_b128 a[76:79], v135 offset:6144
    v_mfma_f32_16x16x32_bf16 v[16:19], a[4:7], a[48:51], v[16:19]
    ds_read_b64_tr_b16 a[28:29], v143 offset:4096
    v_mfma_f32_16x16x32_bf16 v[32:35], a[8:11], a[48:51], v[32:35]
    s_mov_b32 s12, s52
    v_mfma_f32_16x16x32_bf16 v[36:39], a[8:11], a[52:55], v[36:39]
    ds_read_b64_tr_b16 a[30:31], v143 offset:5120
    v_mfma_f32_16x16x32_bf16 v[40:43], a[8:11], a[56:59], v[40:43]
    ds_read_b64_tr_b16 a[32:33], v142 offset:12288
    ds_read2_b32 v[160:161], v148 offset0:32 offset1:96
    v_mfma_f32_16x16x32_bf16 v[44:47], a[8:11], a[60:63], v[44:47]
    s_mov_b32 s13, s53
    v_mfma_f32_16x16x32_bf16 v[100:103], a[8:11], v[120:123], v[100:103]
    ds_read_b64_tr_b16 a[34:35], v142 offset:13312
    v_mfma_f32_16x16x32_bf16 v[60:63], a[12:15], a[60:63], v[60:63]
    ds_read_b64_tr_b16 a[36:37], v143 offset:12288
    s_mov_b32 s14, 0x200000
    v_mfma_f32_16x16x32_bf16 v[56:59], a[12:15], a[56:59], v[56:59]
    ds_read_b64_tr_b16 a[38:39], v143 offset:13312
    v_mfma_f32_16x16x32_bf16 v[52:55], a[12:15], a[52:55], v[52:55]
    ds_read_b64_tr_b16 a[40:41], v142 offset:20480
    v_mfma_f32_16x16x32_bf16 v[48:51], a[12:15], a[48:51], v[48:51]
    ds_read2_b32 v[162:163], v148 offset0:48 offset1:112
    v_mfma_f32_16x16x32_bf16 v[64:67], a[48:51], a[16:19], v[64:67]
    buffer_load_dwordx4 v[216:219], v241, s[12:15], s3 offen
    ds_read_b64_tr_b16 a[42:43], v142 offset:21504
    v_mfma_f32_16x16x32_bf16 v[68:71], a[52:55], a[16:19], v[68:71]
    ds_read_b64_tr_b16 a[44:45], v143 offset:20480
    v_mfma_f32_16x16x32_bf16 v[72:75], a[56:59], a[16:19], v[72:75]
    buffer_load_dwordx4 v[220:223], v241, s[12:15], s3 offen offset:1024
    v_mfma_f32_16x16x32_bf16 v[76:79], a[60:63], a[16:19], v[76:79]
    ds_read_b64_tr_b16 a[46:47], v143 offset:21504
    v_mfma_f32_16x16x32_bf16 v[104:107], v[120:123], a[16:19], v[104:107]
    v_mfma_f32_16x16x32_bf16 v[92:95], a[60:63], a[20:23], v[92:95]
    v_mfma_f32_16x16x32_bf16 v[88:91], a[56:59], a[20:23], v[88:91]
    v_mfma_f32_16x16x32_bf16 v[84:87], a[52:55], a[20:23], v[84:87]
    v_mfma_f32_16x16x32_bf16 v[80:83], a[48:51], a[20:23], v[80:83]
    s_waitcnt vmcnt(2) lgkmcnt(0)
    s_barrier
    v_mfma_f32_16x16x32_bf16 v[0:3], a[24:27], a[64:67], v[0:3]
    ds_read_b64_tr_b16 a[0:1], v138 offset:0
    v_mfma_f32_16x16x32_bf16 v[4:7], a[24:27], a[68:71], v[4:7]
    ds_read_b128 v[164:167], v149 offset:0
    v_mfma_f32_16x16x32_bf16 v[8:11], a[24:27], a[72:75], v[8:11]
    ds_read_b64_tr_b16 a[2:3], v138 offset:1024
    v_mfma_f32_16x16x32_bf16 v[12:15], a[24:27], a[76:79], v[12:15]
    ds_read_b128 a[48:51], v130 offset:0
    v_mfma_f32_16x16x32_bf16 v[96:99], a[24:27], v[120:123], v[96:99]
    ds_read_b128 a[52:55], v130 offset:2048
    v_mfma_f32_16x16x32_bf16 v[28:31], a[28:31], a[76:79], v[28:31]
    ds_read_b128 a[56:59], v130 offset:4096
    v_mfma_f32_16x16x32_bf16 v[24:27], a[28:31], a[72:75], v[24:27]
    ds_read_b128 v[168:171], v149 offset:64
    v_mfma_f32_16x16x32_bf16 v[20:23], a[28:31], a[68:71], v[20:23]
    ds_read_b128 a[60:63], v130 offset:6144
    v_mfma_f32_16x16x32_bf16 v[16:19], a[28:31], a[64:67], v[16:19]
    ds_read_b64_tr_b16 a[4:5], v139 offset:0
    v_mfma_f32_16x16x32_bf16 v[32:35], a[32:35], a[64:67], v[32:35]
    ds_read_b64_tr_b16 a[6:7], v139 offset:1024
    v_mfma_f32_16x16x32_bf16 v[36:39], a[32:35], a[68:71], v[36:39]
    v_mfma_f32_16x16x32_bf16 v[40:43], a[32:35], a[72:75], v[40:43]
    ds_read_b64_tr_b16 a[8:9], v138 offset:8192
    v_mfma_f32_16x16x32_bf16 v[44:47], a[32:35], a[76:79], v[44:47]
    ds_read_b128 v[172:175], v149 offset:128
    v_mfma_f32_16x16x32_bf16 v[100:103], a[32:35], v[120:123], v[100:103]
    ds_read_b64_tr_b16 a[10:11], v138 offset:9216
    v_mfma_f32_16x16x32_bf16 v[60:63], a[36:39], a[76:79], v[60:63]
    ds_read_b64_tr_b16 a[12:13], v139 offset:8192
    v_mfma_f32_16x16x32_bf16 v[56:59], a[36:39], a[72:75], v[56:59]
    ds_read_b64_tr_b16 a[14:15], v139 offset:9216
    v_mfma_f32_16x16x32_bf16 v[52:55], a[36:39], a[68:71], v[52:55]
    ds_read_b64_tr_b16 a[16:17], v138 offset:16384
    v_mfma_f32_16x16x32_bf16 v[48:51], a[36:39], a[64:67], v[48:51]
    ds_read_b128 v[176:179], v149 offset:192
    v_mfma_f32_16x16x32_bf16 v[64:67], a[64:67], a[40:43], v[64:67]
    ds_read_b64_tr_b16 a[18:19], v138 offset:17408
    v_mfma_f32_16x16x32_bf16 v[68:71], a[68:71], a[40:43], v[68:71]
    ds_read_b64_tr_b16 a[20:21], v139 offset:16384
    v_mfma_f32_16x16x32_bf16 v[72:75], a[72:75], a[40:43], v[72:75]
    ds_read_b64_tr_b16 a[22:23], v139 offset:17408
    v_mfma_f32_16x16x32_bf16 v[76:79], a[76:79], a[40:43], v[76:79]
    v_mfma_f32_16x16x32_bf16 v[104:107], v[120:123], a[40:43], v[104:107]
    v_mfma_f32_16x16x32_bf16 v[92:95], a[76:79], a[44:47], v[92:95]
    v_mfma_f32_16x16x32_bf16 v[88:91], a[72:75], a[44:47], v[88:91]
    v_mfma_f32_16x16x32_bf16 v[84:87], a[68:71], a[44:47], v[84:87]
    v_mfma_f32_16x16x32_bf16 v[80:83], a[64:67], a[44:47], v[80:83]
    s_waitcnt lgkmcnt(0)
    v_mfma_f32_16x16x32_bf16 v[0:3], a[0:3], a[48:51], v[0:3]
    ds_read_b64_tr_b16 a[24:25], v138 offset:4096
    v_mfma_f32_16x16x32_bf16 v[4:7], a[0:3], a[52:55], v[4:7]
    ds_read_b128 v[180:183], v149 offset:256
    v_mfma_f32_16x16x32_bf16 v[8:11], a[0:3], a[56:59], v[8:11]
    ds_read_b64_tr_b16 a[26:27], v138 offset:5120
    v_mfma_f32_16x16x32_bf16 v[12:15], a[0:3], a[60:63], v[12:15]
    ds_read_b128 a[64:67], v131 offset:0
    v_mfma_f32_16x16x32_bf16 v[96:99], a[0:3], v[120:123], v[96:99]
    ds_read_b128 a[68:71], v131 offset:2048
    v_mfma_f32_16x16x32_bf16 v[28:31], a[4:7], a[60:63], v[28:31]
    ds_read_b128 a[72:75], v131 offset:4096
    v_mfma_f32_16x16x32_bf16 v[24:27], a[4:7], a[56:59], v[24:27]
    ds_read_b128 v[184:187], v149 offset:320
    v_mfma_f32_16x16x32_bf16 v[20:23], a[4:7], a[52:55], v[20:23]
    ds_read_b128 a[76:79], v131 offset:6144
    v_mfma_f32_16x16x32_bf16 v[16:19], a[4:7], a[48:51], v[16:19]
    ds_read_b64_tr_b16 a[28:29], v139 offset:4096
    v_mfma_f32_16x16x32_bf16 v[32:35], a[8:11], a[48:51], v[32:35]
    ds_read_b64_tr_b16 a[30:31], v139 offset:5120
    v_mfma_f32_16x16x32_bf16 v[36:39], a[8:11], a[52:55], v[36:39]
    v_mfma_f32_16x16x32_bf16 v[40:43], a[8:11], a[56:59], v[40:43]
    ds_read_b64_tr_b16 a[32:33], v138 offset:12288
    v_mfma_f32_16x16x32_bf16 v[44:47], a[8:11], a[60:63], v[44:47]
    ds_read_b128 v[188:191], v149 offset:384
    v_mfma_f32_16x16x32_bf16 v[100:103], a[8:11], v[120:123], v[100:103]
    ds_read_b64_tr_b16 a[34:35], v138 offset:13312
    v_mfma_f32_16x16x32_bf16 v[60:63], a[12:15], a[60:63], v[60:63]
    ds_read_b64_tr_b16 a[36:37], v139 offset:12288
    v_mfma_f32_16x16x32_bf16 v[56:59], a[12:15], a[56:59], v[56:59]
    ds_read_b64_tr_b16 a[38:39], v139 offset:13312
    v_mfma_f32_16x16x32_bf16 v[52:55], a[12:15], a[52:55], v[52:55]
    ds_read_b64_tr_b16 a[40:41], v138 offset:20480
    v_mfma_f32_16x16x32_bf16 v[48:51], a[12:15], a[48:51], v[48:51]
    ds_read_b128 v[192:195], v149 offset:448
    v_mfma_f32_16x16x32_bf16 v[64:67], a[48:51], a[16:19], v[64:67]
    ds_read_b64_tr_b16 a[42:43], v138 offset:21504
    v_mfma_f32_16x16x32_bf16 v[68:71], a[52:55], a[16:19], v[68:71]
    ds_read_b64_tr_b16 a[44:45], v139 offset:20480
    v_mfma_f32_16x16x32_bf16 v[72:75], a[56:59], a[16:19], v[72:75]
    ds_read_b64_tr_b16 a[46:47], v139 offset:21504
    v_mfma_f32_16x16x32_bf16 v[76:79], a[60:63], a[16:19], v[76:79]
    v_mfma_f32_16x16x32_bf16 v[104:107], v[120:123], a[16:19], v[104:107]
    v_mfma_f32_16x16x32_bf16 v[92:95], a[60:63], a[20:23], v[92:95]
    v_mfma_f32_16x16x32_bf16 v[88:91], a[56:59], a[20:23], v[88:91]
    v_mfma_f32_16x16x32_bf16 v[84:87], a[52:55], a[20:23], v[84:87]
    v_mfma_f32_16x16x32_bf16 v[80:83], a[48:51], a[20:23], v[80:83]
    s_waitcnt lgkmcnt(0)
    v_mfma_f32_16x16x32_bf16 v[0:3], a[24:27], a[64:67], v[0:3]
    v_mfma_f32_16x16x32_bf16 v[4:7], a[24:27], a[68:71], v[4:7]
    v_mfma_f32_16x16x32_bf16 v[8:11], a[24:27], a[72:75], v[8:11]
    v_mfma_f32_16x16x32_bf16 v[12:15], a[24:27], a[76:79], v[12:15]
    v_mfma_f32_16x16x32_bf16 v[96:99], a[24:27], v[120:123], v[96:99]
    v_mfma_f32_16x16x32_bf16 v[28:31], a[28:31], a[76:79], v[28:31]
    v_mfma_f32_16x16x32_bf16 v[24:27], a[28:31], a[72:75], v[24:27]
    v_mfma_f32_16x16x32_bf16 v[20:23], a[28:31], a[68:71], v[20:23]
    v_mfma_f32_16x16x32_bf16 v[16:19], a[28:31], a[64:67], v[16:19]
    v_mfma_f32_16x16x32_bf16 v[32:35], a[32:35], a[64:67], v[32:35]
    v_mfma_f32_16x16x32_bf16 v[36:39], a[32:35], a[68:71], v[36:39]
    v_mfma_f32_16x16x32_bf16 v[40:43], a[32:35], a[72:75], v[40:43]
    v_mfma_f32_16x16x32_bf16 v[44:47], a[32:35], a[76:79], v[44:47]
    v_mfma_f32_16x16x32_bf16 v[100:103], a[32:35], v[120:123], v[100:103]
    v_mfma_f32_16x16x32_bf16 v[60:63], a[36:39], a[76:79], v[60:63]
    v_mfma_f32_16x16x32_bf16 v[56:59], a[36:39], a[72:75], v[56:59]
    v_mfma_f32_16x16x32_bf16 v[52:55], a[36:39], a[68:71], v[52:55]
    v_mfma_f32_16x16x32_bf16 v[48:51], a[36:39], a[64:67], v[48:51]
    v_mfma_f32_16x16x32_bf16 v[64:67], a[64:67], a[40:43], v[64:67]
    v_mfma_f32_16x16x32_bf16 v[68:71], a[68:71], a[40:43], v[68:71]
    v_mfma_f32_16x16x32_bf16 v[72:75], a[72:75], a[40:43], v[72:75]
    v_mfma_f32_16x16x32_bf16 v[76:79], a[76:79], a[40:43], v[76:79]
    v_mfma_f32_16x16x32_bf16 v[104:107], v[120:123], a[40:43], v[104:107]
    v_mfma_f32_16x16x32_bf16 v[92:95], a[76:79], a[44:47], v[92:95]
    v_mfma_f32_16x16x32_bf16 v[88:91], a[72:75], a[44:47], v[88:91]
    v_mfma_f32_16x16x32_bf16 v[84:87], a[68:71], a[44:47], v[84:87]
    v_mfma_f32_16x16x32_bf16 v[80:83], a[64:67], a[44:47], v[80:83]
    v_lshl_add_u32 v228, v240, 4, 0
    s_lshl_b32 s3, s21, 12
    s_add_u32 s3, s3, 123904
    v_add_u32 v229, s3, v228
    s_xor_b32 s3, s21, 2
    s_lshl_b32 s3, s3, 12
    s_add_u32 s3, s3, 123904
    v_add_u32 v230, s3, v228
    ds_write_b128 v229, v[96:99] offset:0
    ds_write_b128 v229, v[100:103] offset:1024
    ds_write_b128 v229, v[104:107] offset:2048
    v_mul_f32 v224, 0x3e8293ee, v157
    v_mul_f32 v225, 0x3e8293ee, v159
    v_mul_f32 v226, 0x3e8293ee, v161
    v_mul_f32 v227, 0x3e8293ee, v163
    s_lshl_b32 s3, s35, 18
    s_add_u32 s35, s3, 8388608
    s_lshl_b32 s3, s33, 13
    s_add_u32 s35, s35, s3
    s_lshl_b32 s28, s22, 14
    s_add_u32 s24, s35, s28
    v_add_u32 v242, 4096, v241
    s_waitcnt lgkmcnt(0)
    s_barrier
    ds_read_b128 v[108:111], v230 offset:0
    ds_read_b128 v[112:115], v230 offset:1024
    ds_read_b128 v[116:119], v230 offset:2048
    v_pk_fma_f32 v[32:33], v[100:101], v[156:157], v[32:33] op_sel:[0,0,0] op_sel_hi:[1,0,1] neg_lo:[0,1,0] neg_hi:[0,1,0]
    v_pk_fma_f32 v[34:35], v[102:103], v[156:157], v[34:35] op_sel:[0,0,0] op_sel_hi:[1,0,1] neg_lo:[0,1,0] neg_hi:[0,1,0]
    v_pk_mul_f32 v[32:33], v[32:33], v[156:157] op_sel:[0,1] op_sel_hi:[1,1]
    v_pk_mul_f32 v[34:35], v[34:35], v[156:157] op_sel:[0,1] op_sel_hi:[1,1]
    v_pk_fma_f32 v[64:65], v[164:165], v[104:105], v[64:65] op_sel:[0,0,0] op_sel_hi:[1,0,1] neg_lo:[0,1,0] neg_hi:[0,1,0]
    v_pk_fma_f32 v[66:67], v[166:167], v[104:105], v[66:67] op_sel:[0,0,0] op_sel_hi:[1,0,1] neg_lo:[0,1,0] neg_hi:[0,1,0]
    v_pk_mul_f32 v[64:65], v[64:65], v[180:181]
    v_pk_mul_f32 v[66:67], v[66:67], v[182:183]
    v_pk_fma_f32 v[36:37], v[100:101], v[158:159], v[36:37] op_sel:[0,0,0] op_sel_hi:[1,0,1] neg_lo:[0,1,0] neg_hi:[0,1,0]
    v_pk_fma_f32 v[38:39], v[102:103], v[158:159], v[38:39] op_sel:[0,0,0] op_sel_hi:[1,0,1] neg_lo:[0,1,0] neg_hi:[0,1,0]
    v_pk_mul_f32 v[36:37], v[36:37], v[158:159] op_sel:[0,1] op_sel_hi:[1,1]
    v_pk_mul_f32 v[38:39], v[38:39], v[158:159] op_sel:[0,1] op_sel_hi:[1,1]
    v_pk_fma_f32 v[68:69], v[168:169], v[104:105], v[68:69] op_sel:[0,0,0] op_sel_hi:[1,0,1] neg_lo:[0,1,0] neg_hi:[0,1,0]
    v_pk_fma_f32 v[70:71], v[170:171], v[104:105], v[70:71] op_sel:[0,0,0] op_sel_hi:[1,0,1] neg_lo:[0,1,0] neg_hi:[0,1,0]
    v_pk_mul_f32 v[68:69], v[68:69], v[184:185]
    v_pk_mul_f32 v[70:71], v[70:71], v[186:187]
    v_pk_fma_f32 v[40:41], v[100:101], v[160:161], v[40:41] op_sel:[0,0,0] op_sel_hi:[1,0,1] neg_lo:[0,1,0] neg_hi:[0,1,0]
    v_pk_fma_f32 v[42:43], v[102:103], v[160:161], v[42:43] op_sel:[0,0,0] op_sel_hi:[1,0,1] neg_lo:[0,1,0] neg_hi:[0,1,0]
    v_pk_mul_f32 v[40:41], v[40:41], v[160:161] op_sel:[0,1] op_sel_hi:[1,1]
    v_pk_mul_f32 v[42:43], v[42:43], v[160:161] op_sel:[0,1] op_sel_hi:[1,1]
    v_pk_fma_f32 v[72:73], v[172:173], v[104:105], v[72:73] op_sel:[0,0,0] op_sel_hi:[1,0,1] neg_lo:[0,1,0] neg_hi:[0,1,0]
    v_pk_fma_f32 v[74:75], v[174:175], v[104:105], v[74:75] op_sel:[0,0,0] op_sel_hi:[1,0,1] neg_lo:[0,1,0] neg_hi:[0,1,0]
    v_pk_mul_f32 v[72:73], v[72:73], v[188:189]
    v_pk_mul_f32 v[74:75], v[74:75], v[190:191]
    v_pk_fma_f32 v[44:45], v[100:101], v[162:163], v[44:45] op_sel:[0,0,0] op_sel_hi:[1,0,1] neg_lo:[0,1,0] neg_hi:[0,1,0]
    v_pk_fma_f32 v[46:47], v[102:103], v[162:163], v[46:47] op_sel:[0,0,0] op_sel_hi:[1,0,1] neg_lo:[0,1,0] neg_hi:[0,1,0]
    v_pk_mul_f32 v[44:45], v[44:45], v[162:163] op_sel:[0,1] op_sel_hi:[1,1]
    v_pk_mul_f32 v[46:47], v[46:47], v[162:163] op_sel:[0,1] op_sel_hi:[1,1]
    v_pk_fma_f32 v[76:77], v[176:177], v[104:105], v[76:77] op_sel:[0,0,0] op_sel_hi:[1,0,1] neg_lo:[0,1,0] neg_hi:[0,1,0]
    v_pk_fma_f32 v[78:79], v[178:179], v[104:105], v[78:79] op_sel:[0,0,0] op_sel_hi:[1,0,1] neg_lo:[0,1,0] neg_hi:[0,1,0]
    v_pk_mul_f32 v[76:77], v[76:77], v[192:193]
    v_pk_mul_f32 v[78:79], v[78:79], v[194:195]
    s_waitcnt lgkmcnt(0)
    v_pk_fma_f32 v[48:49], v[112:113], v[156:157], v[48:49] op_sel:[0,0,0] op_sel_hi:[1,0,1] neg_lo:[0,1,0] neg_hi:[0,1,0]
    v_pk_fma_f32 v[50:51], v[114:115], v[156:157], v[50:51] op_sel:[0,0,0] op_sel_hi:[1,0,1] neg_lo:[0,1,0] neg_hi:[0,1,0]
    v_pk_mul_f32 v[48:49], v[48:49], v[156:157] op_sel:[0,1] op_sel_hi:[1,1]
    v_pk_mul_f32 v[50:51], v[50:51], v[156:157] op_sel:[0,1] op_sel_hi:[1,1]
    v_cvt_pk_bf16_f32 v32, v32, v33
    v_cvt_pk_bf16_f32 v33, v34, v35
    v_cvt_pk_bf16_f32 v34, v48, v49
    v_cvt_pk_bf16_f32 v35, v50, v51
    v_pk_fma_f32 v[80:81], v[164:165], v[116:117], v[80:81] op_sel:[0,0,0] op_sel_hi:[1,0,1] neg_lo:[0,1,0] neg_hi:[0,1,0]
    v_pk_fma_f32 v[82:83], v[166:167], v[116:117], v[82:83] op_sel:[0,0,0] op_sel_hi:[1,0,1] neg_lo:[0,1,0] neg_hi:[0,1,0]
    v_pk_mul_f32 v[80:81], v[80:81], v[180:181]
    v_pk_mul_f32 v[82:83], v[82:83], v[182:183]
    v_cvt_pk_bf16_f32 v64, v64, v65
    v_cvt_pk_bf16_f32 v65, v66, v67
    v_cvt_pk_bf16_f32 v66, v80, v81
    v_cvt_pk_bf16_f32 v67, v82, v83
    v_pk_fma_f32 v[52:53], v[112:113], v[158:159], v[52:53] op_sel:[0,0,0] op_sel_hi:[1,0,1] neg_lo:[0,1,0] neg_hi:[0,1,0]
    v_pk_fma_f32 v[54:55], v[114:115], v[158:159], v[54:55] op_sel:[0,0,0] op_sel_hi:[1,0,1] neg_lo:[0,1,0] neg_hi:[0,1,0]
    v_pk_mul_f32 v[52:53], v[52:53], v[158:159] op_sel:[0,1] op_sel_hi:[1,1]
    v_pk_mul_f32 v[54:55], v[54:55], v[158:159] op_sel:[0,1] op_sel_hi:[1,1]
    v_cvt_pk_bf16_f32 v36, v36, v37
    v_cvt_pk_bf16_f32 v37, v38, v39
    v_cvt_pk_bf16_f32 v38, v52, v53
    v_cvt_pk_bf16_f32 v39, v54, v55
    v_pk_fma_f32 v[84:85], v[168:169], v[116:117], v[84:85] op_sel:[0,0,0] op_sel_hi:[1,0,1] neg_lo:[0,1,0] neg_hi:[0,1,0]
    v_pk_fma_f32 v[86:87], v[170:171], v[116:117], v[86:87] op_sel:[0,0,0] op_sel_hi:[1,0,1] neg_lo:[0,1,0] neg_hi:[0,1,0]
    v_pk_mul_f32 v[84:85], v[84:85], v[184:185]
    v_pk_mul_f32 v[86:87], v[86:87], v[186:187]
    v_cvt_pk_bf16_f32 v68, v68, v69
    v_cvt_pk_bf16_f32 v69, v70, v71
    v_cvt_pk_bf16_f32 v70, v84, v85
    v_cvt_pk_bf16_f32 v71, v86, v87
    v_pk_fma_f32 v[56:57], v[112:113], v[160:161], v[56:57] op_sel:[0,0,0] op_sel_hi:[1,0,1] neg_lo:[0,1,0] neg_hi:[0,1,0]
    v_pk_fma_f32 v[58:59], v[114:115], v[160:161], v[58:59] op_sel:[0,0,0] op_sel_hi:[1,0,1] neg_lo:[0,1,0] neg_hi:[0,1,0]
    v_pk_mul_f32 v[56:57], v[56:57], v[160:161] op_sel:[0,1] op_sel_hi:[1,1]
    v_pk_mul_f32 v[58:59], v[58:59], v[160:161] op_sel:[0,1] op_sel_hi:[1,1]
    v_cvt_pk_bf16_f32 v40, v40, v41
    v_cvt_pk_bf16_f32 v41, v42, v43
    v_cvt_pk_bf16_f32 v42, v56, v57
    v_cvt_pk_bf16_f32 v43, v58, v59
    v_pk_fma_f32 v[88:89], v[172:173], v[116:117], v[88:89] op_sel:[0,0,0] op_sel_hi:[1,0,1] neg_lo:[0,1,0] neg_hi:[0,1,0]
    v_pk_fma_f32 v[90:91], v[174:175], v[116:117], v[90:91] op_sel:[0,0,0] op_sel_hi:[1,0,1] neg_lo:[0,1,0] neg_hi:[0,1,0]
    v_pk_mul_f32 v[88:89], v[88:89], v[188:189]
    v_pk_mul_f32 v[90:91], v[90:91], v[190:191]
    v_cvt_pk_bf16_f32 v72, v72, v73
    v_cvt_pk_bf16_f32 v73, v74, v75
    v_cvt_pk_bf16_f32 v74, v88, v89
    v_cvt_pk_bf16_f32 v75, v90, v91
    v_pk_fma_f32 v[60:61], v[112:113], v[162:163], v[60:61] op_sel:[0,0,0] op_sel_hi:[1,0,1] neg_lo:[0,1,0] neg_hi:[0,1,0]
    v_pk_fma_f32 v[62:63], v[114:115], v[162:163], v[62:63] op_sel:[0,0,0] op_sel_hi:[1,0,1] neg_lo:[0,1,0] neg_hi:[0,1,0]
    v_pk_mul_f32 v[60:61], v[60:61], v[162:163] op_sel:[0,1] op_sel_hi:[1,1]
    v_pk_mul_f32 v[62:63], v[62:63], v[162:163] op_sel:[0,1] op_sel_hi:[1,1]
    v_cvt_pk_bf16_f32 v44, v44, v45
    v_cvt_pk_bf16_f32 v45, v46, v47
    v_cvt_pk_bf16_f32 v46, v60, v61
    v_cvt_pk_bf16_f32 v47, v62, v63
    v_pk_fma_f32 v[92:93], v[176:177], v[116:117], v[92:93] op_sel:[0,0,0] op_sel_hi:[1,0,1] neg_lo:[0,1,0] neg_hi:[0,1,0]
    v_pk_fma_f32 v[94:95], v[178:179], v[116:117], v[94:95] op_sel:[0,0,0] op_sel_hi:[1,0,1] neg_lo:[0,1,0] neg_hi:[0,1,0]
    v_pk_mul_f32 v[92:93], v[92:93], v[192:193]
    v_pk_mul_f32 v[94:95], v[94:95], v[194:195]
    v_cvt_pk_bf16_f32 v76, v76, v77
    v_cvt_pk_bf16_f32 v77, v78, v79
    v_cvt_pk_bf16_f32 v78, v92, v93
    v_cvt_pk_bf16_f32 v79, v94, v95
    s_cmp_eq_u32 s33, 0
    s_cbranch_scc1 unswap_kv
    v_swap_b32 v32, v34
    v_swap_b32 v33, v35
    v_swap_b32 v36, v38
    v_swap_b32 v37, v39
    v_swap_b32 v40, v42
    v_swap_b32 v41, v43
    v_swap_b32 v44, v46
    v_swap_b32 v45, v47
    v_swap_b32 v64, v66
    v_swap_b32 v65, v67
    v_swap_b32 v68, v70
    v_swap_b32 v69, v71
    v_swap_b32 v72, v74
    v_swap_b32 v73, v75
    v_swap_b32 v76, v78
    v_swap_b32 v77, v79
unswap_kv:
    s_nop 1
    v_permlane16_swap_b32 v32, v36
    v_permlane16_swap_b32 v33, v37
    v_permlane16_swap_b32 v34, v38
    v_permlane16_swap_b32 v35, v39
    buffer_store_dwordx4 v[32:35], v241, s[8:11], s24 offen offset:0 sc1
    buffer_store_dwordx4 v[36:39], v241, s[8:11], s24 offen offset:1024 sc1
    v_permlane16_swap_b32 v64, v66
    v_permlane16_swap_b32 v65, v67
    v_permlane16_swap_b32 v68, v70
    v_permlane16_swap_b32 v69, v71
    v_permlane32_swap_b32 v64, v66
    v_permlane32_swap_b32 v65, v67
    v_permlane32_swap_b32 v68, v70
    v_permlane32_swap_b32 v69, v71
    buffer_store_dwordx4 v[64:67], v241, s[8:11], s24 offen offset:2048 sc1
    buffer_store_dwordx4 v[68:71], v241, s[8:11], s24 offen offset:3072 sc1
    v_permlane16_swap_b32 v40, v44
    v_permlane16_swap_b32 v41, v45
    v_permlane16_swap_b32 v42, v46
    v_permlane16_swap_b32 v43, v47
    buffer_store_dwordx4 v[40:43], v242, s[8:11], s24 offen offset:0 sc1
    buffer_store_dwordx4 v[44:47], v242, s[8:11], s24 offen offset:1024 sc1
    v_permlane16_swap_b32 v72, v74
    v_permlane16_swap_b32 v73, v75
    v_permlane16_swap_b32 v76, v78
    v_permlane16_swap_b32 v77, v79
    v_permlane32_swap_b32 v72, v74
    v_permlane32_swap_b32 v73, v75
    v_permlane32_swap_b32 v76, v78
    v_permlane32_swap_b32 v77, v79
    buffer_store_dwordx4 v[72:75], v242, s[8:11], s24 offen offset:2048 sc1
    buffer_store_dwordx4 v[76:79], v242, s[8:11], s24 offen offset:3072 sc1
    s_waitcnt vmcnt(8)
    v_mov_b32 v232, 0
    v_dot2c_f32_bf16 v232, v216, v120
    v_dot2c_f32_bf16 v232, v217, v120
    v_dot2c_f32_bf16 v232, v218, v120
    v_dot2c_f32_bf16 v232, v219, v120
    v_dot2c_f32_bf16 v232, v220, v120
    v_dot2c_f32_bf16 v232, v221, v120
    v_dot2c_f32_bf16 v232, v222, v120
    v_dot2c_f32_bf16 v232, v223, v120
    s_nop 1
    s_nop 1
    v_add_f32_dpp v232, v232, v232 row_ror:8 row_mask:0xf bank_mask:0xf
    s_nop 1
    v_add_f32_dpp v232, v232, v232 row_ror:4 row_mask:0xf bank_mask:0xf
    s_nop 1
    v_add_f32_dpp v232, v232, v232 row_ror:2 row_mask:0xf bank_mask:0xf
    s_nop 1
    v_add_f32_dpp v232, v232, v232 row_ror:1 row_mask:0xf bank_mask:0xf
    v_mov_b32 v233, v232
    s_nop 1
    v_permlane16_swap_b32 v232, v233
    v_add_f32 v232, v232, v233
    v_mov_b32 v233, v232
    s_lshl_b32 s3, s2, 7
    s_lshl_b32 s4, s21, 3
    v_permlane32_swap_b32 v232, v233
    v_add_f32 v232, v232, v233
    v_mul_f32 v232, 0x3a800000, v232
    v_cvt_pk_bf16_f32 v233, v232, v232
    v_and_b32 v234, 0xffff0000, v233
    v_sub_f32 v234, v232, v234
    v_cvt_pk_bf16_f32 v232, v232, v234
    v_mov_b32 v233, v247
    s_add_u32 s3, s3, s4
    s_add_u32 s3, s3, 40239104
    buffer_store_dwordx2 v[232:233], v248, s[8:11], s3 offen sc1
    v_pk_fma_f32 v[0:1], v[96:97], v[156:157], v[0:1] op_sel:[0,0,0] op_sel_hi:[1,0,1] neg_lo:[0,1,0] neg_hi:[0,1,0]
    v_pk_fma_f32 v[2:3], v[98:99], v[156:157], v[2:3] op_sel:[0,0,0] op_sel_hi:[1,0,1] neg_lo:[0,1,0] neg_hi:[0,1,0]
    v_pk_mul_f32 v[0:1], v[0:1], v[224:225] op_sel:[0,0] op_sel_hi:[1,0]
    v_pk_mul_f32 v[2:3], v[2:3], v[224:225] op_sel:[0,0] op_sel_hi:[1,0]
    v_pk_fma_f32 v[16:17], v[108:109], v[156:157], v[16:17] op_sel:[0,0,0] op_sel_hi:[1,0,1] neg_lo:[0,1,0] neg_hi:[0,1,0]
    v_pk_fma_f32 v[18:19], v[110:111], v[156:157], v[18:19] op_sel:[0,0,0] op_sel_hi:[1,0,1] neg_lo:[0,1,0] neg_hi:[0,1,0]
    v_pk_mul_f32 v[16:17], v[16:17], v[224:225] op_sel:[0,0] op_sel_hi:[1,0]
    v_pk_mul_f32 v[18:19], v[18:19], v[224:225] op_sel:[0,0] op_sel_hi:[1,0]
    v_cvt_pk_bf16_f32 v0, v0, v1
    v_cvt_pk_bf16_f32 v1, v2, v3
    v_cvt_pk_bf16_f32 v2, v16, v17
    v_cvt_pk_bf16_f32 v3, v18, v19
    v_pk_fma_f32 v[4:5], v[96:97], v[158:159], v[4:5] op_sel:[0,0,0] op_sel_hi:[1,0,1] neg_lo:[0,1,0] neg_hi:[0,1,0]
    v_pk_fma_f32 v[6:7], v[98:99], v[158:159], v[6:7] op_sel:[0,0,0] op_sel_hi:[1,0,1] neg_lo:[0,1,0] neg_hi:[0,1,0]
    v_pk_mul_f32 v[4:5], v[4:5], v[224:225] op_sel:[0,1] op_sel_hi:[1,1]
    v_pk_mul_f32 v[6:7], v[6:7], v[224:225] op_sel:[0,1] op_sel_hi:[1,1]
    v_pk_fma_f32 v[20:21], v[108:109], v[158:159], v[20:21] op_sel:[0,0,0] op_sel_hi:[1,0,1] neg_lo:[0,1,0] neg_hi:[0,1,0]
    v_pk_fma_f32 v[22:23], v[110:111], v[158:159], v[22:23] op_sel:[0,0,0] op_sel_hi:[1,0,1] neg_lo:[0,1,0] neg_hi:[0,1,0]
    v_pk_mul_f32 v[20:21], v[20:21], v[224:225] op_sel:[0,1] op_sel_hi:[1,1]
    v_pk_mul_f32 v[22:23], v[22:23], v[224:225] op_sel:[0,1] op_sel_hi:[1,1]
    v_cvt_pk_bf16_f32 v4, v4, v5
    v_cvt_pk_bf16_f32 v5, v6, v7
    v_cvt_pk_bf16_f32 v6, v20, v21
    v_cvt_pk_bf16_f32 v7, v22, v23
    v_pk_fma_f32 v[8:9], v[96:97], v[160:161], v[8:9] op_sel:[0,0,0] op_sel_hi:[1,0,1] neg_lo:[0,1,0] neg_hi:[0,1,0]
    v_pk_fma_f32 v[10:11], v[98:99], v[160:161], v[10:11] op_sel:[0,0,0] op_sel_hi:[1,0,1] neg_lo:[0,1,0] neg_hi:[0,1,0]
    v_pk_mul_f32 v[8:9], v[8:9], v[226:227] op_sel:[0,0] op_sel_hi:[1,0]
    v_pk_mul_f32 v[10:11], v[10:11], v[226:227] op_sel:[0,0] op_sel_hi:[1,0]
    v_pk_fma_f32 v[24:25], v[108:109], v[160:161], v[24:25] op_sel:[0,0,0] op_sel_hi:[1,0,1] neg_lo:[0,1,0] neg_hi:[0,1,0]
    v_pk_fma_f32 v[26:27], v[110:111], v[160:161], v[26:27] op_sel:[0,0,0] op_sel_hi:[1,0,1] neg_lo:[0,1,0] neg_hi:[0,1,0]
    v_pk_mul_f32 v[24:25], v[24:25], v[226:227] op_sel:[0,0] op_sel_hi:[1,0]
    v_pk_mul_f32 v[26:27], v[26:27], v[226:227] op_sel:[0,0] op_sel_hi:[1,0]
    v_cvt_pk_bf16_f32 v8, v8, v9
    v_cvt_pk_bf16_f32 v9, v10, v11
    v_cvt_pk_bf16_f32 v10, v24, v25
    v_cvt_pk_bf16_f32 v11, v26, v27
    v_pk_fma_f32 v[12:13], v[96:97], v[162:163], v[12:13] op_sel:[0,0,0] op_sel_hi:[1,0,1] neg_lo:[0,1,0] neg_hi:[0,1,0]
    v_pk_fma_f32 v[14:15], v[98:99], v[162:163], v[14:15] op_sel:[0,0,0] op_sel_hi:[1,0,1] neg_lo:[0,1,0] neg_hi:[0,1,0]
    v_pk_mul_f32 v[12:13], v[12:13], v[226:227] op_sel:[0,1] op_sel_hi:[1,1]
    v_pk_mul_f32 v[14:15], v[14:15], v[226:227] op_sel:[0,1] op_sel_hi:[1,1]
    v_pk_fma_f32 v[28:29], v[108:109], v[162:163], v[28:29] op_sel:[0,0,0] op_sel_hi:[1,0,1] neg_lo:[0,1,0] neg_hi:[0,1,0]
    v_pk_fma_f32 v[30:31], v[110:111], v[162:163], v[30:31] op_sel:[0,0,0] op_sel_hi:[1,0,1] neg_lo:[0,1,0] neg_hi:[0,1,0]
    v_pk_mul_f32 v[28:29], v[28:29], v[226:227] op_sel:[0,1] op_sel_hi:[1,1]
    v_pk_mul_f32 v[30:31], v[30:31], v[226:227] op_sel:[0,1] op_sel_hi:[1,1]
    v_cvt_pk_bf16_f32 v12, v12, v13
    v_cvt_pk_bf16_f32 v13, v14, v15
    v_cvt_pk_bf16_f32 v14, v28, v29
    v_cvt_pk_bf16_f32 v15, v30, v31
    s_cmp_eq_u32 s33, 0
    s_cbranch_scc1 unswap_q
    v_swap_b32 v0, v2
    v_swap_b32 v1, v3
    v_swap_b32 v4, v6
    v_swap_b32 v5, v7
    v_swap_b32 v8, v10
    v_swap_b32 v9, v11
    v_swap_b32 v12, v14
    v_swap_b32 v13, v15
unswap_q:
    s_nop 1
    s_lshl_b32 s3, s21, 12
    s_add_u32 s3, s3, 40960
    v_add_u32 v228, s3, v241
    s_xor_b32 s3, s21, 2
    s_lshl_b32 s3, s3, 12
    s_add_u32 s3, s3, 40960
    v_add_u32 v229, s3, v241
    v_permlane16_swap_b32 v0, v4
    v_permlane16_swap_b32 v1, v5
    v_permlane16_swap_b32 v2, v6
    v_permlane16_swap_b32 v3, v7
    v_permlane16_swap_b32 v8, v12
    v_permlane16_swap_b32 v9, v13
    v_permlane16_swap_b32 v10, v14
    v_permlane16_swap_b32 v11, v15
    ds_write_b128 v228, v[0:3] offset:0
    ds_write_b128 v228, v[4:7] offset:1024
    ds_write_b128 v228, v[8:11] offset:2048
    ds_write_b128 v228, v[12:15] offset:3072
    v_accvgpr_write_b32 a0, v32
    v_accvgpr_write_b32 a8, v64
    v_accvgpr_write_b32 a1, v33
    v_accvgpr_write_b32 a9, v65
    v_accvgpr_write_b32 a2, v34
    v_accvgpr_write_b32 a10, v66
    v_accvgpr_write_b32 a3, v35
    v_accvgpr_write_b32 a11, v67
    v_accvgpr_write_b32 a4, v36
    v_accvgpr_write_b32 a12, v68
    v_accvgpr_write_b32 a5, v37
    v_accvgpr_write_b32 a13, v69
    v_accvgpr_write_b32 a6, v38
    v_accvgpr_write_b32 a14, v70
    v_accvgpr_write_b32 a7, v39
    v_accvgpr_write_b32 a15, v71
    v_accvgpr_write_b32 a16, v40
    v_accvgpr_write_b32 a24, v72
    v_accvgpr_write_b32 a17, v41
    v_accvgpr_write_b32 a25, v73
    v_accvgpr_write_b32 a18, v42
    v_accvgpr_write_b32 a26, v74
    v_accvgpr_write_b32 a19, v43
    v_accvgpr_write_b32 a27, v75
    v_accvgpr_write_b32 a20, v44
    v_accvgpr_write_b32 a28, v76
    v_accvgpr_write_b32 a21, v45
    v_accvgpr_write_b32 a29, v77
    v_accvgpr_write_b32 a22, v46
    v_accvgpr_write_b32 a30, v78
    v_accvgpr_write_b32 a23, v47
    v_accvgpr_write_b32 a31, v79
    v_accvgpr_write_b32 a64, v0
    v_accvgpr_write_b32 a65, v1
    v_accvgpr_write_b32 a66, v2
    v_accvgpr_write_b32 a67, v3
    v_accvgpr_write_b32 a68, v4
    v_accvgpr_write_b32 a69, v5
    v_accvgpr_write_b32 a70, v6
    v_accvgpr_write_b32 a71, v7
    v_accvgpr_write_b32 a72, v8
    v_accvgpr_write_b32 a73, v9
    v_accvgpr_write_b32 a74, v10
    v_accvgpr_write_b32 a75, v11
    v_accvgpr_write_b32 a76, v12
    v_accvgpr_write_b32 a77, v13
    v_accvgpr_write_b32 a78, v14
    v_accvgpr_write_b32 a79, v15
    s_waitcnt lgkmcnt(0)
    s_barrier
    ds_read_b128 a[80:83], v229 offset:0
    ds_read_b128 a[84:87], v229 offset:1024
    ds_read_b128 a[88:91], v229 offset:2048
    ds_read_b128 a[92:95], v229 offset:3072
    s_nop 1
    v_mfma_f32_32x32x16_bf16 v[112:127], a[0:3], a[64:67], 0
    v_mfma_f32_32x32x16_bf16 v[112:127], a[4:7], a[68:71], v[112:127]
    v_mfma_f32_32x32x16_bf16 v[128:143], a[0:3], a[72:75], 0
    v_mfma_f32_32x32x16_bf16 v[128:143], a[4:7], a[76:79], v[128:143]
    s_waitcnt lgkmcnt(0)
    v_mfma_f32_32x32x16_bf16 v[144:159], a[0:3], a[80:83], 0
    v_mfma_f32_32x32x16_bf16 v[144:159], a[4:7], a[84:87], v[144:159]
    v_mfma_f32_32x32x16_bf16 v[160:175], a[0:3], a[88:91], 0
    v_mfma_f32_32x32x16_bf16 v[160:175], a[4:7], a[92:95], v[160:175]
    s_nop 7
    v_max3_f32 v176, v112, v113, v114
    v_max_f32 v176, v176, v115
    v_max3_f32 v176, v116, v117, v176
    v_max3_f32 v176, v118, v119, v176
    v_max3_f32 v176, v120, v121, v176
    v_max3_f32 v176, v122, v123, v176
    v_max3_f32 v176, v124, v125, v176
    v_max3_f32 v176, v126, v127, v176
    v_max3_f32 v177, v128, v129, v130
    v_max_f32 v177, v177, v131
    v_max3_f32 v177, v132, v133, v177
    v_max3_f32 v177, v134, v135, v177
    v_max3_f32 v177, v136, v137, v177
    v_max3_f32 v177, v138, v139, v177
    v_max3_f32 v177, v140, v141, v177
    v_max3_f32 v177, v142, v143, v177
    v_max3_f32 v178, v144, v145, v146
    v_max_f32 v178, v178, v147
    v_max3_f32 v178, v148, v149, v178
    v_max3_f32 v178, v150, v151, v178
    v_max3_f32 v178, v152, v153, v178
    v_max3_f32 v178, v154, v155, v178
    v_max3_f32 v178, v156, v157, v178
    v_max3_f32 v178, v158, v159, v178
    v_max3_f32 v179, v160, v161, v162
    v_max_f32 v179, v179, v163
    v_max3_f32 v179, v164, v165, v179
    v_max3_f32 v179, v166, v167, v179
    v_max3_f32 v179, v168, v169, v179
    v_max3_f32 v179, v170, v171, v179
    v_max3_f32 v179, v172, v173, v179
    v_max3_f32 v179, v174, v175, v179
    v_mov_b32 v180, v176
    v_mov_b32 v181, v177
    v_mov_b32 v182, v178
    v_mov_b32 v183, v179
    s_nop 1
    v_permlane32_swap_b32 v176, v180
    v_permlane32_swap_b32 v177, v181
    v_permlane32_swap_b32 v178, v182
    v_permlane32_swap_b32 v179, v183
    v_max_f32 v176, v176, v180
    v_max_f32 v177, v177, v181
    v_max_f32 v178, v178, v182
    v_max_f32 v179, v179, v183
    v_pk_mul_f32 v[48:49], v[176:177], -1.0 op_sel:[0,0] op_sel_hi:[0,0]
    v_pk_mul_f32 v[50:51], v[176:177], -1.0 op_sel:[0,0] op_sel_hi:[0,0]
    v_pk_mul_f32 v[52:53], v[176:177], -1.0 op_sel:[0,0] op_sel_hi:[0,0]
    v_pk_mul_f32 v[54:55], v[176:177], -1.0 op_sel:[0,0] op_sel_hi:[0,0]
    v_pk_mul_f32 v[56:57], v[176:177], -1.0 op_sel:[0,0] op_sel_hi:[0,0]
    v_pk_mul_f32 v[58:59], v[176:177], -1.0 op_sel:[0,0] op_sel_hi:[0,0]
    v_pk_mul_f32 v[60:61], v[176:177], -1.0 op_sel:[0,0] op_sel_hi:[0,0]
    v_pk_mul_f32 v[62:63], v[176:177], -1.0 op_sel:[0,0] op_sel_hi:[0,0]
    v_pk_mul_f32 v[64:65], v[176:177], -1.0 op_sel:[1,0] op_sel_hi:[1,0]
    v_pk_mul_f32 v[66:67], v[176:177], -1.0 op_sel:[1,0] op_sel_hi:[1,0]
    v_pk_mul_f32 v[68:69], v[176:177], -1.0 op_sel:[1,0] op_sel_hi:[1,0]
    v_pk_mul_f32 v[70:71], v[176:177], -1.0 op_sel:[1,0] op_sel_hi:[1,0]
    v_pk_mul_f32 v[72:73], v[176:177], -1.0 op_sel:[1,0] op_sel_hi:[1,0]
    v_pk_mul_f32 v[74:75], v[176:177], -1.0 op_sel:[1,0] op_sel_hi:[1,0]
    v_pk_mul_f32 v[76:77], v[176:177], -1.0 op_sel:[1,0] op_sel_hi:[1,0]
    v_pk_mul_f32 v[78:79], v[176:177], -1.0 op_sel:[1,0] op_sel_hi:[1,0]
    v_pk_mul_f32 v[80:81], v[178:179], -1.0 op_sel:[0,0] op_sel_hi:[0,0]
    v_pk_mul_f32 v[82:83], v[178:179], -1.0 op_sel:[0,0] op_sel_hi:[0,0]
    v_pk_mul_f32 v[84:85], v[178:179], -1.0 op_sel:[0,0] op_sel_hi:[0,0]
    v_pk_mul_f32 v[86:87], v[178:179], -1.0 op_sel:[0,0] op_sel_hi:[0,0]
    v_pk_mul_f32 v[88:89], v[178:179], -1.0 op_sel:[0,0] op_sel_hi:[0,0]
    v_pk_mul_f32 v[90:91], v[178:179], -1.0 op_sel:[0,0] op_sel_hi:[0,0]
    v_pk_mul_f32 v[92:93], v[178:179], -1.0 op_sel:[0,0] op_sel_hi:[0,0]
    v_pk_mul_f32 v[94:95], v[178:179], -1.0 op_sel:[0,0] op_sel_hi:[0,0]
    v_pk_mul_f32 v[96:97], v[178:179], -1.0 op_sel:[1,0] op_sel_hi:[1,0]
    v_pk_mul_f32 v[98:99], v[178:179], -1.0 op_sel:[1,0] op_sel_hi:[1,0]
    v_pk_mul_f32 v[100:101], v[178:179], -1.0 op_sel:[1,0] op_sel_hi:[1,0]
    v_pk_mul_f32 v[102:103], v[178:179], -1.0 op_sel:[1,0] op_sel_hi:[1,0]
    v_pk_mul_f32 v[104:105], v[178:179], -1.0 op_sel:[1,0] op_sel_hi:[1,0]
    v_pk_mul_f32 v[106:107], v[178:179], -1.0 op_sel:[1,0] op_sel_hi:[1,0]
    v_pk_mul_f32 v[108:109], v[178:179], -1.0 op_sel:[1,0] op_sel_hi:[1,0]
    v_pk_mul_f32 v[110:111], v[178:179], -1.0 op_sel:[1,0] op_sel_hi:[1,0]
    s_nop 1
    v_mfma_f32_32x32x16_bf16 v[0:15], a[0:3], a[64:67], v[48:63]
    v_mfma_f32_32x32x16_bf16 v[0:15], a[4:7], a[68:71], v[0:15]
    s_lshl_b32 s32, s21, 11
    s_nop 9
    s_waitcnt vmcnt(0)
    s_barrier
    buffer_store_dword v247, v246, s[8:11], s7 offen sc1
    v_mfma_f32_32x32x16_bf16 v[16:31], a[0:3], a[72:75], v[64:79]
    v_exp_f32 v0, v0
    v_exp_f32 v1, v1
    v_exp_f32 v2, v2
    v_mfma_f32_32x32x16_bf16 v[16:31], a[4:7], a[76:79], v[16:31]
    v_exp_f32 v3, v3
    v_exp_f32 v4, v4
    v_exp_f32 v5, v5
    v_exp_f32 v6, v6
    v_exp_f32 v7, v7
    v_cvt_pk_bf16_f32 v32, v0, v1
    v_cvt_pk_bf16_f32 v33, v2, v3
    v_exp_f32 v8, v8
    v_exp_f32 v9, v9
    v_cvt_pk_bf16_f32 v34, v4, v5
    v_cvt_pk_bf16_f32 v35, v6, v7
    v_exp_f32 v10, v10
    v_exp_f32 v11, v11
    v_exp_f32 v12, v12
    v_exp_f32 v13, v13
    v_cvt_pk_bf16_f32 v36, v8, v9
    v_exp_f32 v14, v14
    v_cvt_pk_bf16_f32 v37, v10, v11
    v_exp_f32 v15, v15
    v_cvt_pk_bf16_f32 v38, v12, v13
    v_cvt_pk_bf16_f32 v39, v14, v15
    v_mfma_f32_32x32x16_bf16 v[0:15], a[0:3], a[80:83], v[80:95]
    v_exp_f32 v16, v16
    v_exp_f32 v17, v17
    v_exp_f32 v18, v18
    v_mfma_f32_32x32x16_bf16 v[0:15], a[4:7], a[84:87], v[0:15]
    v_exp_f32 v19, v19
    v_exp_f32 v20, v20
    v_exp_f32 v21, v21
    v_mfma_f32_32x32x16_bf16 v[112:127], a[8:11], v[32:35], 0
    v_exp_f32 v22, v22
    v_exp_f32 v23, v23
    v_cvt_pk_bf16_f32 v40, v16, v17
    v_cvt_pk_bf16_f32 v41, v18, v19
    v_mfma_f32_32x32x16_bf16 v[112:127], a[12:15], v[36:39], v[112:127]
    v_exp_f32 v24, v24
    v_exp_f32 v25, v25
    v_cvt_pk_bf16_f32 v42, v20, v21
    v_cvt_pk_bf16_f32 v43, v22, v23
    v_mfma_f32_16x16x32_bf16 a[96:99], a[112:115], v[32:35], 0
    v_exp_f32 v26, v26
    v_mfma_f32_16x16x32_bf16 a[96:99], a[112:115], v[36:39], a[96:99]
    v_exp_f32 v27, v27
    v_exp_f32 v28, v28
    v_exp_f32 v29, v29
    v_cvt_pk_bf16_f32 v44, v24, v25
    v_exp_f32 v30, v30
    v_cvt_pk_bf16_f32 v45, v26, v27
    v_exp_f32 v31, v31
    v_cvt_pk_bf16_f32 v46, v28, v29
    v_cvt_pk_bf16_f32 v47, v30, v31
    v_mfma_f32_32x32x16_bf16 v[16:31], a[0:3], a[88:91], v[96:111]
    v_exp_f32 v0, v0
    v_exp_f32 v1, v1
    v_exp_f32 v2, v2
    v_mfma_f32_32x32x16_bf16 v[16:31], a[4:7], a[92:95], v[16:31]
    v_exp_f32 v3, v3
    v_exp_f32 v4, v4
    v_exp_f32 v5, v5
    v_mfma_f32_32x32x16_bf16 v[128:143], a[8:11], v[40:43], 0
    v_exp_f32 v6, v6
    v_exp_f32 v7, v7
    v_cvt_pk_bf16_f32 v32, v0, v1
    v_cvt_pk_bf16_f32 v33, v2, v3
    v_mfma_f32_32x32x16_bf16 v[128:143], a[12:15], v[44:47], v[128:143]
    v_exp_f32 v8, v8
    v_exp_f32 v9, v9
    v_cvt_pk_bf16_f32 v34, v4, v5
    v_cvt_pk_bf16_f32 v35, v6, v7
    v_mfma_f32_16x16x32_bf16 a[100:103], a[112:115], v[40:43], 0
    v_exp_f32 v10, v10
    v_mfma_f32_16x16x32_bf16 a[100:103], a[112:115], v[44:47], a[100:103]
    v_exp_f32 v11, v11
    v_exp_f32 v12, v12
    v_exp_f32 v13, v13
    v_cvt_pk_bf16_f32 v36, v8, v9
    v_exp_f32 v14, v14
    v_cvt_pk_bf16_f32 v37, v10, v11
    v_exp_f32 v15, v15
    v_cvt_pk_bf16_f32 v38, v12, v13
    v_cvt_pk_bf16_f32 v39, v14, v15
    v_mfma_f32_32x32x16_bf16 v[0:15], a[16:19], a[64:67], v[48:63]
    v_exp_f32 v16, v16
    v_exp_f32 v17, v17
    v_exp_f32 v18, v18
    v_mfma_f32_32x32x16_bf16 v[0:15], a[20:23], a[68:71], v[0:15]
    v_exp_f32 v19, v19
    v_exp_f32 v20, v20
    v_exp_f32 v21, v21
    v_mfma_f32_32x32x16_bf16 v[144:159], a[8:11], v[32:35], 0
    v_exp_f32 v22, v22
    v_exp_f32 v23, v23
    v_cvt_pk_bf16_f32 v40, v16, v17
    v_cvt_pk_bf16_f32 v41, v18, v19
    v_mfma_f32_32x32x16_bf16 v[144:159], a[12:15], v[36:39], v[144:159]
    v_exp_f32 v24, v24
    v_exp_f32 v25, v25
    v_cvt_pk_bf16_f32 v42, v20, v21
    v_cvt_pk_bf16_f32 v43, v22, v23
    v_mfma_f32_16x16x32_bf16 a[104:107], a[112:115], v[32:35], 0
    v_exp_f32 v26, v26
    v_mfma_f32_16x16x32_bf16 a[104:107], a[112:115], v[36:39], a[104:107]
    v_exp_f32 v27, v27
    v_exp_f32 v28, v28
    v_exp_f32 v29, v29
    v_cvt_pk_bf16_f32 v44, v24, v25
    v_exp_f32 v30, v30
    v_cvt_pk_bf16_f32 v45, v26, v27
    v_exp_f32 v31, v31
    v_cvt_pk_bf16_f32 v46, v28, v29
    v_cvt_pk_bf16_f32 v47, v30, v31
    v_mfma_f32_32x32x16_bf16 v[16:31], a[16:19], a[72:75], v[64:79]
    buffer_load_dword v184, v245, s[8:11], s100 offen sc1
    v_exp_f32 v0, v0
    v_exp_f32 v1, v1
    v_exp_f32 v2, v2
    v_mfma_f32_32x32x16_bf16 v[16:31], a[20:23], a[76:79], v[16:31]
    v_exp_f32 v3, v3
    v_exp_f32 v4, v4
    v_exp_f32 v5, v5
    v_mfma_f32_32x32x16_bf16 v[160:175], a[8:11], v[40:43], 0
    v_exp_f32 v6, v6
    v_exp_f32 v7, v7
    v_cvt_pk_bf16_f32 v32, v0, v1
    v_cvt_pk_bf16_f32 v33, v2, v3
    v_mfma_f32_32x32x16_bf16 v[160:175], a[12:15], v[44:47], v[160:175]
    v_exp_f32 v8, v8
    v_exp_f32 v9, v9
    v_cvt_pk_bf16_f32 v34, v4, v5
    v_cvt_pk_bf16_f32 v35, v6, v7
    v_mfma_f32_16x16x32_bf16 a[108:111], a[112:115], v[40:43], 0
    v_exp_f32 v10, v10
    v_mfma_f32_16x16x32_bf16 a[108:111], a[112:115], v[44:47], a[108:111]
    v_exp_f32 v11, v11
    v_exp_f32 v12, v12
    v_exp_f32 v13, v13
    v_cvt_pk_bf16_f32 v36, v8, v9
    v_exp_f32 v14, v14
    v_cvt_pk_bf16_f32 v37, v10, v11
    v_exp_f32 v15, v15
    v_cvt_pk_bf16_f32 v38, v12, v13
    v_cvt_pk_bf16_f32 v39, v14, v15
    v_mfma_f32_32x32x16_bf16 v[0:15], a[16:19], a[80:83], v[80:95]
    v_exp_f32 v16, v16
    v_exp_f32 v17, v17
    v_exp_f32 v18, v18
    v_mfma_f32_32x32x16_bf16 v[0:15], a[20:23], a[84:87], v[0:15]
    v_exp_f32 v19, v19
    v_exp_f32 v20, v20
    v_exp_f32 v21, v21
    v_mfma_f32_32x32x16_bf16 v[112:127], a[24:27], v[32:35], v[112:127]
    v_exp_f32 v22, v22
    v_exp_f32 v23, v23
    v_cvt_pk_bf16_f32 v40, v16, v17
    v_cvt_pk_bf16_f32 v41, v18, v19
    v_mfma_f32_32x32x16_bf16 v[112:127], a[28:31], v[36:39], v[112:127]
    v_exp_f32 v24, v24
    v_exp_f32 v25, v25
    v_cvt_pk_bf16_f32 v42, v20, v21
    v_cvt_pk_bf16_f32 v43, v22, v23
    v_mfma_f32_16x16x32_bf16 a[96:99], a[112:115], v[32:35], a[96:99]
    v_exp_f32 v26, v26
    v_mfma_f32_16x16x32_bf16 a[96:99], a[112:115], v[36:39], a[96:99]
    v_exp_f32 v27, v27
    v_exp_f32 v28, v28
    v_exp_f32 v29, v29
    v_cvt_pk_bf16_f32 v44, v24, v25
    v_exp_f32 v30, v30
    v_cvt_pk_bf16_f32 v45, v26, v27
    v_exp_f32 v31, v31
    v_cvt_pk_bf16_f32 v46, v28, v29
    v_cvt_pk_bf16_f32 v47, v30, v31
    s_waitcnt vmcnt(0)
    v_cmp_ne_u32 vcc, s29, v184
    s_cbranch_vccz kvwait_ok
    s_mov_b32 s4, 0
kvwait:
    buffer_load_dword v184, v245, s[8:11], s100 offen sc1
    s_add_u32 s4, s4, 1
    s_waitcnt vmcnt(0)
    v_cmp_ne_u32 vcc, s29, v184
    s_cbranch_vccz kvwait_ok
    s_cmp_lt_u32 s4, 2097152
    s_cbranch_scc1 kvwait
kvwait_ok:
    s_add_u32 s28, s28, 16384
    s_and_b32 s28, s28, 0x3ffff
    s_add_u32 s24, s35, s28
    v_mfma_f32_32x32x16_bf16 v[16:31], a[16:19], a[88:91], v[96:111]
    buffer_load_dwordx4 a[32:35], v241, s[8:11], s24 offen offset:0 sc1
    v_exp_f32 v0, v0
    v_exp_f32 v1, v1
    v_exp_f32 v2, v2
    v_mfma_f32_32x32x16_bf16 v[16:31], a[20:23], a[92:95], v[16:31]
    buffer_load_dwordx4 a[36:39], v241, s[8:11], s24 offen offset:1024 sc1
    v_exp_f32 v3, v3
    v_exp_f32 v4, v4
    v_exp_f32 v5, v5
    v_mfma_f32_32x32x16_bf16 v[128:143], a[24:27], v[40:43], v[128:143]
    buffer_load_dwordx4 a[40:43], v241, s[8:11], s24 offen offset:2048 sc1
    v_exp_f32 v6, v6
    v_exp_f32 v7, v7
    v_cvt_pk_bf16_f32 v32, v0, v1
    v_cvt_pk_bf16_f32 v33, v2, v3
    v_mfma_f32_32x32x16_bf16 v[128:143], a[28:31], v[44:47], v[128:143]
    buffer_load_dwordx4 a[44:47], v241, s[8:11], s24 offen offset:3072 sc1
    v_exp_f32 v8, v8
    v_exp_f32 v9, v9
    v_cvt_pk_bf16_f32 v34, v4, v5
    v_cvt_pk_bf16_f32 v35, v6, v7
    v_mfma_f32_16x16x32_bf16 a[100:103], a[112:115], v[40:43], a[100:103]
    buffer_load_dwordx4 a[48:51], v242, s[8:11], s24 offen offset:0 sc1
    v_exp_f32 v10, v10
    v_mfma_f32_16x16x32_bf16 a[100:103], a[112:115], v[44:47], a[100:103]
    buffer_load_dwordx4 a[52:55], v242, s[8:11], s24 offen offset:1024 sc1
    v_exp_f32 v11, v11
    v_exp_f32 v12, v12
    v_exp_f32 v13, v13
    v_cvt_pk_bf16_f32 v36, v8, v9
    v_exp_f32 v14, v14
    v_cvt_pk_bf16_f32 v37, v10, v11
    v_exp_f32 v15, v15
    v_cvt_pk_bf16_f32 v38, v12, v13
    v_cvt_pk_bf16_f32 v39, v14, v15
    buffer_load_dwordx4 a[56:59], v242, s[8:11], s24 offen offset:2048 sc1
    buffer_load_dwordx4 a[60:63], v242, s[8:11], s24 offen offset:3072 sc1
    s_add_u32 s28, s28, 16384
    s_and_b32 s28, s28, 0x3ffff
    s_add_u32 s24, s35, s28
    s_waitcnt vmcnt(4)
    v_mfma_f32_32x32x16_bf16 v[0:15], a[32:35], a[64:67], v[48:63]
    buffer_load_dwordx4 a[0:3], v241, s[8:11], s24 offen offset:0 sc1
    v_exp_f32 v16, v16
    v_exp_f32 v17, v17
    v_exp_f32 v18, v18
    v_mfma_f32_32x32x16_bf16 v[0:15], a[36:39], a[68:71], v[0:15]
    buffer_load_dwordx4 a[4:7], v241, s[8:11], s24 offen offset:1024 sc1
    v_exp_f32 v19, v19
    v_exp_f32 v20, v20
    v_exp_f32 v21, v21
    v_mfma_f32_32x32x16_bf16 v[144:159], a[24:27], v[32:35], v[144:159]
    buffer_load_dwordx4 a[8:11], v241, s[8:11], s24 offen offset:2048 sc1
    v_exp_f32 v22, v22
    v_exp_f32 v23, v23
    v_cvt_pk_bf16_f32 v40, v16, v17
    v_cvt_pk_bf16_f32 v41, v18, v19
    v_mfma_f32_32x32x16_bf16 v[144:159], a[28:31], v[36:39], v[144:159]
    buffer_load_dwordx4 a[12:15], v241, s[8:11], s24 offen offset:3072 sc1
    v_exp_f32 v24, v24
    v_exp_f32 v25, v25
    v_cvt_pk_bf16_f32 v42, v20, v21
    v_cvt_pk_bf16_f32 v43, v22, v23
    v_mfma_f32_16x16x32_bf16 a[104:107], a[112:115], v[32:35], a[104:107]
    v_exp_f32 v26, v26
    v_mfma_f32_16x16x32_bf16 a[104:107], a[112:115], v[36:39], a[104:107]
    v_exp_f32 v27, v27
    v_exp_f32 v28, v28
    v_exp_f32 v29, v29
    v_cvt_pk_bf16_f32 v44, v24, v25
    v_exp_f32 v30, v30
    v_cvt_pk_bf16_f32 v45, v26, v27
    v_exp_f32 v31, v31
    v_cvt_pk_bf16_f32 v46, v28, v29
    v_cvt_pk_bf16_f32 v47, v30, v31
    s_mov_b32 s20, 7
.p2align 6
attn_loop:
    v_mfma_f32_32x32x16_bf16 v[16:31], a[32:35], a[72:75], v[64:79]
    buffer_load_dwordx4 a[16:19], v242, s[8:11], s24 offen offset:0 sc1
    v_exp_f32 v0, v0
    v_exp_f32 v1, v1
    v_exp_f32 v2, v2
    v_mfma_f32_32x32x16_bf16 v[16:31], a[36:39], a[76:79], v[16:31]
    v_exp_f32 v3, v3
    v_exp_f32 v4, v4
    v_exp_f32 v5, v5
    v_mfma_f32_32x32x16_bf16 v[160:175], a[24:27], v[40:43], v[160:175]
    v_exp_f32 v6, v6
    v_exp_f32 v7, v7
    v_cvt_pk_bf16_f32 v32, v0, v1
    v_cvt_pk_bf16_f32 v33, v2, v3
    v_mfma_f32_32x32x16_bf16 v[160:175], a[28:31], v[44:47], v[160:175]
    v_exp_f32 v8, v8
    v_exp_f32 v9, v9
    v_cvt_pk_bf16_f32 v34, v4, v5
    v_cvt_pk_bf16_f32 v35, v6, v7
    v_mfma_f32_16x16x32_bf16 a[108:111], a[112:115], v[40:43], a[108:111]
    v_exp_f32 v10, v10
    v_mfma_f32_16x16x32_bf16 a[108:111], a[112:115], v[44:47], a[108:111]
    v_exp_f32 v11, v11
    v_exp_f32 v12, v12
    v_exp_f32 v13, v13
    v_cvt_pk_bf16_f32 v36, v8, v9
    v_exp_f32 v14, v14
    v_cvt_pk_bf16_f32 v37, v10, v11
    v_exp_f32 v15, v15
    v_cvt_pk_bf16_f32 v38, v12, v13
    v_cvt_pk_bf16_f32 v39, v14, v15
    v_mfma_f32_32x32x16_bf16 v[0:15], a[32:35], a[80:83], v[80:95]
    buffer_load_dwordx4 a[20:23], v242, s[8:11], s24 offen offset:1024 sc1
    v_exp_f32 v16, v16
    v_exp_f32 v17, v17
    v_exp_f32 v18, v18
    v_mfma_f32_32x32x16_bf16 v[0:15], a[36:39], a[84:87], v[0:15]
    s_mov_b32 m0, s32
    v_exp_f32 v19, v19
    v_exp_f32 v20, v20
    v_exp_f32 v21, v21
    v_mfma_f32_32x32x16_bf16 v[112:127], a[40:43], v[32:35], v[112:127]
    buffer_load_dwordx4 v249, s[12:15], s30 offen lds
    v_exp_f32 v22, v22
    v_exp_f32 v23, v23
    v_cvt_pk_bf16_f32 v40, v16, v17
    v_cvt_pk_bf16_f32 v41, v18, v19
    v_mfma_f32_32x32x16_bf16 v[112:127], a[44:47], v[36:39], v[112:127]
    v_exp_f32 v24, v24
    v_exp_f32 v25, v25
    v_cvt_pk_bf16_f32 v42, v20, v21
    v_cvt_pk_bf16_f32 v43, v22, v23
    v_mfma_f32_16x16x32_bf16 a[96:99], a[112:115], v[32:35], a[96:99]
    v_exp_f32 v26, v26
    v_mfma_f32_16x16x32_bf16 a[96:99], a[112:115], v[36:39], a[96:99]
    v_exp_f32 v27, v27
    v_exp_f32 v28, v28
    v_exp_f32 v29, v29
    v_cvt_pk_bf16_f32 v44, v24, v25
    v_exp_f32 v30, v30
    v_cvt_pk_bf16_f32 v45, v26, v27
    v_exp_f32 v31, v31
    v_cvt_pk_bf16_f32 v46, v28, v29
    v_cvt_pk_bf16_f32 v47, v30, v31
    v_mfma_f32_32x32x16_bf16 v[16:31], a[32:35], a[88:91], v[96:111]
    buffer_load_dwordx4 a[24:27], v242, s[8:11], s24 offen offset:2048 sc1
    v_exp_f32 v0, v0
    v_exp_f32 v1, v1
    v_exp_f32 v2, v2
    v_mfma_f32_32x32x16_bf16 v[16:31], a[36:39], a[92:95], v[16:31]
    buffer_load_dwordx4 v250, s[12:15], s30 offen offset:1024 lds
    v_exp_f32 v3, v3
    v_exp_f32 v4, v4
    v_exp_f32 v5, v5
    v_mfma_f32_32x32x16_bf16 v[128:143], a[40:43], v[40:43], v[128:143]
    s_add_u32 s32, s32, 8192
    v_exp_f32 v6, v6
    v_exp_f32 v7, v7
    v_cvt_pk_bf16_f32 v32, v0, v1
    v_cvt_pk_bf16_f32 v33, v2, v3
    v_mfma_f32_32x32x16_bf16 v[128:143], a[44:47], v[44:47], v[128:143]
    s_add_u32 s30, s30, 131072
    v_exp_f32 v8, v8
    v_exp_f32 v9, v9
    v_cvt_pk_bf16_f32 v34, v4, v5
    v_cvt_pk_bf16_f32 v35, v6, v7
    v_mfma_f32_16x16x32_bf16 a[100:103], a[112:115], v[40:43], a[100:103]
    v_exp_f32 v10, v10
    v_mfma_f32_16x16x32_bf16 a[100:103], a[112:115], v[44:47], a[100:103]
    s_waitcnt vmcnt(9)
    v_exp_f32 v11, v11
    v_exp_f32 v12, v12
    v_exp_f32 v13, v13
    v_cvt_pk_bf16_f32 v36, v8, v9
    v_exp_f32 v14, v14
    v_cvt_pk_bf16_f32 v37, v10, v11
    v_exp_f32 v15, v15
    v_cvt_pk_bf16_f32 v38, v12, v13
    v_cvt_pk_bf16_f32 v39, v14, v15
    v_mfma_f32_32x32x16_bf16 v[0:15], a[48:51], a[64:67], v[48:63]
    buffer_load_dwordx4 a[28:31], v242, s[8:11], s24 offen offset:3072 sc1
    v_exp_f32 v16, v16
    v_exp_f32 v17, v17
    v_exp_f32 v18, v18
    v_mfma_f32_32x32x16_bf16 v[0:15], a[52:55], a[68:71], v[0:15]
    s_add_u32 s28, s28, 16384
    v_exp_f32 v19, v19
    v_exp_f32 v20, v20
    v_exp_f32 v21, v21
    v_mfma_f32_32x32x16_bf16 v[144:159], a[40:43], v[32:35], v[144:159]
    s_and_b32 s28, s28, 0x3ffff
    v_exp_f32 v22, v22
    v_exp_f32 v23, v23
    v_cvt_pk_bf16_f32 v40, v16, v17
    v_cvt_pk_bf16_f32 v41, v18, v19
    v_mfma_f32_32x32x16_bf16 v[144:159], a[44:47], v[36:39], v[144:159]
    s_add_u32 s24, s35, s28
    v_exp_f32 v24, v24
    v_exp_f32 v25, v25
    v_cvt_pk_bf16_f32 v42, v20, v21
    v_cvt_pk_bf16_f32 v43, v22, v23
    v_mfma_f32_16x16x32_bf16 a[104:107], a[112:115], v[32:35], a[104:107]
    v_exp_f32 v26, v26
    v_mfma_f32_16x16x32_bf16 a[104:107], a[112:115], v[36:39], a[104:107]
    v_exp_f32 v27, v27
    v_exp_f32 v28, v28
    v_exp_f32 v29, v29
    v_cvt_pk_bf16_f32 v44, v24, v25
    v_exp_f32 v30, v30
    v_cvt_pk_bf16_f32 v45, v26, v27
    v_exp_f32 v31, v31
    v_cvt_pk_bf16_f32 v46, v28, v29
    v_cvt_pk_bf16_f32 v47, v30, v31
    v_mfma_f32_32x32x16_bf16 v[16:31], a[48:51], a[72:75], v[64:79]
    buffer_load_dwordx4 a[32:35], v241, s[8:11], s24 offen offset:0 sc1
    v_exp_f32 v0, v0
    v_exp_f32 v1, v1
    v_exp_f32 v2, v2
    v_mfma_f32_32x32x16_bf16 v[16:31], a[52:55], a[76:79], v[16:31]
    v_exp_f32 v3, v3
    v_exp_f32 v4, v4
    v_exp_f32 v5, v5
    v_mfma_f32_32x32x16_bf16 v[160:175], a[40:43], v[40:43], v[160:175]
    v_exp_f32 v6, v6
    v_exp_f32 v7, v7
    v_cvt_pk_bf16_f32 v32, v0, v1
    v_cvt_pk_bf16_f32 v33, v2, v3
    v_mfma_f32_32x32x16_bf16 v[160:175], a[44:47], v[44:47], v[160:175]
    v_exp_f32 v8, v8
    v_exp_f32 v9, v9
    v_cvt_pk_bf16_f32 v34, v4, v5
    v_cvt_pk_bf16_f32 v35, v6, v7
    v_mfma_f32_16x16x32_bf16 a[108:111], a[112:115], v[40:43], a[108:111]
    v_exp_f32 v10, v10
    v_mfma_f32_16x16x32_bf16 a[108:111], a[112:115], v[44:47], a[108:111]
    v_exp_f32 v11, v11
    v_exp_f32 v12, v12
    v_exp_f32 v13, v13
    v_cvt_pk_bf16_f32 v36, v8, v9
    v_exp_f32 v14, v14
    v_cvt_pk_bf16_f32 v37, v10, v11
    v_exp_f32 v15, v15
    v_cvt_pk_bf16_f32 v38, v12, v13
    v_cvt_pk_bf16_f32 v39, v14, v15
    v_mfma_f32_32x32x16_bf16 v[0:15], a[48:51], a[80:83], v[80:95]
    buffer_load_dwordx4 a[36:39], v241, s[8:11], s24 offen offset:1024 sc1
    v_exp_f32 v16, v16
    v_exp_f32 v17, v17
    v_exp_f32 v18, v18
    v_mfma_f32_32x32x16_bf16 v[0:15], a[52:55], a[84:87], v[0:15]
    v_exp_f32 v19, v19
    v_exp_f32 v20, v20
    v_exp_f32 v21, v21
    v_mfma_f32_32x32x16_bf16 v[112:127], a[56:59], v[32:35], v[112:127]
    v_exp_f32 v22, v22
    v_exp_f32 v23, v23
    v_cvt_pk_bf16_f32 v40, v16, v17
    v_cvt_pk_bf16_f32 v41, v18, v19
    v_mfma_f32_32x32x16_bf16 v[112:127], a[60:63], v[36:39], v[112:127]
    v_exp_f32 v24, v24
    v_exp_f32 v25, v25
    v_cvt_pk_bf16_f32 v42, v20, v21
    v_cvt_pk_bf16_f32 v43, v22, v23
    v_mfma_f32_16x16x32_bf16 a[96:99], a[112:115], v[32:35], a[96:99]
    v_exp_f32 v26, v26
    v_mfma_f32_16x16x32_bf16 a[96:99], a[112:115], v[36:39], a[96:99]
    v_exp_f32 v27, v27
    v_exp_f32 v28, v28
    v_exp_f32 v29, v29
    v_cvt_pk_bf16_f32 v44, v24, v25
    v_exp_f32 v30, v30
    v_cvt_pk_bf16_f32 v45, v26, v27
    v_exp_f32 v31, v31
    v_cvt_pk_bf16_f32 v46, v28, v29
    v_cvt_pk_bf16_f32 v47, v30, v31
    v_mfma_f32_32x32x16_bf16 v[16:31], a[48:51], a[88:91], v[96:111]
    buffer_load_dwordx4 a[40:43], v241, s[8:11], s24 offen offset:2048 sc1
    v_exp_f32 v0, v0
    v_exp_f32 v1, v1
    v_exp_f32 v2, v2
    v_mfma_f32_32x32x16_bf16 v[16:31], a[52:55], a[92:95], v[16:31]
    v_exp_f32 v3, v3
    v_exp_f32 v4, v4
    v_exp_f32 v5, v5
    v_mfma_f32_32x32x16_bf16 v[128:143], a[56:59], v[40:43], v[128:143]
    v_exp_f32 v6, v6
    v_exp_f32 v7, v7
    v_cvt_pk_bf16_f32 v32, v0, v1
    v_cvt_pk_bf16_f32 v33, v2, v3
    v_mfma_f32_32x32x16_bf16 v[128:143], a[60:63], v[44:47], v[128:143]
    v_exp_f32 v8, v8
    v_exp_f32 v9, v9
    v_cvt_pk_bf16_f32 v34, v4, v5
    v_cvt_pk_bf16_f32 v35, v6, v7
    v_mfma_f32_16x16x32_bf16 a[100:103], a[112:115], v[40:43], a[100:103]
    v_exp_f32 v10, v10
    v_mfma_f32_16x16x32_bf16 a[100:103], a[112:115], v[44:47], a[100:103]
    s_waitcnt vmcnt(9)
    v_exp_f32 v11, v11
    v_exp_f32 v12, v12
    v_exp_f32 v13, v13
    v_cvt_pk_bf16_f32 v36, v8, v9
    v_exp_f32 v14, v14
    v_cvt_pk_bf16_f32 v37, v10, v11
    v_exp_f32 v15, v15
    v_cvt_pk_bf16_f32 v38, v12, v13
    v_cvt_pk_bf16_f32 v39, v14, v15
    v_mfma_f32_32x32x16_bf16 v[0:15], a[0:3], a[64:67], v[48:63]
    buffer_load_dwordx4 a[44:47], v241, s[8:11], s24 offen offset:3072 sc1
    v_exp_f32 v16, v16
    v_exp_f32 v17, v17
    v_exp_f32 v18, v18
    v_mfma_f32_32x32x16_bf16 v[0:15], a[4:7], a[68:71], v[0:15]
    buffer_load_dword v244, v243, s[44:47], 0 offen
    v_exp_f32 v19, v19
    v_exp_f32 v20, v20
    v_exp_f32 v21, v21
    v_mfma_f32_32x32x16_bf16 v[144:159], a[56:59], v[32:35], v[144:159]
    v_add_u32 v243, 524288, v243
    v_exp_f32 v22, v22
    v_exp_f32 v23, v23
    v_cvt_pk_bf16_f32 v40, v16, v17
    v_cvt_pk_bf16_f32 v41, v18, v19
    v_mfma_f32_32x32x16_bf16 v[144:159], a[60:63], v[36:39], v[144:159]
    v_exp_f32 v24, v24
    v_exp_f32 v25, v25
    v_cvt_pk_bf16_f32 v42, v20, v21
    v_cvt_pk_bf16_f32 v43, v22, v23
    v_mfma_f32_16x16x32_bf16 a[104:107], a[112:115], v[32:35], a[104:107]
    v_exp_f32 v26, v26
    v_mfma_f32_16x16x32_bf16 a[104:107], a[112:115], v[36:39], a[104:107]
    v_exp_f32 v27, v27
    v_exp_f32 v28, v28
    v_exp_f32 v29, v29
    v_cvt_pk_bf16_f32 v44, v24, v25
    v_exp_f32 v30, v30
    v_cvt_pk_bf16_f32 v45, v26, v27
    v_exp_f32 v31, v31
    v_cvt_pk_bf16_f32 v46, v28, v29
    v_cvt_pk_bf16_f32 v47, v30, v31
    v_mfma_f32_32x32x16_bf16 v[16:31], a[0:3], a[72:75], v[64:79]
    buffer_load_dwordx4 a[48:51], v242, s[8:11], s24 offen offset:0 sc1
    v_exp_f32 v0, v0
    v_exp_f32 v1, v1
    v_exp_f32 v2, v2
    v_mfma_f32_32x32x16_bf16 v[16:31], a[4:7], a[76:79], v[16:31]
    v_exp_f32 v3, v3
    v_exp_f32 v4, v4
    v_exp_f32 v5, v5
    v_mfma_f32_32x32x16_bf16 v[160:175], a[56:59], v[40:43], v[160:175]
    v_exp_f32 v6, v6
    v_exp_f32 v7, v7
    v_cvt_pk_bf16_f32 v32, v0, v1
    v_cvt_pk_bf16_f32 v33, v2, v3
    v_mfma_f32_32x32x16_bf16 v[160:175], a[60:63], v[44:47], v[160:175]
    v_exp_f32 v8, v8
    v_exp_f32 v9, v9
    v_cvt_pk_bf16_f32 v34, v4, v5
    v_cvt_pk_bf16_f32 v35, v6, v7
    v_mfma_f32_16x16x32_bf16 a[108:111], a[112:115], v[40:43], a[108:111]
    v_exp_f32 v10, v10
    v_mfma_f32_16x16x32_bf16 a[108:111], a[112:115], v[44:47], a[108:111]
    v_exp_f32 v11, v11
    v_exp_f32 v12, v12
    v_exp_f32 v13, v13
    v_cvt_pk_bf16_f32 v36, v8, v9
    v_exp_f32 v14, v14
    v_cvt_pk_bf16_f32 v37, v10, v11
    v_exp_f32 v15, v15
    v_cvt_pk_bf16_f32 v38, v12, v13
    v_cvt_pk_bf16_f32 v39, v14, v15
    v_mfma_f32_32x32x16_bf16 v[0:15], a[0:3], a[80:83], v[80:95]
    buffer_load_dwordx4 a[52:55], v242, s[8:11], s24 offen offset:1024 sc1
    v_exp_f32 v16, v16
    v_exp_f32 v17, v17
    v_exp_f32 v18, v18
    v_mfma_f32_32x32x16_bf16 v[0:15], a[4:7], a[84:87], v[0:15]
    s_mov_b32 m0, s32
    v_exp_f32 v19, v19
    v_exp_f32 v20, v20
    v_exp_f32 v21, v21
    v_mfma_f32_32x32x16_bf16 v[112:127], a[8:11], v[32:35], v[112:127]
    buffer_load_dwordx4 v249, s[12:15], s30 offen lds
    v_exp_f32 v22, v22
    v_exp_f32 v23, v23
    v_cvt_pk_bf16_f32 v40, v16, v17
    v_cvt_pk_bf16_f32 v41, v18, v19
    v_mfma_f32_32x32x16_bf16 v[112:127], a[12:15], v[36:39], v[112:127]
    v_exp_f32 v24, v24
    v_exp_f32 v25, v25
    v_cvt_pk_bf16_f32 v42, v20, v21
    v_cvt_pk_bf16_f32 v43, v22, v23
    v_mfma_f32_16x16x32_bf16 a[96:99], a[112:115], v[32:35], a[96:99]
    v_exp_f32 v26, v26
    v_mfma_f32_16x16x32_bf16 a[96:99], a[112:115], v[36:39], a[96:99]
    v_exp_f32 v27, v27
    v_exp_f32 v28, v28
    v_exp_f32 v29, v29
    v_cvt_pk_bf16_f32 v44, v24, v25
    v_exp_f32 v30, v30
    v_cvt_pk_bf16_f32 v45, v26, v27
    v_exp_f32 v31, v31
    v_cvt_pk_bf16_f32 v46, v28, v29
    v_cvt_pk_bf16_f32 v47, v30, v31
    v_mfma_f32_32x32x16_bf16 v[16:31], a[0:3], a[88:91], v[96:111]
    buffer_load_dwordx4 a[56:59], v242, s[8:11], s24 offen offset:2048 sc1
    v_exp_f32 v0, v0
    v_exp_f32 v1, v1
    v_exp_f32 v2, v2
    v_mfma_f32_32x32x16_bf16 v[16:31], a[4:7], a[92:95], v[16:31]
    buffer_load_dwordx4 v250, s[12:15], s30 offen offset:1024 lds
    v_exp_f32 v3, v3
    v_exp_f32 v4, v4
    v_exp_f32 v5, v5
    v_mfma_f32_32x32x16_bf16 v[128:143], a[8:11], v[40:43], v[128:143]
    s_add_u32 s32, s32, 8192
    v_exp_f32 v6, v6
    v_exp_f32 v7, v7
    v_cvt_pk_bf16_f32 v32, v0, v1
    v_cvt_pk_bf16_f32 v33, v2, v3
    v_mfma_f32_32x32x16_bf16 v[128:143], a[12:15], v[44:47], v[128:143]
    s_add_u32 s30, s30, 131072
    v_exp_f32 v8, v8
    v_exp_f32 v9, v9
    v_cvt_pk_bf16_f32 v34, v4, v5
    v_cvt_pk_bf16_f32 v35, v6, v7
    v_mfma_f32_16x16x32_bf16 a[100:103], a[112:115], v[40:43], a[100:103]
    v_exp_f32 v10, v10
    v_mfma_f32_16x16x32_bf16 a[100:103], a[112:115], v[44:47], a[100:103]
    s_waitcnt vmcnt(10)
    v_exp_f32 v11, v11
    v_exp_f32 v12, v12
    v_exp_f32 v13, v13
    v_cvt_pk_bf16_f32 v36, v8, v9
    v_exp_f32 v14, v14
    v_cvt_pk_bf16_f32 v37, v10, v11
    v_exp_f32 v15, v15
    v_cvt_pk_bf16_f32 v38, v12, v13
    v_cvt_pk_bf16_f32 v39, v14, v15
    v_mfma_f32_32x32x16_bf16 v[0:15], a[16:19], a[64:67], v[48:63]
    buffer_load_dwordx4 a[60:63], v242, s[8:11], s24 offen offset:3072 sc1
    v_exp_f32 v16, v16
    v_exp_f32 v17, v17
    v_exp_f32 v18, v18
    v_mfma_f32_32x32x16_bf16 v[0:15], a[20:23], a[68:71], v[0:15]
    s_add_u32 s28, s28, 16384
    v_exp_f32 v19, v19
    v_exp_f32 v20, v20
    v_exp_f32 v21, v21
    v_mfma_f32_32x32x16_bf16 v[144:159], a[8:11], v[32:35], v[144:159]
    s_and_b32 s28, s28, 0x3ffff
    v_exp_f32 v22, v22
    v_exp_f32 v23, v23
    v_cvt_pk_bf16_f32 v40, v16, v17
    v_cvt_pk_bf16_f32 v41, v18, v19
    v_mfma_f32_32x32x16_bf16 v[144:159], a[12:15], v[36:39], v[144:159]
    s_add_u32 s24, s35, s28
    v_exp_f32 v24, v24
    v_exp_f32 v25, v25
    v_cvt_pk_bf16_f32 v42, v20, v21
    v_cvt_pk_bf16_f32 v43, v22, v23
    v_mfma_f32_16x16x32_bf16 a[104:107], a[112:115], v[32:35], a[104:107]
    v_exp_f32 v26, v26
    v_mfma_f32_16x16x32_bf16 a[104:107], a[112:115], v[36:39], a[104:107]
    v_exp_f32 v27, v27
    v_exp_f32 v28, v28
    v_exp_f32 v29, v29
    v_cvt_pk_bf16_f32 v44, v24, v25
    v_exp_f32 v30, v30
    v_cvt_pk_bf16_f32 v45, v26, v27
    v_exp_f32 v31, v31
    v_cvt_pk_bf16_f32 v46, v28, v29
    v_cvt_pk_bf16_f32 v47, v30, v31
    v_mfma_f32_32x32x16_bf16 v[16:31], a[16:19], a[72:75], v[64:79]
    buffer_load_dwordx4 a[0:3], v241, s[8:11], s24 offen offset:0 sc1
    v_exp_f32 v0, v0
    v_exp_f32 v1, v1
    v_exp_f32 v2, v2
    v_mfma_f32_32x32x16_bf16 v[16:31], a[20:23], a[76:79], v[16:31]
    v_exp_f32 v3, v3
    v_exp_f32 v4, v4
    v_exp_f32 v5, v5
    v_mfma_f32_32x32x16_bf16 v[160:175], a[8:11], v[40:43], v[160:175]
    v_exp_f32 v6, v6
    v_exp_f32 v7, v7
    v_cvt_pk_bf16_f32 v32, v0, v1
    v_cvt_pk_bf16_f32 v33, v2, v3
    v_mfma_f32_32x32x16_bf16 v[160:175], a[12:15], v[44:47], v[160:175]
    v_exp_f32 v8, v8
    v_exp_f32 v9, v9
    v_cvt_pk_bf16_f32 v34, v4, v5
    v_cvt_pk_bf16_f32 v35, v6, v7
    v_mfma_f32_16x16x32_bf16 a[108:111], a[112:115], v[40:43], a[108:111]
    v_exp_f32 v10, v10
    v_mfma_f32_16x16x32_bf16 a[108:111], a[112:115], v[44:47], a[108:111]
    v_exp_f32 v11, v11
    v_exp_f32 v12, v12
    v_exp_f32 v13, v13
    v_cvt_pk_bf16_f32 v36, v8, v9
    v_exp_f32 v14, v14
    v_cvt_pk_bf16_f32 v37, v10, v11
    v_exp_f32 v15, v15
    v_cvt_pk_bf16_f32 v38, v12, v13
    v_cvt_pk_bf16_f32 v39, v14, v15
    v_mfma_f32_32x32x16_bf16 v[0:15], a[16:19], a[80:83], v[80:95]
    buffer_load_dwordx4 a[4:7], v241, s[8:11], s24 offen offset:1024 sc1
    v_exp_f32 v16, v16
    v_exp_f32 v17, v17
    v_exp_f32 v18, v18
    v_mfma_f32_32x32x16_bf16 v[0:15], a[20:23], a[84:87], v[0:15]
    v_exp_f32 v19, v19
    v_exp_f32 v20, v20
    v_exp_f32 v21, v21
    v_mfma_f32_32x32x16_bf16 v[112:127], a[24:27], v[32:35], v[112:127]
    v_exp_f32 v22, v22
    v_exp_f32 v23, v23
    v_cvt_pk_bf16_f32 v40, v16, v17
    v_cvt_pk_bf16_f32 v41, v18, v19
    v_mfma_f32_32x32x16_bf16 v[112:127], a[28:31], v[36:39], v[112:127]
    v_exp_f32 v24, v24
    v_exp_f32 v25, v25
    v_cvt_pk_bf16_f32 v42, v20, v21
    v_cvt_pk_bf16_f32 v43, v22, v23
    v_mfma_f32_16x16x32_bf16 a[96:99], a[112:115], v[32:35], a[96:99]
    v_exp_f32 v26, v26
    v_mfma_f32_16x16x32_bf16 a[96:99], a[112:115], v[36:39], a[96:99]
    v_exp_f32 v27, v27
    v_exp_f32 v28, v28
    v_exp_f32 v29, v29
    v_cvt_pk_bf16_f32 v44, v24, v25
    v_exp_f32 v30, v30
    v_cvt_pk_bf16_f32 v45, v26, v27
    v_exp_f32 v31, v31
    v_cvt_pk_bf16_f32 v46, v28, v29
    v_cvt_pk_bf16_f32 v47, v30, v31
    v_mfma_f32_32x32x16_bf16 v[16:31], a[16:19], a[88:91], v[96:111]
    buffer_load_dwordx4 a[8:11], v241, s[8:11], s24 offen offset:2048 sc1
    v_exp_f32 v0, v0
    v_exp_f32 v1, v1
    v_exp_f32 v2, v2
    v_mfma_f32_32x32x16_bf16 v[16:31], a[20:23], a[92:95], v[16:31]
    v_exp_f32 v3, v3
    v_exp_f32 v4, v4
    v_exp_f32 v5, v5
    v_mfma_f32_32x32x16_bf16 v[128:143], a[24:27], v[40:43], v[128:143]
    v_exp_f32 v6, v6
    v_exp_f32 v7, v7
    v_cvt_pk_bf16_f32 v32, v0, v1
    v_cvt_pk_bf16_f32 v33, v2, v3
    v_mfma_f32_32x32x16_bf16 v[128:143], a[28:31], v[44:47], v[128:143]
    v_exp_f32 v8, v8
    v_exp_f32 v9, v9
    v_cvt_pk_bf16_f32 v34, v4, v5
    v_cvt_pk_bf16_f32 v35, v6, v7
    v_mfma_f32_16x16x32_bf16 a[100:103], a[112:115], v[40:43], a[100:103]
    v_exp_f32 v10, v10
    v_mfma_f32_16x16x32_bf16 a[100:103], a[112:115], v[44:47], a[100:103]
    s_waitcnt vmcnt(10)
    v_exp_f32 v11, v11
    v_exp_f32 v12, v12
    v_exp_f32 v13, v13
    v_cvt_pk_bf16_f32 v36, v8, v9
    v_exp_f32 v14, v14
    v_cvt_pk_bf16_f32 v37, v10, v11
    v_exp_f32 v15, v15
    v_cvt_pk_bf16_f32 v38, v12, v13
    v_cvt_pk_bf16_f32 v39, v14, v15
    v_mfma_f32_32x32x16_bf16 v[0:15], a[32:35], a[64:67], v[48:63]
    buffer_load_dwordx4 a[12:15], v241, s[8:11], s24 offen offset:3072 sc1
    v_exp_f32 v16, v16
    v_exp_f32 v17, v17
    v_exp_f32 v18, v18
    v_mfma_f32_32x32x16_bf16 v[0:15], a[36:39], a[68:71], v[0:15]
    buffer_load_dword v244, v243, s[44:47], 0 offen
    v_exp_f32 v19, v19
    v_exp_f32 v20, v20
    v_exp_f32 v21, v21
    v_mfma_f32_32x32x16_bf16 v[144:159], a[24:27], v[32:35], v[144:159]
    v_add_u32 v243, 524288, v243
    v_exp_f32 v22, v22
    v_exp_f32 v23, v23
    v_cvt_pk_bf16_f32 v40, v16, v17
    v_cvt_pk_bf16_f32 v41, v18, v19
    v_mfma_f32_32x32x16_bf16 v[144:159], a[28:31], v[36:39], v[144:159]
    v_exp_f32 v24, v24
    v_exp_f32 v25, v25
    v_cvt_pk_bf16_f32 v42, v20, v21
    v_cvt_pk_bf16_f32 v43, v22, v23
    v_mfma_f32_16x16x32_bf16 a[104:107], a[112:115], v[32:35], a[104:107]
    s_sub_u32 s20, s20, 1
    v_exp_f32 v26, v26
    v_mfma_f32_16x16x32_bf16 a[104:107], a[112:115], v[36:39], a[104:107]
    s_cmp_lg_u32 s20, 0
    v_exp_f32 v27, v27
    v_exp_f32 v28, v28
    v_exp_f32 v29, v29
    v_cvt_pk_bf16_f32 v44, v24, v25
    v_exp_f32 v30, v30
    v_cvt_pk_bf16_f32 v45, v26, v27
    v_exp_f32 v31, v31
    v_cvt_pk_bf16_f32 v46, v28, v29
    v_cvt_pk_bf16_f32 v47, v30, v31
    s_cbranch_scc1 attn_loop
    v_mfma_f32_32x32x16_bf16 v[16:31], a[32:35], a[72:75], v[64:79]
    v_exp_f32 v0, v0
    v_exp_f32 v1, v1
    v_exp_f32 v2, v2
    v_mfma_f32_32x32x16_bf16 v[16:31], a[36:39], a[76:79], v[16:31]
    v_exp_f32 v3, v3
    v_exp_f32 v4, v4
    v_exp_f32 v5, v5
    v_mfma_f32_32x32x16_bf16 v[160:175], a[24:27], v[40:43], v[160:175]
    v_exp_f32 v6, v6
    v_exp_f32 v7, v7
    v_cvt_pk_bf16_f32 v32, v0, v1
    v_cvt_pk_bf16_f32 v33, v2, v3
    v_mfma_f32_32x32x16_bf16 v[160:175], a[28:31], v[44:47], v[160:175]
    v_exp_f32 v8, v8
    v_exp_f32 v9, v9
    v_cvt_pk_bf16_f32 v34, v4, v5
    v_cvt_pk_bf16_f32 v35, v6, v7
    v_mfma_f32_16x16x32_bf16 a[108:111], a[112:115], v[40:43], a[108:111]
    v_exp_f32 v10, v10
    v_mfma_f32_16x16x32_bf16 a[108:111], a[112:115], v[44:47], a[108:111]
    v_exp_f32 v11, v11
    v_exp_f32 v12, v12
    v_exp_f32 v13, v13
    v_cvt_pk_bf16_f32 v36, v8, v9
    v_exp_f32 v14, v14
    v_cvt_pk_bf16_f32 v37, v10, v11
    v_exp_f32 v15, v15
    v_cvt_pk_bf16_f32 v38, v12, v13
    v_cvt_pk_bf16_f32 v39, v14, v15
    v_mfma_f32_32x32x16_bf16 v[0:15], a[32:35], a[80:83], v[80:95]
    s_lshl_b32 s3, s21, 13
    v_exp_f32 v16, v16
    v_exp_f32 v17, v17
    v_exp_f32 v18, v18
    v_mfma_f32_32x32x16_bf16 v[0:15], a[36:39], a[84:87], v[0:15]
    s_add_u32 s101, s3, 40239104
    v_exp_f32 v19, v19
    v_exp_f32 v20, v20
    v_exp_f32 v21, v21
    v_mfma_f32_32x32x16_bf16 v[112:127], a[40:43], v[32:35], v[112:127]
    v_lshlrev_b32 v245, 7, v240
    v_exp_f32 v22, v22
    v_exp_f32 v23, v23
    v_cvt_pk_bf16_f32 v40, v16, v17
    v_cvt_pk_bf16_f32 v41, v18, v19
    v_mfma_f32_32x32x16_bf16 v[112:127], a[44:47], v[36:39], v[112:127]
    buffer_load_dwordx4 v[216:219], v245, s[8:11], s101 offen offset:0 sc1
    v_exp_f32 v24, v24
    v_exp_f32 v25, v25
    v_cvt_pk_bf16_f32 v42, v20, v21
    v_cvt_pk_bf16_f32 v43, v22, v23
    v_mfma_f32_16x16x32_bf16 a[96:99], a[112:115], v[32:35], a[96:99]
    buffer_load_dwordx4 v[220:223], v245, s[8:11], s101 offen offset:16 sc1
    v_exp_f32 v26, v26
    v_mfma_f32_16x16x32_bf16 a[96:99], a[112:115], v[36:39], a[96:99]
    v_exp_f32 v27, v27
    v_exp_f32 v28, v28
    v_exp_f32 v29, v29
    v_cvt_pk_bf16_f32 v44, v24, v25
    v_exp_f32 v30, v30
    v_cvt_pk_bf16_f32 v45, v26, v27
    v_exp_f32 v31, v31
    v_cvt_pk_bf16_f32 v46, v28, v29
    v_cvt_pk_bf16_f32 v47, v30, v31
    v_mfma_f32_32x32x16_bf16 v[16:31], a[32:35], a[88:91], v[96:111]
    v_exp_f32 v0, v0
    v_exp_f32 v1, v1
    v_exp_f32 v2, v2
    v_mfma_f32_32x32x16_bf16 v[16:31], a[36:39], a[92:95], v[16:31]
    v_exp_f32 v3, v3
    v_exp_f32 v4, v4
    v_exp_f32 v5, v5
    v_mfma_f32_32x32x16_bf16 v[128:143], a[40:43], v[40:43], v[128:143]
    v_exp_f32 v6, v6
    v_exp_f32 v7, v7
    v_cvt_pk_bf16_f32 v32, v0, v1
    v_cvt_pk_bf16_f32 v33, v2, v3
    v_mfma_f32_32x32x16_bf16 v[128:143], a[44:47], v[44:47], v[128:143]
    v_exp_f32 v8, v8
    v_exp_f32 v9, v9
    v_cvt_pk_bf16_f32 v34, v4, v5
    v_cvt_pk_bf16_f32 v35, v6, v7
    v_mfma_f32_16x16x32_bf16 a[100:103], a[112:115], v[40:43], a[100:103]
    v_exp_f32 v10, v10
    v_mfma_f32_16x16x32_bf16 a[100:103], a[112:115], v[44:47], a[100:103]
    s_waitcnt vmcnt(7)
    v_exp_f32 v11, v11
    v_exp_f32 v12, v12
    v_exp_f32 v13, v13
    v_cvt_pk_bf16_f32 v36, v8, v9
    v_exp_f32 v14, v14
    v_cvt_pk_bf16_f32 v37, v10, v11
    v_exp_f32 v15, v15
    v_cvt_pk_bf16_f32 v38, v12, v13
    v_cvt_pk_bf16_f32 v39, v14, v15
    v_mfma_f32_32x32x16_bf16 v[0:15], a[48:51], a[64:67], v[48:63]
    v_exp_f32 v16, v16
    v_exp_f32 v17, v17
    v_exp_f32 v18, v18
    v_mfma_f32_32x32x16_bf16 v[0:15], a[52:55], a[68:71], v[0:15]
    v_exp_f32 v19, v19
    v_exp_f32 v20, v20
    v_exp_f32 v21, v21
    v_mfma_f32_32x32x16_bf16 v[144:159], a[40:43], v[32:35], v[144:159]
    v_exp_f32 v22, v22
    v_exp_f32 v23, v23
    v_cvt_pk_bf16_f32 v40, v16, v17
    v_cvt_pk_bf16_f32 v41, v18, v19
    v_mfma_f32_32x32x16_bf16 v[144:159], a[44:47], v[36:39], v[144:159]
    v_exp_f32 v24, v24
    v_exp_f32 v25, v25
    v_cvt_pk_bf16_f32 v42, v20, v21
    v_cvt_pk_bf16_f32 v43, v22, v23
    v_mfma_f32_16x16x32_bf16 a[104:107], a[112:115], v[32:35], a[104:107]
    v_exp_f32 v26, v26
    v_mfma_f32_16x16x32_bf16 a[104:107], a[112:115], v[36:39], a[104:107]
    v_exp_f32 v27, v27
    v_exp_f32 v28, v28
    v_exp_f32 v29, v29
    v_cvt_pk_bf16_f32 v44, v24, v25
    v_exp_f32 v30, v30
    v_cvt_pk_bf16_f32 v45, v26, v27
    v_exp_f32 v31, v31
    v_cvt_pk_bf16_f32 v46, v28, v29
    v_cvt_pk_bf16_f32 v47, v30, v31
    v_mfma_f32_32x32x16_bf16 v[16:31], a[48:51], a[72:75], v[64:79]
    v_exp_f32 v0, v0
    v_exp_f32 v1, v1
    v_exp_f32 v2, v2
    v_mfma_f32_32x32x16_bf16 v[16:31], a[52:55], a[76:79], v[16:31]
    v_exp_f32 v3, v3
    v_exp_f32 v4, v4
    v_exp_f32 v5, v5
    v_mfma_f32_32x32x16_bf16 v[160:175], a[40:43], v[40:43], v[160:175]
    v_exp_f32 v6, v6
    v_exp_f32 v7, v7
    v_cvt_pk_bf16_f32 v32, v0, v1
    v_cvt_pk_bf16_f32 v33, v2, v3
    v_mfma_f32_32x32x16_bf16 v[160:175], a[44:47], v[44:47], v[160:175]
    v_exp_f32 v8, v8
    v_exp_f32 v9, v9
    v_cvt_pk_bf16_f32 v34, v4, v5
    v_cvt_pk_bf16_f32 v35, v6, v7
    v_mfma_f32_16x16x32_bf16 a[108:111], a[112:115], v[40:43], a[108:111]
    v_exp_f32 v10, v10
    v_mfma_f32_16x16x32_bf16 a[108:111], a[112:115], v[44:47], a[108:111]
    v_exp_f32 v11, v11
    v_exp_f32 v12, v12
    v_exp_f32 v13, v13
    v_cvt_pk_bf16_f32 v36, v8, v9
    v_exp_f32 v14, v14
    v_cvt_pk_bf16_f32 v37, v10, v11
    v_exp_f32 v15, v15
    v_cvt_pk_bf16_f32 v38, v12, v13
    v_cvt_pk_bf16_f32 v39, v14, v15
    v_mfma_f32_32x32x16_bf16 v[0:15], a[48:51], a[80:83], v[80:95]
    v_exp_f32 v16, v16
    v_exp_f32 v17, v17
    v_exp_f32 v18, v18
    v_mfma_f32_32x32x16_bf16 v[0:15], a[52:55], a[84:87], v[0:15]
    v_exp_f32 v19, v19
    v_exp_f32 v20, v20
    v_exp_f32 v21, v21
    v_mfma_f32_32x32x16_bf16 v[112:127], a[56:59], v[32:35], v[112:127]
    v_exp_f32 v22, v22
    v_exp_f32 v23, v23
    v_cvt_pk_bf16_f32 v40, v16, v17
    v_cvt_pk_bf16_f32 v41, v18, v19
    v_mfma_f32_32x32x16_bf16 v[112:127], a[60:63], v[36:39], v[112:127]
    v_exp_f32 v24, v24
    v_exp_f32 v25, v25
    v_cvt_pk_bf16_f32 v42, v20, v21
    v_cvt_pk_bf16_f32 v43, v22, v23
    v_mfma_f32_16x16x32_bf16 a[96:99], a[112:115], v[32:35], a[96:99]
    v_exp_f32 v26, v26
    v_mfma_f32_16x16x32_bf16 a[96:99], a[112:115], v[36:39], a[96:99]
    v_exp_f32 v27, v27
    v_exp_f32 v28, v28
    v_exp_f32 v29, v29
    v_cvt_pk_bf16_f32 v44, v24, v25
    v_exp_f32 v30, v30
    v_cvt_pk_bf16_f32 v45, v26, v27
    v_exp_f32 v31, v31
    v_cvt_pk_bf16_f32 v46, v28, v29
    v_cvt_pk_bf16_f32 v47, v30, v31
    v_mfma_f32_32x32x16_bf16 v[16:31], a[48:51], a[88:91], v[96:111]
    v_exp_f32 v0, v0
    v_exp_f32 v1, v1
    v_exp_f32 v2, v2
    v_mfma_f32_32x32x16_bf16 v[16:31], a[52:55], a[92:95], v[16:31]
    v_exp_f32 v3, v3
    v_exp_f32 v4, v4
    v_exp_f32 v5, v5
    v_mfma_f32_32x32x16_bf16 v[128:143], a[56:59], v[40:43], v[128:143]
    v_exp_f32 v6, v6
    v_exp_f32 v7, v7
    v_cvt_pk_bf16_f32 v32, v0, v1
    v_cvt_pk_bf16_f32 v33, v2, v3
    v_mfma_f32_32x32x16_bf16 v[128:143], a[60:63], v[44:47], v[128:143]
    v_exp_f32 v8, v8
    v_exp_f32 v9, v9
    v_cvt_pk_bf16_f32 v34, v4, v5
    v_cvt_pk_bf16_f32 v35, v6, v7
    v_mfma_f32_16x16x32_bf16 a[100:103], a[112:115], v[40:43], a[100:103]
    v_exp_f32 v10, v10
    v_mfma_f32_16x16x32_bf16 a[100:103], a[112:115], v[44:47], a[100:103]
    v_exp_f32 v11, v11
    v_exp_f32 v12, v12
    v_exp_f32 v13, v13
    v_cvt_pk_bf16_f32 v36, v8, v9
    v_exp_f32 v14, v14
    v_cvt_pk_bf16_f32 v37, v10, v11
    v_exp_f32 v15, v15
    v_cvt_pk_bf16_f32 v38, v12, v13
    v_cvt_pk_bf16_f32 v39, v14, v15
    v_exp_f32 v16, v16
    v_exp_f32 v17, v17
    v_exp_f32 v18, v18
    v_exp_f32 v19, v19
    v_exp_f32 v20, v20
    v_exp_f32 v21, v21
    v_mfma_f32_32x32x16_bf16 v[144:159], a[56:59], v[32:35], v[144:159]
    v_exp_f32 v22, v22
    v_exp_f32 v23, v23
    v_cvt_pk_bf16_f32 v40, v16, v17
    v_cvt_pk_bf16_f32 v41, v18, v19
    v_mfma_f32_32x32x16_bf16 v[144:159], a[60:63], v[36:39], v[144:159]
    v_exp_f32 v24, v24
    v_exp_f32 v25, v25
    v_cvt_pk_bf16_f32 v42, v20, v21
    v_cvt_pk_bf16_f32 v43, v22, v23
    v_mfma_f32_16x16x32_bf16 a[104:107], a[112:115], v[32:35], a[104:107]
    v_exp_f32 v26, v26
    v_mfma_f32_16x16x32_bf16 a[104:107], a[112:115], v[36:39], a[104:107]
    v_exp_f32 v27, v27
    v_exp_f32 v28, v28
    v_exp_f32 v29, v29
    v_cvt_pk_bf16_f32 v44, v24, v25
    v_exp_f32 v30, v30
    v_cvt_pk_bf16_f32 v45, v26, v27
    v_exp_f32 v31, v31
    v_cvt_pk_bf16_f32 v46, v28, v29
    v_cvt_pk_bf16_f32 v47, v30, v31
    s_nop 1
    v_mfma_f32_32x32x16_bf16 v[160:175], a[56:59], v[40:43], v[160:175]
    v_mfma_f32_32x32x16_bf16 v[160:175], a[60:63], v[44:47], v[160:175]
    v_mfma_f32_16x16x32_bf16 a[108:111], a[112:115], v[40:43], a[108:111]
    v_mfma_f32_16x16x32_bf16 a[108:111], a[112:115], v[44:47], a[108:111]
    s_nop 7
    v_mov_b32 v176, 0
    v_mov_b32 v177, 0
    v_pk_fma_f32 v[176:177], v[112:113], 0, v[176:177] op_sel_hi:[1,0,1]
    v_pk_fma_f32 v[176:177], v[114:115], 0, v[176:177] op_sel_hi:[1,0,1]
    v_pk_fma_f32 v[176:177], v[116:117], 0, v[176:177] op_sel_hi:[1,0,1]
    v_pk_fma_f32 v[176:177], v[118:119], 0, v[176:177] op_sel_hi:[1,0,1]
    v_pk_fma_f32 v[176:177], v[120:121], 0, v[176:177] op_sel_hi:[1,0,1]
    v_pk_fma_f32 v[176:177], v[122:123], 0, v[176:177] op_sel_hi:[1,0,1]
    v_pk_fma_f32 v[176:177], v[124:125], 0, v[176:177] op_sel_hi:[1,0,1]
    v_pk_fma_f32 v[176:177], v[126:127], 0, v[176:177] op_sel_hi:[1,0,1]
    v_pk_fma_f32 v[176:177], v[128:129], 0, v[176:177] op_sel_hi:[1,0,1]
    v_pk_fma_f32 v[176:177], v[130:131], 0, v[176:177] op_sel_hi:[1,0,1]
    v_pk_fma_f32 v[176:177], v[132:133], 0, v[176:177] op_sel_hi:[1,0,1]
    v_pk_fma_f32 v[176:177], v[134:135], 0, v[176:177] op_sel_hi:[1,0,1]
    v_pk_fma_f32 v[176:177], v[136:137], 0, v[176:177] op_sel_hi:[1,0,1]
    v_pk_fma_f32 v[176:177], v[138:139], 0, v[176:177] op_sel_hi:[1,0,1]
    v_pk_fma_f32 v[176:177], v[140:141], 0, v[176:177] op_sel_hi:[1,0,1]
    v_pk_fma_f32 v[176:177], v[142:143], 0, v[176:177] op_sel_hi:[1,0,1]
    v_pk_fma_f32 v[176:177], v[144:145], 0, v[176:177] op_sel_hi:[1,0,1]
    v_pk_fma_f32 v[176:177], v[146:147], 0, v[176:177] op_sel_hi:[1,0,1]
    v_pk_fma_f32 v[176:177], v[148:149], 0, v[176:177] op_sel_hi:[1,0,1]
    v_pk_fma_f32 v[176:177], v[150:151], 0, v[176:177] op_sel_hi:[1,0,1]
    v_pk_fma_f32 v[176:177], v[152:153], 0, v[176:177] op_sel_hi:[1,0,1]
    v_pk_fma_f32 v[176:177], v[154:155], 0, v[176:177] op_sel_hi:[1,0,1]
    v_pk_fma_f32 v[176:177], v[156:157], 0, v[176:177] op_sel_hi:[1,0,1]
    v_pk_fma_f32 v[176:177], v[158:159], 0, v[176:177] op_sel_hi:[1,0,1]
    v_pk_fma_f32 v[176:177], v[160:161], 0, v[176:177] op_sel_hi:[1,0,1]
    v_pk_fma_f32 v[176:177], v[162:163], 0, v[176:177] op_sel_hi:[1,0,1]
    v_pk_fma_f32 v[176:177], v[164:165], 0, v[176:177] op_sel_hi:[1,0,1]
    v_pk_fma_f32 v[176:177], v[166:167], 0, v[176:177] op_sel_hi:[1,0,1]
    v_pk_fma_f32 v[176:177], v[168:169], 0, v[176:177] op_sel_hi:[1,0,1]
    v_pk_fma_f32 v[176:177], v[170:171], 0, v[176:177] op_sel_hi:[1,0,1]
    v_pk_fma_f32 v[176:177], v[172:173], 0, v[176:177] op_sel_hi:[1,0,1]
    v_pk_fma_f32 v[176:177], v[174:175], 0, v[176:177] op_sel_hi:[1,0,1]
    v_accvgpr_read_b32 v180, a96
    v_accvgpr_read_b32 v181, a100
    v_accvgpr_read_b32 v182, a104
    v_accvgpr_read_b32 v183, a108
    v_add_f32 v176, v176, v177
    v_add_f32 v178, v180, v181
    v_add_f32 v179, v182, v183
    v_add_f32 v176, v176, v178
    v_add_f32 v176, v176, v179
    v_mov_b32 v177, 0x71800000
    v_cmp_nlt_f32 vcc, v176, v177
    s_cbranch_vccnz attn_slow
attn_merge:
    s_mul_i32 s3, s21, 9216
    s_add_u32 s3, s3, 114688
    v_add_u32 v224, s3, v241
    s_xor_b32 s4, s21, 2
    s_mul_i32 s4, s4, 9216
    s_add_u32 s4, s4, 114688
    v_add_u32 v225, s4, v241
    v_mov_b32 v184, v182
    v_mov_b32 v185, v183
    v_mov_b32 v186, v80
    v_mov_b32 v187, v96
    ds_write_b128 v224, v[184:187] offset:8192
    ds_write_b128 v224, v[144:147] offset:0
    ds_write_b128 v224, v[148:151] offset:1024
    ds_write_b128 v224, v[152:155] offset:2048
    ds_write_b128 v224, v[156:159] offset:3072
    ds_write_b128 v224, v[160:163] offset:4096
    ds_write_b128 v224, v[164:167] offset:5120
    ds_write_b128 v224, v[168:171] offset:6144
    ds_write_b128 v224, v[172:175] offset:7168
    v_bfe_u32 v228, v240, 4, 1
    v_lshlrev_b32 v228, 10, v228
    v_and_b32 v229, 15, v240
    v_lshl_add_u32 v228, v229, 4, v228
    v_lshrrev_b32 v229, 5, v240
    v_lshl_add_u32 v228, v229, 8, v228
    s_lshl_b32 s3, s22, 2
    s_lshl_b32 s4, s33, 1
    s_add_u32 s3, s3, s4
    s_lshl_b32 s3, s3, 16
    s_lshl_b32 s4, s23, 12
    s_add_u32 s3, s3, s4
    s_lshl_b32 s4, s34, 11
    s_add_u32 s3, s3, s4
    s_add_u32 s4, s3, 16777216
    s_add_u32 s5, s4, 65536
    s_waitcnt lgkmcnt(0)
    s_barrier
    ds_read_b128 v[184:187], v225 offset:8192
    ds_read_b128 v[144:147], v225 offset:0
    ds_read_b128 v[148:151], v225 offset:1024
    ds_read_b128 v[152:155], v225 offset:2048
    ds_read_b128 v[156:159], v225 offset:3072
    ds_read_b128 v[160:163], v225 offset:4096
    ds_read_b128 v[164:167], v225 offset:5120
    ds_read_b128 v[168:171], v225 offset:6144
    ds_read_b128 v[172:175], v225 offset:7168
    s_waitcnt lgkmcnt(8)
    v_min_f32 v176, v48, v186
    v_sub_f32 v177, v176, v48
    v_sub_f32 v178, v176, v186
    v_exp_f32 v177, v177
    v_exp_f32 v178, v178
    s_nop 0
    v_mul_f32 v176, v180, v177
    v_fmac_f32 v176, v184, v178
    v_rcp_f32 v176, v176
    s_nop 0
    v_mul_f32 v188, v177, v176
    v_mul_f32 v189, v178, v176
    v_min_f32 v176, v64, v187
    v_sub_f32 v177, v176, v64
    v_sub_f32 v178, v176, v187
    v_exp_f32 v177, v177
    v_exp_f32 v178, v178
    s_nop 0
    v_mul_f32 v176, v181, v177
    v_fmac_f32 v176, v185, v178
    v_rcp_f32 v176, v176
    s_nop 0
    v_mul_f32 v190, v177, v176
    v_mul_f32 v191, v178, v176
    v_pk_mul_f32 v[112:113], v[112:113], v[188:189] op_sel_hi:[1,0]
    v_pk_mul_f32 v[114:115], v[114:115], v[188:189] op_sel_hi:[1,0]
    v_pk_mul_f32 v[116:117], v[116:117], v[188:189] op_sel_hi:[1,0]
    v_pk_mul_f32 v[118:119], v[118:119], v[188:189] op_sel_hi:[1,0]
    v_pk_mul_f32 v[120:121], v[120:121], v[188:189] op_sel_hi:[1,0]
    v_pk_mul_f32 v[122:123], v[122:123], v[188:189] op_sel_hi:[1,0]
    v_pk_mul_f32 v[124:125], v[124:125], v[188:189] op_sel_hi:[1,0]
    v_pk_mul_f32 v[126:127], v[126:127], v[188:189] op_sel_hi:[1,0]
    v_pk_mul_f32 v[128:129], v[128:129], v[190:191] op_sel_hi:[1,0]
    v_pk_mul_f32 v[130:131], v[130:131], v[190:191] op_sel_hi:[1,0]
    v_pk_mul_f32 v[132:133], v[132:133], v[190:191] op_sel_hi:[1,0]
    v_pk_mul_f32 v[134:135], v[134:135], v[190:191] op_sel_hi:[1,0]
    v_pk_mul_f32 v[136:137], v[136:137], v[190:191] op_sel_hi:[1,0]
    v_pk_mul_f32 v[138:139], v[138:139], v[190:191] op_sel_hi:[1,0]
    v_pk_mul_f32 v[140:141], v[140:141], v[190:191] op_sel_hi:[1,0]
    v_pk_mul_f32 v[142:143], v[142:143], v[190:191] op_sel_hi:[1,0]
    s_waitcnt lgkmcnt(4)
    v_pk_fma_f32 v[112:113], v[144:145], v[188:189], v[112:113] op_sel:[0,1,0] op_sel_hi:[1,1,1]
    v_pk_fma_f32 v[114:115], v[146:147], v[188:189], v[114:115] op_sel:[0,1,0] op_sel_hi:[1,1,1]
    v_pk_fma_f32 v[116:117], v[148:149], v[188:189], v[116:117] op_sel:[0,1,0] op_sel_hi:[1,1,1]
    v_pk_fma_f32 v[118:119], v[150:151], v[188:189], v[118:119] op_sel:[0,1,0] op_sel_hi:[1,1,1]
    v_pk_fma_f32 v[120:121], v[152:153], v[188:189], v[120:121] op_sel:[0,1,0] op_sel_hi:[1,1,1]
    v_pk_fma_f32 v[122:123], v[154:155], v[188:189], v[122:123] op_sel:[0,1,0] op_sel_hi:[1,1,1]
    v_pk_fma_f32 v[124:125], v[156:157], v[188:189], v[124:125] op_sel:[0,1,0] op_sel_hi:[1,1,1]
    v_pk_fma_f32 v[126:127], v[158:159], v[188:189], v[126:127] op_sel:[0,1,0] op_sel_hi:[1,1,1]
    v_cvt_pk_bf16_f32 v32, v112, v113
    v_cvt_pk_bf16_f32 v33, v114, v115
    v_cvt_pk_bf16_f32 v34, v116, v117
    v_cvt_pk_bf16_f32 v35, v118, v119
    v_cvt_pk_bf16_f32 v36, v120, v121
    v_cvt_pk_bf16_f32 v37, v122, v123
    v_cvt_pk_bf16_f32 v38, v124, v125
    v_cvt_pk_bf16_f32 v39, v126, v127
    buffer_store_dwordx4 v[32:35], v228, s[8:11], s4 offen offset:0 sc1
    buffer_store_dwordx4 v[36:39], v228, s[8:11], s4 offen offset:512 sc1
    s_waitcnt lgkmcnt(0)
    v_pk_fma_f32 v[128:129], v[160:161], v[190:191], v[128:129] op_sel:[0,1,0] op_sel_hi:[1,1,1]
    v_pk_fma_f32 v[130:131], v[162:163], v[190:191], v[130:131] op_sel:[0,1,0] op_sel_hi:[1,1,1]
    v_pk_fma_f32 v[132:133], v[164:165], v[190:191], v[132:133] op_sel:[0,1,0] op_sel_hi:[1,1,1]
    v_pk_fma_f32 v[134:135], v[166:167], v[190:191], v[134:135] op_sel:[0,1,0] op_sel_hi:[1,1,1]
    v_pk_fma_f32 v[136:137], v[168:169], v[190:191], v[136:137] op_sel:[0,1,0] op_sel_hi:[1,1,1]
    v_pk_fma_f32 v[138:139], v[170:171], v[190:191], v[138:139] op_sel:[0,1,0] op_sel_hi:[1,1,1]
    v_pk_fma_f32 v[140:141], v[172:173], v[190:191], v[140:141] op_sel:[0,1,0] op_sel_hi:[1,1,1]
    v_pk_fma_f32 v[142:143], v[174:175], v[190:191], v[142:143] op_sel:[0,1,0] op_sel_hi:[1,1,1]
    v_cvt_pk_bf16_f32 v40, v128, v129
    v_cvt_pk_bf16_f32 v41, v130, v131
    v_cvt_pk_bf16_f32 v42, v132, v133
    v_cvt_pk_bf16_f32 v43, v134, v135
    v_cvt_pk_bf16_f32 v44, v136, v137
    v_cvt_pk_bf16_f32 v45, v138, v139
    v_cvt_pk_bf16_f32 v46, v140, v141
    v_cvt_pk_bf16_f32 v47, v142, v143
    buffer_store_dwordx4 v[40:43], v228, s[8:11], s5 offen offset:0 sc1
    buffer_store_dwordx4 v[44:47], v228, s[8:11], s5 offen offset:512 sc1
    v_bfe_u32 v56, v240, 2, 3
    v_lshrrev_b32 v57, 1, v56
    v_lshrrev_b32 v58, 5, v240
    v_lshl_add_u32 v56, v58, 4, v56
    v_lshlrev_b32 v56, 7, v56
    v_and_b32 v58, 3, v240
    v_lshl_add_u32 v56, v58, 3, v56
    v_xor_b32 v58, 0, v57
    v_lshl_add_u32 v44, v58, 5, v56
    v_xor_b32 v58, 1, v57
    v_lshl_add_u32 v45, v58, 5, v56
    v_xor_b32 v58, 2, v57
    v_lshl_add_u32 v46, v58, 5, v56
    v_xor_b32 v58, 3, v57
    v_lshl_add_u32 v47, v58, 5, v56
    v_and_b32 v56, 1, v240
    v_lshlrev_b32 v56, 6, v56
    v_lshrrev_b32 v57, 4, v240
    v_lshl_add_u32 v56, v57, 4, v56
    v_add_u32 v48, 151552, v56
    v_lshrrev_b32 v56, 3, v240
    v_and_b32 v58, 7, v240
    v_xor_b32 v57, v57, v58
    v_lshlrev_b32 v57, 4, v57
    v_lshl_add_u32 v49, v56, 11, v57
    v_xor_b32 v59, 64, v49
    v_add_u32 v60, 15360, v59
    v_add_u32 v61, 30720, v49
    v_add_u32 v62, 46080, v59
    v_and_b32 v56, 15, v240
    v_lshrrev_b32 v57, 1, v56
    v_lshlrev_b32 v57, 7, v57
    v_and_b32 v58, 1, v56
    v_lshl_add_u32 v63, v58, 4, v57
    s_lshl_b32 s4, s21, 6
    v_add_u32 v64, s4, v240
    v_lshrrev_b32 v56, 3, v64
    v_lshlrev_b32 v56, 7, v56
    v_bfe_u32 v57, v240, 2, 1
    v_lshl_add_u32 v56, v57, 5, v56
    v_and_b32 v57, 1, v240
    v_lshl_add_u32 v56, v57, 4, v56
    v_bfe_u32 v57, v240, 1, 1
    v_lshl_add_u32 v56, v57, 3, v56
    v_add_u32 v64, 151552, v56
    s_waitcnt vmcnt(4)
    v_xor_b32 v56, v217, v247
    v_bitop3_b32 v56, v219, v247, v56 bitop3:0xbe
    v_bitop3_b32 v56, v221, v247, v56 bitop3:0xbe
    v_bitop3_b32 v56, v223, v247, v56 bitop3:0xbe
    v_cmp_ne_u32 vcc, 0, v56
    s_cbranch_vccz mwait_ok
    s_mov_b32 s4, 0
mwait:
    buffer_load_dwordx4 v[216:219], v245, s[8:11], s101 offen offset:0 sc1
    buffer_load_dwordx4 v[220:223], v245, s[8:11], s101 offen offset:16 sc1
    s_add_u32 s4, s4, 1
    s_waitcnt vmcnt(0)
    v_xor_b32 v56, v217, v247
    v_bitop3_b32 v56, v219, v247, v56 bitop3:0xbe
    v_bitop3_b32 v56, v221, v247, v56 bitop3:0xbe
    v_bitop3_b32 v56, v223, v247, v56 bitop3:0xbe
    v_cmp_ne_u32 vcc, 0, v56
    s_cbranch_vccz mwait_ok
    s_cmp_lt_u32 s4, 2097152
    s_cbranch_scc1 mwait
mwait_ok:
    s_mov_b32 s4, 0x05040100
    s_mov_b32 s5, 0x07060302
    v_perm_b32 v56, v218, v216, s4
    v_perm_b32 v57, v222, v220, s4
    v_perm_b32 v58, v218, v216, s5
    v_perm_b32 v59, v222, v220, s5
    ds_write_b64 v64, v[56:57]
    ds_write_b64 v64, v[58:59] offset:64
    s_and_b32 s4, s21, 1
    s_mul_i32 s4, s4, 448
    v_add_u32 v234, s4, v240
    v_add_u32 v234, 0, v234
    v_mul_u32_u24 v235, 4682, v234
    v_lshrrev_b32 v235, 16, v235
    v_mul_u32_u24 v236, 14, v235
    v_sub_u32 v236, v234, v236
    v_mul_u32_u24 v235, 7168, v235
    v_lshl_add_u32 v224, v236, 4, v235
    v_add_u32 v234, s4, v240
    v_add_u32 v234, 64, v234
    v_mul_u32_u24 v235, 4682, v234
    v_lshrrev_b32 v235, 16, v235
    v_mul_u32_u24 v236, 14, v235
    v_sub_u32 v236, v234, v236
    v_mul_u32_u24 v235, 7168, v235
    v_lshl_add_u32 v225, v236, 4, v235
    v_subrev_u32 v225, 1024, v225
    v_add_u32 v234, s4, v240
    v_add_u32 v234, 128, v234
    v_mul_u32_u24 v235, 4682, v234
    v_lshrrev_b32 v235, 16, v235
    v_mul_u32_u24 v236, 14, v235
    v_sub_u32 v236, v234, v236
    v_mul_u32_u24 v235, 7168, v235
    v_lshl_add_u32 v226, v236, 4, v235
    v_subrev_u32 v226, 2048, v226
    v_add_u32 v234, s4, v240
    v_add_u32 v234, 192, v234
    v_mul_u32_u24 v235, 4682, v234
    v_lshrrev_b32 v235, 16, v235
    v_mul_u32_u24 v236, 14, v235
    v_sub_u32 v236, v234, v236
    v_mul_u32_u24 v235, 7168, v235
    v_lshl_add_u32 v227, v236, 4, v235
    v_subrev_u32 v227, 3072, v227
    v_add_u32 v234, s4, v240
    v_add_u32 v234, 256, v234
    v_mul_u32_u24 v235, 4682, v234
    v_lshrrev_b32 v235, 16, v235
    v_mul_u32_u24 v236, 14, v235
    v_sub_u32 v236, v234, v236
    v_mul_u32_u24 v235, 7168, v235
    v_lshl_add_u32 v228, v236, 4, v235
    v_add_u32 v234, s4, v240
    v_add_u32 v234, 320, v234
    v_mul_u32_u24 v235, 4682, v234
    v_lshrrev_b32 v235, 16, v235
    v_mul_u32_u24 v236, 14, v235
    v_sub_u32 v236, v234, v236
    v_mul_u32_u24 v235, 7168, v235
    v_lshl_add_u32 v229, v236, 4, v235
    v_subrev_u32 v229, 1024, v229
    v_add_u32 v234, s4, v240
    v_add_u32 v234, 384, v234
    v_mul_u32_u24 v235, 4682, v234
    v_lshrrev_b32 v235, 16, v235
    v_mul_u32_u24 v236, 14, v235
    v_sub_u32 v236, v234, v236
    v_mul_u32_u24 v235, 7168, v235
    v_lshl_add_u32 v230, v236, 4, v235
    v_subrev_u32 v230, 2048, v230
    v_lshrrev_b32 v234, 2, v240
    v_mul_u32_u24 v234, 224, v234
    v_and_b32 v235, 3, v240
    v_lshl_add_u32 v231, v235, 3, v234
    v_add_u32 v232, 57344, v231
    v_lshrrev_b32 v237, 5, v240
    v_lshlrev_b32 v237, 10, v237
    v_and_b32 v238, 31, v240
    v_lshl_add_u32 v237, v238, 4, v237
    v_add_u32 v238, 229376, v237
    s_cmp_lt_u32 s21, 2
    s_cselect_b32 s44, s56, s58
    s_cselect_b32 s45, s57, s59
    s_mov_b32 s46, 7340032
    s_and_b32 s100, s2, 1
    s_lshl_b32 s100, s100, 2
    s_bfe_u32 s4, s2, 0x20003
    s_add_u32 s100, s100, s4
    s_bfe_u32 s101, s2, 0x20001
    s_lshl_b32 s101, s101, 3
    s_lshr_b32 s4, s2, 5
    s_add_u32 s101, s101, s4
    s_mul_i32 s26, s21, 7168
    s_mul_i32 s25, s101, 224
    s_waitcnt lgkmcnt(0)
    s_lshl_b32 s3, s22, 4
    s_add_u32 s3, s3, s23
    s_lshl_b32 s3, s3, 7
    s_add_u32 s3, s3, 40402944
    s_waitcnt vmcnt(0)
    s_barrier
    buffer_store_dword v247, v246, s[8:11], s3 offen sc1
    s_mov_b32 s22, s23
    s_bfe_u32 s23, s2, 0x40003
    s_lshl_b32 s35, s22, 2
    s_add_u32 s35, s35, s21
    s_lshl_b32 s24, s35, 16
    s_lshl_b32 s4, s23, 7
    s_add_u32 s6, s24, s4
    s_add_u32 s24, s24, 16777216
    s_lshl_b32 s33, s21, 12
    s_lshl_b32 s7, s35, 11
    s_add_u32 s7, s7, 40108032
    s_lshl_b32 s28, s22, 11
    s_add_u32 s28, s28, 40402944
    ds_read_b64_tr_b16 a[0:1], v44 offset:0
    ds_read_b64_tr_b16 a[2:3], v44 offset:1024
    ds_read_b64_tr_b16 a[4:5], v45 offset:0
    ds_read_b64_tr_b16 a[6:7], v45 offset:1024
    ds_read_b64_tr_b16 a[8:9], v46 offset:0
    ds_read_b64_tr_b16 a[10:11], v46 offset:1024
    ds_read_b64_tr_b16 a[12:13], v47 offset:0
    ds_read_b64_tr_b16 a[14:15], v47 offset:1024
    ds_read_b128 a[16:19], v48 offset:0
    s_mov_b32 m0, s32
    s_add_u32 s32, s32, 8192
    buffer_load_dwordx4 v249, s[12:15], s30 offen lds
    buffer_load_dwordx4 v250, s[12:15], s30 offen offset:1024 lds
    s_add_u32 s30, s30, 131072
    s_mov_b32 m0, s32
    s_add_u32 s32, s32, 8192
    buffer_load_dwordx4 v249, s[12:15], s30 offen lds
    buffer_load_dwordx4 v250, s[12:15], s30 offen offset:1024 lds
    s_add_u32 s30, s30, 131072
    s_add_u32 m0, s33, 131072
    s_nop 0
    buffer_load_dwordx4 v49, s[16:19], s6 offen offset:0 lds
    buffer_load_dwordx4 v60, s[16:19], s6 offen offset:1024 lds
    buffer_load_dwordx4 v61, s[16:19], s6 offen offset:2048 lds
    buffer_load_dwordx4 v62, s[16:19], s6 offen offset:3072 lds
    v_and_b32 v245, 15, v240
    v_lshlrev_b32 v245, 7, v245
    s_mov_b32 s4, 0
owait:
    buffer_load_dword v100, v245, s[8:11], s28 offen sc1
    s_add_u32 s4, s4, 1
    s_waitcnt vmcnt(0)
    v_cmp_ne_u32 vcc, s29, v100
    s_cbranch_vccz owait_ok
    s_cmp_lt_u32 s4, 2097152
    s_cbranch_scc1 owait
owait_ok:
    buffer_load_dwordx4 a[40:43], v241, s[8:11], s24 offen offset:0 sc1
    buffer_load_dwordx4 a[44:47], v241, s[8:11], s24 offen offset:1024 sc1
    s_add_u32 s24, s24, 2048
    buffer_load_dwordx4 a[48:51], v241, s[8:11], s24 offen offset:0 sc1
    buffer_load_dwordx4 a[52:55], v241, s[8:11], s24 offen offset:1024 sc1
    s_add_u32 s24, s24, 2048
    buffer_load_dwordx4 a[56:59], v241, s[8:11], s24 offen offset:0 sc1
    buffer_load_dwordx4 a[60:63], v241, s[8:11], s24 offen offset:1024 sc1
    s_add_u32 s24, s24, 2048
    buffer_load_dwordx4 a[64:67], v241, s[8:11], s24 offen offset:0 sc1
    buffer_load_dwordx4 a[68:71], v241, s[8:11], s24 offen offset:1024 sc1
    s_add_u32 s24, s24, 2048
    s_waitcnt vmcnt(6) lgkmcnt(5)
    v_mfma_f32_16x16x32_bf16 v[0:3], a[0:3], a[40:43], 0
    ds_read_b64_tr_b16 a[20:21], v44 offset:4096
    v_mfma_f32_16x16x32_bf16 v[4:7], a[0:3], a[44:47], 0
    ds_read_b64_tr_b16 a[22:23], v44 offset:5120
    buffer_load_dwordx4 a[72:75], v241, s[8:11], s24 offen offset:0 sc1
    v_mfma_f32_16x16x32_bf16 v[12:15], a[4:7], a[44:47], 0
    ds_read_b64_tr_b16 a[24:25], v45 offset:4096
    buffer_load_dwordx4 a[76:79], v241, s[8:11], s24 offen offset:1024 sc1
    v_mfma_f32_16x16x32_bf16 v[8:11], a[4:7], a[40:43], 0
    ds_read_b64_tr_b16 a[26:27], v45 offset:5120
    s_add_u32 s24, s24, 2048
    s_waitcnt lgkmcnt(4)
    v_mfma_f32_16x16x32_bf16 v[16:19], a[8:11], a[40:43], 0
    ds_read_b64_tr_b16 a[28:29], v46 offset:4096
    v_mfma_f32_16x16x32_bf16 v[20:23], a[8:11], a[44:47], 0
    ds_read_b64_tr_b16 a[30:31], v46 offset:5120
    buffer_load_dwordx4 a[80:83], v241, s[8:11], s24 offen offset:0 sc1
    v_mfma_f32_16x16x32_bf16 v[28:31], a[12:15], a[44:47], 0
    ds_read_b64_tr_b16 a[32:33], v47 offset:4096
    buffer_load_dwordx4 a[84:87], v241, s[8:11], s24 offen offset:1024 sc1
    v_mfma_f32_16x16x32_bf16 v[24:27], a[12:15], a[40:43], 0
    ds_read_b64_tr_b16 a[34:35], v47 offset:5120
    s_add_u32 s24, s24, 2048
    v_mfma_f32_16x16x32_bf16 v[32:35], a[16:19], a[40:43], 0
    ds_read_b128 a[36:39], v48 offset:128
    v_mfma_f32_16x16x32_bf16 v[36:39], a[16:19], a[44:47], 0
    s_waitcnt vmcnt(8) lgkmcnt(5)
    v_mfma_f32_16x16x32_bf16 v[0:3], a[20:23], a[48:51], v[0:3]
    ds_read_b64_tr_b16 a[0:1], v44 offset:8192
    v_mfma_f32_16x16x32_bf16 v[4:7], a[20:23], a[52:55], v[4:7]
    ds_read_b64_tr_b16 a[2:3], v44 offset:9216
    buffer_load_dwordx4 a[88:91], v241, s[8:11], s24 offen offset:0 sc1
    v_mfma_f32_16x16x32_bf16 v[12:15], a[24:27], a[52:55], v[12:15]
    ds_read_b64_tr_b16 a[4:5], v45 offset:8192
    buffer_load_dwordx4 a[92:95], v241, s[8:11], s24 offen offset:1024 sc1
    v_mfma_f32_16x16x32_bf16 v[8:11], a[24:27], a[48:51], v[8:11]
    ds_read_b64_tr_b16 a[6:7], v45 offset:9216
    s_add_u32 s24, s24, 2048
    s_waitcnt lgkmcnt(4)
    v_mfma_f32_16x16x32_bf16 v[16:19], a[28:31], a[48:51], v[16:19]
    ds_read_b64_tr_b16 a[8:9], v46 offset:8192
    v_mfma_f32_16x16x32_bf16 v[20:23], a[28:31], a[52:55], v[20:23]
    ds_read_b64_tr_b16 a[10:11], v46 offset:9216
    buffer_load_dwordx4 a[96:99], v241, s[8:11], s24 offen offset:0 sc1
    v_mfma_f32_16x16x32_bf16 v[28:31], a[32:35], a[52:55], v[28:31]
    ds_read_b64_tr_b16 a[12:13], v47 offset:8192
    buffer_load_dwordx4 a[100:103], v241, s[8:11], s24 offen offset:1024 sc1
    v_mfma_f32_16x16x32_bf16 v[24:27], a[32:35], a[48:51], v[24:27]
    ds_read_b64_tr_b16 a[14:15], v47 offset:9216
    s_add_u32 s24, s24, 2048
    v_mfma_f32_16x16x32_bf16 v[32:35], a[36:39], a[48:51], v[32:35]
    ds_read_b128 a[16:19], v48 offset:256
    v_mfma_f32_16x16x32_bf16 v[36:39], a[36:39], a[52:55], v[36:39]
    s_waitcnt vmcnt(10) lgkmcnt(5)
    v_mfma_f32_16x16x32_bf16 v[0:3], a[0:3], a[56:59], v[0:3]
    ds_read_b64_tr_b16 a[20:21], v44 offset:12288
    v_mfma_f32_16x16x32_bf16 v[4:7], a[0:3], a[60:63], v[4:7]
    ds_read_b64_tr_b16 a[22:23], v44 offset:13312
    buffer_load_dwordx4 a[40:43], v241, s[8:11], s24 offen offset:0 sc1
    v_mfma_f32_16x16x32_bf16 v[12:15], a[4:7], a[60:63], v[12:15]
    ds_read_b64_tr_b16 a[24:25], v45 offset:12288
    buffer_load_dwordx4 a[44:47], v241, s[8:11], s24 offen offset:1024 sc1
    v_mfma_f32_16x16x32_bf16 v[8:11], a[4:7], a[56:59], v[8:11]
    ds_read_b64_tr_b16 a[26:27], v45 offset:13312
    s_add_u32 s24, s24, 2048
    s_waitcnt lgkmcnt(4)
    v_mfma_f32_16x16x32_bf16 v[16:19], a[8:11], a[56:59], v[16:19]
    ds_read_b64_tr_b16 a[28:29], v46 offset:12288
    v_mfma_f32_16x16x32_bf16 v[20:23], a[8:11], a[60:63], v[20:23]
    ds_read_b64_tr_b16 a[30:31], v46 offset:13312
    buffer_load_dwordx4 a[48:51], v241, s[8:11], s24 offen offset:0 sc1
    v_mfma_f32_16x16x32_bf16 v[28:31], a[12:15], a[60:63], v[28:31]
    ds_read_b64_tr_b16 a[32:33], v47 offset:12288
    buffer_load_dwordx4 a[52:55], v241, s[8:11], s24 offen offset:1024 sc1
    v_mfma_f32_16x16x32_bf16 v[24:27], a[12:15], a[56:59], v[24:27]
    ds_read_b64_tr_b16 a[34:35], v47 offset:13312
    s_add_u32 s24, s24, 2048
    v_mfma_f32_16x16x32_bf16 v[32:35], a[16:19], a[56:59], v[32:35]
    ds_read_b128 a[36:39], v48 offset:384
    v_mfma_f32_16x16x32_bf16 v[36:39], a[16:19], a[60:63], v[36:39]
    s_waitcnt vmcnt(12) lgkmcnt(5)
    v_mfma_f32_16x16x32_bf16 v[0:3], a[20:23], a[64:67], v[0:3]
    ds_read_b64_tr_b16 a[0:1], v44 offset:16384
    v_mfma_f32_16x16x32_bf16 v[4:7], a[20:23], a[68:71], v[4:7]
    ds_read_b64_tr_b16 a[2:3], v44 offset:17408
    v_mfma_f32_16x16x32_bf16 v[12:15], a[24:27], a[68:71], v[12:15]
    ds_read_b64_tr_b16 a[4:5], v45 offset:16384
    buffer_load_dwordx4 a[56:59], v241, s[8:11], s24 offen offset:0 sc1
    v_mfma_f32_16x16x32_bf16 v[8:11], a[24:27], a[64:67], v[8:11]
    ds_read_b64_tr_b16 a[6:7], v45 offset:17408
    s_waitcnt lgkmcnt(4)
    v_mfma_f32_16x16x32_bf16 v[16:19], a[28:31], a[64:67], v[16:19]
    ds_read_b64_tr_b16 a[8:9], v46 offset:16384
    v_mfma_f32_16x16x32_bf16 v[20:23], a[28:31], a[68:71], v[20:23]
    ds_read_b64_tr_b16 a[10:11], v46 offset:17408
    buffer_load_dwordx4 a[60:63], v241, s[8:11], s24 offen offset:1024 sc1
    v_mfma_f32_16x16x32_bf16 v[28:31], a[32:35], a[68:71], v[28:31]
    ds_read_b64_tr_b16 a[12:13], v47 offset:16384
    v_mfma_f32_16x16x32_bf16 v[24:27], a[32:35], a[64:67], v[24:27]
    ds_read_b64_tr_b16 a[14:15], v47 offset:17408
    s_add_u32 s24, s24, 2048
    v_mfma_f32_16x16x32_bf16 v[32:35], a[36:39], a[64:67], v[32:35]
    ds_read_b128 a[16:19], v48 offset:512
    v_mfma_f32_16x16x32_bf16 v[36:39], a[36:39], a[68:71], v[36:39]
    s_waitcnt vmcnt(12) lgkmcnt(5)
    v_mfma_f32_16x16x32_bf16 v[0:3], a[0:3], a[72:75], v[0:3]
    ds_read_b64_tr_b16 a[20:21], v44 offset:20480
    v_mfma_f32_16x16x32_bf16 v[4:7], a[0:3], a[76:79], v[4:7]
    ds_read_b64_tr_b16 a[22:23], v44 offset:21504
    v_mfma_f32_16x16x32_bf16 v[12:15], a[4:7], a[76:79], v[12:15]
    ds_read_b64_tr_b16 a[24:25], v45 offset:20480
    buffer_load_dwordx4 a[64:67], v241, s[8:11], s24 offen offset:0 sc1
    v_mfma_f32_16x16x32_bf16 v[8:11], a[4:7], a[72:75], v[8:11]
    ds_read_b64_tr_b16 a[26:27], v45 offset:21504
    s_waitcnt lgkmcnt(4)
    v_mfma_f32_16x16x32_bf16 v[16:19], a[8:11], a[72:75], v[16:19]
    ds_read_b64_tr_b16 a[28:29], v46 offset:20480
    v_mfma_f32_16x16x32_bf16 v[20:23], a[8:11], a[76:79], v[20:23]
    ds_read_b64_tr_b16 a[30:31], v46 offset:21504
    buffer_load_dwordx4 a[68:71], v241, s[8:11], s24 offen offset:1024 sc1
    v_mfma_f32_16x16x32_bf16 v[28:31], a[12:15], a[76:79], v[28:31]
    ds_read_b64_tr_b16 a[32:33], v47 offset:20480
    v_mfma_f32_16x16x32_bf16 v[24:27], a[12:15], a[72:75], v[24:27]
    ds_read_b64_tr_b16 a[34:35], v47 offset:21504
    s_add_u32 s24, s24, 2048
    v_mfma_f32_16x16x32_bf16 v[32:35], a[16:19], a[72:75], v[32:35]
    ds_read_b128 a[36:39], v48 offset:640
    v_mfma_f32_16x16x32_bf16 v[36:39], a[16:19], a[76:79], v[36:39]
    s_waitcnt vmcnt(12) lgkmcnt(5)
    v_mfma_f32_16x16x32_bf16 v[0:3], a[20:23], a[80:83], v[0:3]
    ds_read_b64_tr_b16 a[0:1], v44 offset:24576
    v_mfma_f32_16x16x32_bf16 v[4:7], a[20:23], a[84:87], v[4:7]
    ds_read_b64_tr_b16 a[2:3], v44 offset:25600
    v_mfma_f32_16x16x32_bf16 v[12:15], a[24:27], a[84:87], v[12:15]
    ds_read_b64_tr_b16 a[4:5], v45 offset:24576
    buffer_load_dwordx4 a[72:75], v241, s[8:11], s24 offen offset:0 sc1
    v_mfma_f32_16x16x32_bf16 v[8:11], a[24:27], a[80:83], v[8:11]
    ds_read_b64_tr_b16 a[6:7], v45 offset:25600
    s_waitcnt lgkmcnt(4)
    v_mfma_f32_16x16x32_bf16 v[16:19], a[28:31], a[80:83], v[16:19]
    ds_read_b64_tr_b16 a[8:9], v46 offset:24576
    v_mfma_f32_16x16x32_bf16 v[20:23], a[28:31], a[84:87], v[20:23]
    ds_read_b64_tr_b16 a[10:11], v46 offset:25600
    buffer_load_dwordx4 a[76:79], v241, s[8:11], s24 offen offset:1024 sc1
    v_mfma_f32_16x16x32_bf16 v[28:31], a[32:35], a[84:87], v[28:31]
    ds_read_b64_tr_b16 a[12:13], v47 offset:24576
    v_mfma_f32_16x16x32_bf16 v[24:27], a[32:35], a[80:83], v[24:27]
    ds_read_b64_tr_b16 a[14:15], v47 offset:25600
    s_add_u32 s24, s24, 2048
    v_mfma_f32_16x16x32_bf16 v[32:35], a[36:39], a[80:83], v[32:35]
    ds_read_b128 a[16:19], v48 offset:768
    v_mfma_f32_16x16x32_bf16 v[36:39], a[36:39], a[84:87], v[36:39]
    s_waitcnt vmcnt(12) lgkmcnt(5)
    v_mfma_f32_16x16x32_bf16 v[0:3], a[0:3], a[88:91], v[0:3]
    ds_read_b64_tr_b16 a[20:21], v44 offset:28672
    v_mfma_f32_16x16x32_bf16 v[4:7], a[0:3], a[92:95], v[4:7]
    ds_read_b64_tr_b16 a[22:23], v44 offset:29696
    v_mfma_f32_16x16x32_bf16 v[12:15], a[4:7], a[92:95], v[12:15]
    ds_read_b64_tr_b16 a[24:25], v45 offset:28672
    buffer_load_dwordx4 a[80:83], v241, s[8:11], s24 offen offset:0 sc1
    v_mfma_f32_16x16x32_bf16 v[8:11], a[4:7], a[88:91], v[8:11]
    ds_read_b64_tr_b16 a[26:27], v45 offset:29696
    s_waitcnt lgkmcnt(4)
    v_mfma_f32_16x16x32_bf16 v[16:19], a[8:11], a[88:91], v[16:19]
    ds_read_b64_tr_b16 a[28:29], v46 offset:28672
    v_mfma_f32_16x16x32_bf16 v[20:23], a[8:11], a[92:95], v[20:23]
    ds_read_b64_tr_b16 a[30:31], v46 offset:29696
    buffer_load_dwordx4 a[84:87], v241, s[8:11], s24 offen offset:1024 sc1
    v_mfma_f32_16x16x32_bf16 v[28:31], a[12:15], a[92:95], v[28:31]
    ds_read_b64_tr_b16 a[32:33], v47 offset:28672
    v_mfma_f32_16x16x32_bf16 v[24:27], a[12:15], a[88:91], v[24:27]
    ds_read_b64_tr_b16 a[34:35], v47 offset:29696
    s_add_u32 s24, s24, 2048
    v_mfma_f32_16x16x32_bf16 v[32:35], a[16:19], a[88:91], v[32:35]
    ds_read_b128 a[36:39], v48 offset:896
    v_mfma_f32_16x16x32_bf16 v[36:39], a[16:19], a[92:95], v[36:39]
    s_waitcnt vmcnt(12) lgkmcnt(5)
    v_mfma_f32_16x16x32_bf16 v[0:3], a[20:23], a[96:99], v[0:3]
    ds_read_b64_tr_b16 a[0:1], v44 offset:32768
    v_mfma_f32_16x16x32_bf16 v[4:7], a[20:23], a[100:103], v[4:7]
    ds_read_b64_tr_b16 a[2:3], v44 offset:33792
    v_mfma_f32_16x16x32_bf16 v[12:15], a[24:27], a[100:103], v[12:15]
    ds_read_b64_tr_b16 a[4:5], v45 offset:32768
    buffer_load_dwordx4 a[88:91], v241, s[8:11], s24 offen offset:0 sc1
    v_mfma_f32_16x16x32_bf16 v[8:11], a[24:27], a[96:99], v[8:11]
    ds_read_b64_tr_b16 a[6:7], v45 offset:33792
    s_waitcnt lgkmcnt(4)
    v_mfma_f32_16x16x32_bf16 v[16:19], a[28:31], a[96:99], v[16:19]
    ds_read_b64_tr_b16 a[8:9], v46 offset:32768
    v_mfma_f32_16x16x32_bf16 v[20:23], a[28:31], a[100:103], v[20:23]
    ds_read_b64_tr_b16 a[10:11], v46 offset:33792
    buffer_load_dwordx4 a[92:95], v241, s[8:11], s24 offen offset:1024 sc1
    v_mfma_f32_16x16x32_bf16 v[28:31], a[32:35], a[100:103], v[28:31]
    ds_read_b64_tr_b16 a[12:13], v47 offset:32768
    v_mfma_f32_16x16x32_bf16 v[24:27], a[32:35], a[96:99], v[24:27]
    ds_read_b64_tr_b16 a[14:15], v47 offset:33792
    s_add_u32 s24, s24, 2048
    v_mfma_f32_16x16x32_bf16 v[32:35], a[36:39], a[96:99], v[32:35]
    ds_read_b128 a[16:19], v48 offset:1024
    v_add_u32 v44, 32768, v44
    v_add_u32 v45, 32768, v45
    v_add_u32 v46, 32768, v46
    v_add_u32 v47, 32768, v47
    v_add_u32 v48, 1024, v48
    v_mfma_f32_16x16x32_bf16 v[36:39], a[36:39], a[100:103], v[36:39]
    s_waitcnt vmcnt(12) lgkmcnt(5)
    v_mfma_f32_16x16x32_bf16 v[0:3], a[0:3], a[40:43], v[0:3]
    ds_read_b64_tr_b16 a[20:21], v44 offset:4096
    v_mfma_f32_16x16x32_bf16 v[4:7], a[0:3], a[44:47], v[4:7]
    ds_read_b64_tr_b16 a[22:23], v44 offset:5120
    v_mfma_f32_16x16x32_bf16 v[12:15], a[4:7], a[44:47], v[12:15]
    ds_read_b64_tr_b16 a[24:25], v45 offset:4096
    buffer_load_dwordx4 a[96:99], v241, s[8:11], s24 offen offset:0 sc1
    v_mfma_f32_16x16x32_bf16 v[8:11], a[4:7], a[40:43], v[8:11]
    ds_read_b64_tr_b16 a[26:27], v45 offset:5120
    s_waitcnt lgkmcnt(4)
    v_mfma_f32_16x16x32_bf16 v[16:19], a[8:11], a[40:43], v[16:19]
    ds_read_b64_tr_b16 a[28:29], v46 offset:4096
    v_mfma_f32_16x16x32_bf16 v[20:23], a[8:11], a[44:47], v[20:23]
    ds_read_b64_tr_b16 a[30:31], v46 offset:5120
    buffer_load_dwordx4 a[100:103], v241, s[8:11], s24 offen offset:1024 sc1
    v_mfma_f32_16x16x32_bf16 v[28:31], a[12:15], a[44:47], v[28:31]
    ds_read_b64_tr_b16 a[32:33], v47 offset:4096
    v_mfma_f32_16x16x32_bf16 v[24:27], a[12:15], a[40:43], v[24:27]
    ds_read_b64_tr_b16 a[34:35], v47 offset:5120
    s_add_u32 s24, s24, 2048
    v_mfma_f32_16x16x32_bf16 v[32:35], a[16:19], a[40:43], v[32:35]
    ds_read_b128 a[36:39], v48 offset:128
    v_mfma_f32_16x16x32_bf16 v[36:39], a[16:19], a[44:47], v[36:39]
    s_waitcnt vmcnt(12) lgkmcnt(5)
    v_mfma_f32_16x16x32_bf16 v[0:3], a[20:23], a[48:51], v[0:3]
    ds_read_b64_tr_b16 a[0:1], v44 offset:8192
    v_mfma_f32_16x16x32_bf16 v[4:7], a[20:23], a[52:55], v[4:7]
    ds_read_b64_tr_b16 a[2:3], v44 offset:9216
    v_mfma_f32_16x16x32_bf16 v[12:15], a[24:27], a[52:55], v[12:15]
    ds_read_b64_tr_b16 a[4:5], v45 offset:8192
    buffer_load_dwordx4 a[40:43], v241, s[8:11], s24 offen offset:0 sc1
    v_mfma_f32_16x16x32_bf16 v[8:11], a[24:27], a[48:51], v[8:11]
    ds_read_b64_tr_b16 a[6:7], v45 offset:9216
    s_waitcnt lgkmcnt(4)
    v_mfma_f32_16x16x32_bf16 v[16:19], a[28:31], a[48:51], v[16:19]
    ds_read_b64_tr_b16 a[8:9], v46 offset:8192
    v_mfma_f32_16x16x32_bf16 v[20:23], a[28:31], a[52:55], v[20:23]
    ds_read_b64_tr_b16 a[10:11], v46 offset:9216
    buffer_load_dwordx4 a[44:47], v241, s[8:11], s24 offen offset:1024 sc1
    v_mfma_f32_16x16x32_bf16 v[28:31], a[32:35], a[52:55], v[28:31]
    ds_read_b64_tr_b16 a[12:13], v47 offset:8192
    v_mfma_f32_16x16x32_bf16 v[24:27], a[32:35], a[48:51], v[24:27]
    ds_read_b64_tr_b16 a[14:15], v47 offset:9216
    s_add_u32 s24, s24, 2048
    v_mfma_f32_16x16x32_bf16 v[32:35], a[36:39], a[48:51], v[32:35]
    ds_read_b128 a[16:19], v48 offset:256
    v_mfma_f32_16x16x32_bf16 v[36:39], a[36:39], a[52:55], v[36:39]
    s_waitcnt vmcnt(12) lgkmcnt(5)
    v_mfma_f32_16x16x32_bf16 v[0:3], a[0:3], a[56:59], v[0:3]
    ds_read_b64_tr_b16 a[20:21], v44 offset:12288
    v_mfma_f32_16x16x32_bf16 v[4:7], a[0:3], a[60:63], v[4:7]
    ds_read_b64_tr_b16 a[22:23], v44 offset:13312
    v_mfma_f32_16x16x32_bf16 v[12:15], a[4:7], a[60:63], v[12:15]
    ds_read_b64_tr_b16 a[24:25], v45 offset:12288
    buffer_load_dwordx4 a[48:51], v241, s[8:11], s24 offen offset:0 sc1
    v_mfma_f32_16x16x32_bf16 v[8:11], a[4:7], a[56:59], v[8:11]
    ds_read_b64_tr_b16 a[26:27], v45 offset:13312
    s_waitcnt lgkmcnt(4)
    v_mfma_f32_16x16x32_bf16 v[16:19], a[8:11], a[56:59], v[16:19]
    ds_read_b64_tr_b16 a[28:29], v46 offset:12288
    v_mfma_f32_16x16x32_bf16 v[20:23], a[8:11], a[60:63], v[20:23]
    ds_read_b64_tr_b16 a[30:31], v46 offset:13312
    buffer_load_dwordx4 a[52:55], v241, s[8:11], s24 offen offset:1024 sc1
    v_mfma_f32_16x16x32_bf16 v[28:31], a[12:15], a[60:63], v[28:31]
    ds_read_b64_tr_b16 a[32:33], v47 offset:12288
    v_mfma_f32_16x16x32_bf16 v[24:27], a[12:15], a[56:59], v[24:27]
    ds_read_b64_tr_b16 a[34:35], v47 offset:13312
    s_add_u32 s24, s24, 2048
    v_mfma_f32_16x16x32_bf16 v[32:35], a[16:19], a[56:59], v[32:35]
    ds_read_b128 a[36:39], v48 offset:384
    v_mfma_f32_16x16x32_bf16 v[36:39], a[16:19], a[60:63], v[36:39]
    s_waitcnt vmcnt(12) lgkmcnt(5)
    v_mfma_f32_16x16x32_bf16 v[0:3], a[20:23], a[64:67], v[0:3]
    ds_read_b64_tr_b16 a[0:1], v44 offset:16384
    v_mfma_f32_16x16x32_bf16 v[4:7], a[20:23], a[68:71], v[4:7]
    ds_read_b64_tr_b16 a[2:3], v44 offset:17408
    v_mfma_f32_16x16x32_bf16 v[12:15], a[24:27], a[68:71], v[12:15]
    ds_read_b64_tr_b16 a[4:5], v45 offset:16384
    buffer_load_dwordx4 a[56:59], v241, s[8:11], s24 offen offset:0 sc1
    v_mfma_f32_16x16x32_bf16 v[8:11], a[24:27], a[64:67], v[8:11]
    ds_read_b64_tr_b16 a[6:7], v45 offset:17408
    s_waitcnt lgkmcnt(4)
    v_mfma_f32_16x16x32_bf16 v[16:19], a[28:31], a[64:67], v[16:19]
    ds_read_b64_tr_b16 a[8:9], v46 offset:16384
    v_mfma_f32_16x16x32_bf16 v[20:23], a[28:31], a[68:71], v[20:23]
    ds_read_b64_tr_b16 a[10:11], v46 offset:17408
    buffer_load_dwordx4 a[60:63], v241, s[8:11], s24 offen offset:1024 sc1
    v_mfma_f32_16x16x32_bf16 v[28:31], a[32:35], a[68:71], v[28:31]
    ds_read_b64_tr_b16 a[12:13], v47 offset:16384
    v_mfma_f32_16x16x32_bf16 v[24:27], a[32:35], a[64:67], v[24:27]
    ds_read_b64_tr_b16 a[14:15], v47 offset:17408
    s_add_u32 s24, s24, 2048
    v_mfma_f32_16x16x32_bf16 v[32:35], a[36:39], a[64:67], v[32:35]
    ds_read_b128 a[16:19], v48 offset:512
    v_mfma_f32_16x16x32_bf16 v[36:39], a[36:39], a[68:71], v[36:39]
    s_waitcnt vmcnt(12) lgkmcnt(5)
    v_mfma_f32_16x16x32_bf16 v[0:3], a[0:3], a[72:75], v[0:3]
    ds_read_b64_tr_b16 a[20:21], v44 offset:20480
    v_mfma_f32_16x16x32_bf16 v[4:7], a[0:3], a[76:79], v[4:7]
    ds_read_b64_tr_b16 a[22:23], v44 offset:21504
    v_mfma_f32_16x16x32_bf16 v[12:15], a[4:7], a[76:79], v[12:15]
    ds_read_b64_tr_b16 a[24:25], v45 offset:20480
    buffer_load_dwordx4 a[64:67], v241, s[8:11], s24 offen offset:0 sc1
    v_mfma_f32_16x16x32_bf16 v[8:11], a[4:7], a[72:75], v[8:11]
    ds_read_b64_tr_b16 a[26:27], v45 offset:21504
    s_waitcnt lgkmcnt(4)
    v_mfma_f32_16x16x32_bf16 v[16:19], a[8:11], a[72:75], v[16:19]
    ds_read_b64_tr_b16 a[28:29], v46 offset:20480
    v_mfma_f32_16x16x32_bf16 v[20:23], a[8:11], a[76:79], v[20:23]
    ds_read_b64_tr_b16 a[30:31], v46 offset:21504
    buffer_load_dwordx4 a[68:71], v241, s[8:11], s24 offen offset:1024 sc1
    v_mfma_f32_16x16x32_bf16 v[28:31], a[12:15], a[76:79], v[28:31]
    ds_read_b64_tr_b16 a[32:33], v47 offset:20480
    v_mfma_f32_16x16x32_bf16 v[24:27], a[12:15], a[72:75], v[24:27]
    ds_read_b64_tr_b16 a[34:35], v47 offset:21504
    s_add_u32 s24, s24, 2048
    v_mfma_f32_16x16x32_bf16 v[32:35], a[16:19], a[72:75], v[32:35]
    ds_read_b128 a[36:39], v48 offset:640
    v_mfma_f32_16x16x32_bf16 v[36:39], a[16:19], a[76:79], v[36:39]
    s_waitcnt vmcnt(12) lgkmcnt(5)
    v_mfma_f32_16x16x32_bf16 v[0:3], a[20:23], a[80:83], v[0:3]
    ds_read_b64_tr_b16 a[0:1], v44 offset:24576
    v_mfma_f32_16x16x32_bf16 v[4:7], a[20:23], a[84:87], v[4:7]
    ds_read_b64_tr_b16 a[2:3], v44 offset:25600
    v_mfma_f32_16x16x32_bf16 v[12:15], a[24:27], a[84:87], v[12:15]
    ds_read_b64_tr_b16 a[4:5], v45 offset:24576
    buffer_load_dwordx4 a[72:75], v241, s[8:11], s24 offen offset:0 sc1
    v_mfma_f32_16x16x32_bf16 v[8:11], a[24:27], a[80:83], v[8:11]
    ds_read_b64_tr_b16 a[6:7], v45 offset:25600
    s_waitcnt lgkmcnt(4)
    v_mfma_f32_16x16x32_bf16 v[16:19], a[28:31], a[80:83], v[16:19]
    ds_read_b64_tr_b16 a[8:9], v46 offset:24576
    v_mfma_f32_16x16x32_bf16 v[20:23], a[28:31], a[84:87], v[20:23]
    ds_read_b64_tr_b16 a[10:11], v46 offset:25600
    buffer_load_dwordx4 a[76:79], v241, s[8:11], s24 offen offset:1024 sc1
    v_mfma_f32_16x16x32_bf16 v[28:31], a[32:35], a[84:87], v[28:31]
    ds_read_b64_tr_b16 a[12:13], v47 offset:24576
    v_mfma_f32_16x16x32_bf16 v[24:27], a[32:35], a[80:83], v[24:27]
    ds_read_b64_tr_b16 a[14:15], v47 offset:25600
    s_add_u32 s24, s24, 2048
    v_mfma_f32_16x16x32_bf16 v[32:35], a[36:39], a[80:83], v[32:35]
    ds_read_b128 a[16:19], v48 offset:768
    v_mfma_f32_16x16x32_bf16 v[36:39], a[36:39], a[84:87], v[36:39]
    s_waitcnt vmcnt(12) lgkmcnt(5)
    v_mfma_f32_16x16x32_bf16 v[0:3], a[0:3], a[88:91], v[0:3]
    ds_read_b64_tr_b16 a[20:21], v44 offset:28672
    v_mfma_f32_16x16x32_bf16 v[4:7], a[0:3], a[92:95], v[4:7]
    ds_read_b64_tr_b16 a[22:23], v44 offset:29696
    v_mfma_f32_16x16x32_bf16 v[12:15], a[4:7], a[92:95], v[12:15]
    ds_read_b64_tr_b16 a[24:25], v45 offset:28672
    buffer_load_dwordx4 a[80:83], v241, s[8:11], s24 offen offset:0 sc1
    v_mfma_f32_16x16x32_bf16 v[8:11], a[4:7], a[88:91], v[8:11]
    ds_read_b64_tr_b16 a[26:27], v45 offset:29696
    s_waitcnt lgkmcnt(4)
    v_mfma_f32_16x16x32_bf16 v[16:19], a[8:11], a[88:91], v[16:19]
    ds_read_b64_tr_b16 a[28:29], v46 offset:28672
    v_mfma_f32_16x16x32_bf16 v[20:23], a[8:11], a[92:95], v[20:23]
    ds_read_b64_tr_b16 a[30:31], v46 offset:29696
    buffer_load_dwordx4 a[84:87], v241, s[8:11], s24 offen offset:1024 sc1
    v_mfma_f32_16x16x32_bf16 v[28:31], a[12:15], a[92:95], v[28:31]
    ds_read_b64_tr_b16 a[32:33], v47 offset:28672
    v_mfma_f32_16x16x32_bf16 v[24:27], a[12:15], a[88:91], v[24:27]
    ds_read_b64_tr_b16 a[34:35], v47 offset:29696
    s_add_u32 s24, s24, 2048
    v_mfma_f32_16x16x32_bf16 v[32:35], a[16:19], a[88:91], v[32:35]
    ds_read_b128 a[36:39], v48 offset:896
    v_mfma_f32_16x16x32_bf16 v[36:39], a[16:19], a[92:95], v[36:39]
    s_waitcnt vmcnt(12) lgkmcnt(5)
    v_mfma_f32_16x16x32_bf16 v[0:3], a[20:23], a[96:99], v[0:3]
    ds_read_b64_tr_b16 a[0:1], v44 offset:32768
    v_mfma_f32_16x16x32_bf16 v[4:7], a[20:23], a[100:103], v[4:7]
    ds_read_b64_tr_b16 a[2:3], v44 offset:33792
    v_mfma_f32_16x16x32_bf16 v[12:15], a[24:27], a[100:103], v[12:15]
    ds_read_b64_tr_b16 a[4:5], v45 offset:32768
    buffer_load_dwordx4 a[88:91], v241, s[8:11], s24 offen offset:0 sc1
    v_mfma_f32_16x16x32_bf16 v[8:11], a[24:27], a[96:99], v[8:11]
    ds_read_b64_tr_b16 a[6:7], v45 offset:33792
    s_waitcnt lgkmcnt(4)
    v_mfma_f32_16x16x32_bf16 v[16:19], a[28:31], a[96:99], v[16:19]
    ds_read_b64_tr_b16 a[8:9], v46 offset:32768
    v_mfma_f32_16x16x32_bf16 v[20:23], a[28:31], a[100:103], v[20:23]
    ds_read_b64_tr_b16 a[10:11], v46 offset:33792
    buffer_load_dwordx4 a[92:95], v241, s[8:11], s24 offen offset:1024 sc1
    v_mfma_f32_16x16x32_bf16 v[28:31], a[32:35], a[100:103], v[28:31]
    ds_read_b64_tr_b16 a[12:13], v47 offset:32768
    v_mfma_f32_16x16x32_bf16 v[24:27], a[32:35], a[96:99], v[24:27]
    ds_read_b64_tr_b16 a[14:15], v47 offset:33792
    s_add_u32 s24, s24, 2048
    v_mfma_f32_16x16x32_bf16 v[32:35], a[36:39], a[96:99], v[32:35]
    ds_read_b128 a[16:19], v48 offset:1024
    v_add_u32 v44, 32768, v44
    v_add_u32 v45, 32768, v45
    v_add_u32 v46, 32768, v46
    v_add_u32 v47, 32768, v47
    v_add_u32 v48, 1024, v48
    v_mfma_f32_16x16x32_bf16 v[36:39], a[36:39], a[100:103], v[36:39]
    s_waitcnt vmcnt(12) lgkmcnt(5)
    v_mfma_f32_16x16x32_bf16 v[0:3], a[0:3], a[40:43], v[0:3]
    ds_read_b64_tr_b16 a[20:21], v44 offset:4096
    v_mfma_f32_16x16x32_bf16 v[4:7], a[0:3], a[44:47], v[4:7]
    ds_read_b64_tr_b16 a[22:23], v44 offset:5120
    buffer_load_dwordx4 a[96:99], v241, s[8:11], s24 offen offset:0 sc1
    v_mfma_f32_16x16x32_bf16 v[12:15], a[4:7], a[44:47], v[12:15]
    ds_read_b64_tr_b16 a[24:25], v45 offset:4096
    v_mfma_f32_16x16x32_bf16 v[8:11], a[4:7], a[40:43], v[8:11]
    ds_read_b64_tr_b16 a[26:27], v45 offset:5120
    buffer_load_dwordx4 a[100:103], v241, s[8:11], s24 offen offset:1024 sc1
    s_waitcnt lgkmcnt(4)
    v_mfma_f32_16x16x32_bf16 v[16:19], a[8:11], a[40:43], v[16:19]
    ds_read_b64_tr_b16 a[28:29], v46 offset:4096
    s_add_u32 s24, s24, 2048
    v_mfma_f32_16x16x32_bf16 v[20:23], a[8:11], a[44:47], v[20:23]
    ds_read_b64_tr_b16 a[30:31], v46 offset:5120
    v_mfma_f32_16x16x32_bf16 v[28:31], a[12:15], a[44:47], v[28:31]
    ds_read_b64_tr_b16 a[32:33], v47 offset:4096
    buffer_load_dword v50, v63, s[8:11], s7 offen offset:0 sc1
    v_mfma_f32_16x16x32_bf16 v[24:27], a[12:15], a[40:43], v[24:27]
    ds_read_b64_tr_b16 a[34:35], v47 offset:5120
    buffer_load_dword v51, v63, s[8:11], s7 offen offset:1024 sc1
    v_mfma_f32_16x16x32_bf16 v[32:35], a[16:19], a[40:43], v[32:35]
    ds_read_b128 a[36:39], v48 offset:128
    v_mfma_f32_16x16x32_bf16 v[36:39], a[16:19], a[44:47], v[36:39]
    s_waitcnt vmcnt(14) lgkmcnt(5)
    v_mfma_f32_16x16x32_bf16 v[0:3], a[20:23], a[48:51], v[0:3]
    ds_read_b64_tr_b16 a[0:1], v44 offset:8192
    v_mfma_f32_16x16x32_bf16 v[4:7], a[20:23], a[52:55], v[4:7]
    ds_read_b64_tr_b16 a[2:3], v44 offset:9216
    v_mfma_f32_16x16x32_bf16 v[12:15], a[24:27], a[52:55], v[12:15]
    ds_read_b64_tr_b16 a[4:5], v45 offset:8192
    buffer_load_dwordx4 a[40:43], v241, s[8:11], s24 offen offset:0 sc1
    v_mfma_f32_16x16x32_bf16 v[8:11], a[24:27], a[48:51], v[8:11]
    ds_read_b64_tr_b16 a[6:7], v45 offset:9216
    s_waitcnt lgkmcnt(4)
    v_mfma_f32_16x16x32_bf16 v[16:19], a[28:31], a[48:51], v[16:19]
    ds_read_b64_tr_b16 a[8:9], v46 offset:8192
    v_mfma_f32_16x16x32_bf16 v[20:23], a[28:31], a[52:55], v[20:23]
    ds_read_b64_tr_b16 a[10:11], v46 offset:9216
    buffer_load_dwordx4 a[44:47], v241, s[8:11], s24 offen offset:1024 sc1
    v_mfma_f32_16x16x32_bf16 v[28:31], a[32:35], a[52:55], v[28:31]
    ds_read_b64_tr_b16 a[12:13], v47 offset:8192
    v_mfma_f32_16x16x32_bf16 v[24:27], a[32:35], a[48:51], v[24:27]
    ds_read_b64_tr_b16 a[14:15], v47 offset:9216
    s_add_u32 s24, s24, 2048
    v_mfma_f32_16x16x32_bf16 v[32:35], a[36:39], a[48:51], v[32:35]
    ds_read_b128 a[16:19], v48 offset:256
    v_mfma_f32_16x16x32_bf16 v[36:39], a[36:39], a[52:55], v[36:39]
    s_waitcnt vmcnt(14) lgkmcnt(5)
    v_mfma_f32_16x16x32_bf16 v[0:3], a[0:3], a[56:59], v[0:3]
    ds_read_b64_tr_b16 a[20:21], v44 offset:12288
    v_mfma_f32_16x16x32_bf16 v[4:7], a[0:3], a[60:63], v[4:7]
    ds_read_b64_tr_b16 a[22:23], v44 offset:13312
    v_mfma_f32_16x16x32_bf16 v[12:15], a[4:7], a[60:63], v[12:15]
    ds_read_b64_tr_b16 a[24:25], v45 offset:12288
    buffer_load_dwordx4 a[48:51], v241, s[8:11], s24 offen offset:0 sc1
    v_mfma_f32_16x16x32_bf16 v[8:11], a[4:7], a[56:59], v[8:11]
    ds_read_b64_tr_b16 a[26:27], v45 offset:13312
    s_waitcnt lgkmcnt(4)
    v_mfma_f32_16x16x32_bf16 v[16:19], a[8:11], a[56:59], v[16:19]
    ds_read_b64_tr_b16 a[28:29], v46 offset:12288
    v_mfma_f32_16x16x32_bf16 v[20:23], a[8:11], a[60:63], v[20:23]
    ds_read_b64_tr_b16 a[30:31], v46 offset:13312
    buffer_load_dwordx4 a[52:55], v241, s[8:11], s24 offen offset:1024 sc1
    v_mfma_f32_16x16x32_bf16 v[28:31], a[12:15], a[60:63], v[28:31]
    ds_read_b64_tr_b16 a[32:33], v47 offset:12288
    v_mfma_f32_16x16x32_bf16 v[24:27], a[12:15], a[56:59], v[24:27]
    ds_read_b64_tr_b16 a[34:35], v47 offset:13312
    s_add_u32 s24, s24, 2048
    v_mfma_f32_16x16x32_bf16 v[32:35], a[16:19], a[56:59], v[32:35]
    ds_read_b128 a[36:39], v48 offset:384
    v_mfma_f32_16x16x32_bf16 v[36:39], a[16:19], a[60:63], v[36:39]
    s_waitcnt vmcnt(14) lgkmcnt(5)
    v_mfma_f32_16x16x32_bf16 v[0:3], a[20:23], a[64:67], v[0:3]
    ds_read_b64_tr_b16 a[0:1], v44 offset:16384
    v_mfma_f32_16x16x32_bf16 v[4:7], a[20:23], a[68:71], v[4:7]
    ds_read_b64_tr_b16 a[2:3], v44 offset:17408
    v_mfma_f32_16x16x32_bf16 v[12:15], a[24:27], a[68:71], v[12:15]
    ds_read_b64_tr_b16 a[4:5], v45 offset:16384
    buffer_load_dwordx4 a[56:59], v241, s[8:11], s24 offen offset:0 sc1
    v_mfma_f32_16x16x32_bf16 v[8:11], a[24:27], a[64:67], v[8:11]
    ds_read_b64_tr_b16 a[6:7], v45 offset:17408
    s_waitcnt lgkmcnt(4)
    v_mfma_f32_16x16x32_bf16 v[16:19], a[28:31], a[64:67], v[16:19]
    ds_read_b64_tr_b16 a[8:9], v46 offset:16384
    v_mfma_f32_16x16x32_bf16 v[20:23], a[28:31], a[68:71], v[20:23]
    ds_read_b64_tr_b16 a[10:11], v46 offset:17408
    buffer_load_dwordx4 a[60:63], v241, s[8:11], s24 offen offset:1024 sc1
    v_mfma_f32_16x16x32_bf16 v[28:31], a[32:35], a[68:71], v[28:31]
    ds_read_b64_tr_b16 a[12:13], v47 offset:16384
    v_mfma_f32_16x16x32_bf16 v[24:27], a[32:35], a[64:67], v[24:27]
    ds_read_b64_tr_b16 a[14:15], v47 offset:17408
    s_add_u32 s24, s24, 2048
    v_mfma_f32_16x16x32_bf16 v[32:35], a[36:39], a[64:67], v[32:35]
    ds_read_b128 a[16:19], v48 offset:512
    v_mfma_f32_16x16x32_bf16 v[36:39], a[36:39], a[68:71], v[36:39]
    s_waitcnt vmcnt(14) lgkmcnt(5)
    v_mfma_f32_16x16x32_bf16 v[0:3], a[0:3], a[72:75], v[0:3]
    ds_read_b64_tr_b16 a[20:21], v44 offset:20480
    v_mfma_f32_16x16x32_bf16 v[4:7], a[0:3], a[76:79], v[4:7]
    ds_read_b64_tr_b16 a[22:23], v44 offset:21504
    v_mfma_f32_16x16x32_bf16 v[12:15], a[4:7], a[76:79], v[12:15]
    ds_read_b64_tr_b16 a[24:25], v45 offset:20480
    buffer_load_dwordx4 a[64:67], v241, s[8:11], s24 offen offset:0 sc1
    v_mfma_f32_16x16x32_bf16 v[8:11], a[4:7], a[72:75], v[8:11]
    ds_read_b64_tr_b16 a[26:27], v45 offset:21504
    s_waitcnt lgkmcnt(4)
    v_mfma_f32_16x16x32_bf16 v[16:19], a[8:11], a[72:75], v[16:19]
    ds_read_b64_tr_b16 a[28:29], v46 offset:20480
    v_mfma_f32_16x16x32_bf16 v[20:23], a[8:11], a[76:79], v[20:23]
    ds_read_b64_tr_b16 a[30:31], v46 offset:21504
    buffer_load_dwordx4 a[68:71], v241, s[8:11], s24 offen offset:1024 sc1
    v_mfma_f32_16x16x32_bf16 v[28:31], a[12:15], a[76:79], v[28:31]
    ds_read_b64_tr_b16 a[32:33], v47 offset:20480
    v_mfma_f32_16x16x32_bf16 v[24:27], a[12:15], a[72:75], v[24:27]
    ds_read_b64_tr_b16 a[34:35], v47 offset:21504
    s_add_u32 s24, s24, 2048
    v_mfma_f32_16x16x32_bf16 v[32:35], a[16:19], a[72:75], v[32:35]
    ds_read_b128 a[36:39], v48 offset:640
    v_mfma_f32_16x16x32_bf16 v[36:39], a[16:19], a[76:79], v[36:39]
    s_waitcnt vmcnt(14) lgkmcnt(5)
    v_mfma_f32_16x16x32_bf16 v[0:3], a[20:23], a[80:83], v[0:3]
    ds_read_b64_tr_b16 a[0:1], v44 offset:24576
    v_mfma_f32_16x16x32_bf16 v[4:7], a[20:23], a[84:87], v[4:7]
    ds_read_b64_tr_b16 a[2:3], v44 offset:25600
    v_mfma_f32_16x16x32_bf16 v[12:15], a[24:27], a[84:87], v[12:15]
    ds_read_b64_tr_b16 a[4:5], v45 offset:24576
    buffer_load_dwordx4 a[72:75], v241, s[8:11], s24 offen offset:0 sc1
    v_mfma_f32_16x16x32_bf16 v[8:11], a[24:27], a[80:83], v[8:11]
    ds_read_b64_tr_b16 a[6:7], v45 offset:25600
    s_waitcnt lgkmcnt(4)
    v_mfma_f32_16x16x32_bf16 v[16:19], a[28:31], a[80:83], v[16:19]
    ds_read_b64_tr_b16 a[8:9], v46 offset:24576
    v_mfma_f32_16x16x32_bf16 v[20:23], a[28:31], a[84:87], v[20:23]
    ds_read_b64_tr_b16 a[10:11], v46 offset:25600
    buffer_load_dwordx4 a[76:79], v241, s[8:11], s24 offen offset:1024 sc1
    v_mfma_f32_16x16x32_bf16 v[28:31], a[32:35], a[84:87], v[28:31]
    ds_read_b64_tr_b16 a[12:13], v47 offset:24576
    v_mfma_f32_16x16x32_bf16 v[24:27], a[32:35], a[80:83], v[24:27]
    ds_read_b64_tr_b16 a[14:15], v47 offset:25600
    s_add_u32 s24, s24, 2048
    v_mfma_f32_16x16x32_bf16 v[32:35], a[36:39], a[80:83], v[32:35]
    ds_read_b128 a[16:19], v48 offset:768
    v_mfma_f32_16x16x32_bf16 v[36:39], a[36:39], a[84:87], v[36:39]
    s_waitcnt vmcnt(14) lgkmcnt(5)
    v_mfma_f32_16x16x32_bf16 v[0:3], a[0:3], a[88:91], v[0:3]
    ds_read_b64_tr_b16 a[20:21], v44 offset:28672
    v_mfma_f32_16x16x32_bf16 v[4:7], a[0:3], a[92:95], v[4:7]
    ds_read_b64_tr_b16 a[22:23], v44 offset:29696
    v_mfma_f32_16x16x32_bf16 v[12:15], a[4:7], a[92:95], v[12:15]
    ds_read_b64_tr_b16 a[24:25], v45 offset:28672
    buffer_load_dwordx4 a[80:83], v241, s[8:11], s24 offen offset:0 sc1
    v_mfma_f32_16x16x32_bf16 v[8:11], a[4:7], a[88:91], v[8:11]
    ds_read_b64_tr_b16 a[26:27], v45 offset:29696
    s_waitcnt lgkmcnt(4)
    v_mfma_f32_16x16x32_bf16 v[16:19], a[8:11], a[88:91], v[16:19]
    ds_read_b64_tr_b16 a[28:29], v46 offset:28672
    v_mfma_f32_16x16x32_bf16 v[20:23], a[8:11], a[92:95], v[20:23]
    ds_read_b64_tr_b16 a[30:31], v46 offset:29696
    buffer_load_dwordx4 a[84:87], v241, s[8:11], s24 offen offset:1024 sc1
    v_mfma_f32_16x16x32_bf16 v[28:31], a[12:15], a[92:95], v[28:31]
    ds_read_b64_tr_b16 a[32:33], v47 offset:28672
    v_mfma_f32_16x16x32_bf16 v[24:27], a[12:15], a[88:91], v[24:27]
    ds_read_b64_tr_b16 a[34:35], v47 offset:29696
    s_add_u32 s24, s24, 2048
    v_mfma_f32_16x16x32_bf16 v[32:35], a[16:19], a[88:91], v[32:35]
    ds_read_b128 a[36:39], v48 offset:896
    v_mfma_f32_16x16x32_bf16 v[36:39], a[16:19], a[92:95], v[36:39]
    s_waitcnt vmcnt(14) lgkmcnt(5)
    v_mfma_f32_16x16x32_bf16 v[0:3], a[20:23], a[96:99], v[0:3]
    ds_read_b64_tr_b16 a[0:1], v44 offset:32768
    v_mfma_f32_16x16x32_bf16 v[4:7], a[20:23], a[100:103], v[4:7]
    ds_read_b64_tr_b16 a[2:3], v44 offset:33792
    v_mfma_f32_16x16x32_bf16 v[12:15], a[24:27], a[100:103], v[12:15]
    ds_read_b64_tr_b16 a[4:5], v45 offset:32768
    buffer_load_dwordx4 a[88:91], v241, s[8:11], s24 offen offset:0 sc1
    v_mfma_f32_16x16x32_bf16 v[8:11], a[24:27], a[96:99], v[8:11]
    ds_read_b64_tr_b16 a[6:7], v45 offset:33792
    s_waitcnt lgkmcnt(4)
    v_mfma_f32_16x16x32_bf16 v[16:19], a[28:31], a[96:99], v[16:19]
    ds_read_b64_tr_b16 a[8:9], v46 offset:32768
    v_mfma_f32_16x16x32_bf16 v[20:23], a[28:31], a[100:103], v[20:23]
    ds_read_b64_tr_b16 a[10:11], v46 offset:33792
    buffer_load_dwordx4 a[92:95], v241, s[8:11], s24 offen offset:1024 sc1
    v_mfma_f32_16x16x32_bf16 v[28:31], a[32:35], a[100:103], v[28:31]
    ds_read_b64_tr_b16 a[12:13], v47 offset:32768
    v_mfma_f32_16x16x32_bf16 v[24:27], a[32:35], a[96:99], v[24:27]
    ds_read_b64_tr_b16 a[14:15], v47 offset:33792
    s_add_u32 s24, s24, 2048
    v_mfma_f32_16x16x32_bf16 v[32:35], a[36:39], a[96:99], v[32:35]
    ds_read_b128 a[16:19], v48 offset:1024
    v_add_u32 v44, 32768, v44
    v_add_u32 v45, 32768, v45
    v_add_u32 v46, 32768, v46
    v_add_u32 v47, 32768, v47
    v_add_u32 v48, 1024, v48
    v_mfma_f32_16x16x32_bf16 v[36:39], a[36:39], a[100:103], v[36:39]
    s_waitcnt vmcnt(12) lgkmcnt(5)
    v_mfma_f32_16x16x32_bf16 v[0:3], a[0:3], a[40:43], v[0:3]
    ds_read_b64_tr_b16 a[20:21], v44 offset:4096
    v_mfma_f32_16x16x32_bf16 v[4:7], a[0:3], a[44:47], v[4:7]
    ds_read_b64_tr_b16 a[22:23], v44 offset:5120
    v_mfma_f32_16x16x32_bf16 v[12:15], a[4:7], a[44:47], v[12:15]
    ds_read_b64_tr_b16 a[24:25], v45 offset:4096
    buffer_load_dwordx4 a[96:99], v241, s[8:11], s24 offen offset:0 sc1
    v_mfma_f32_16x16x32_bf16 v[8:11], a[4:7], a[40:43], v[8:11]
    ds_read_b64_tr_b16 a[26:27], v45 offset:5120
    s_waitcnt lgkmcnt(4)
    v_mfma_f32_16x16x32_bf16 v[16:19], a[8:11], a[40:43], v[16:19]
    ds_read_b64_tr_b16 a[28:29], v46 offset:4096
    v_mfma_f32_16x16x32_bf16 v[20:23], a[8:11], a[44:47], v[20:23]
    ds_read_b64_tr_b16 a[30:31], v46 offset:5120
    buffer_load_dwordx4 a[100:103], v241, s[8:11], s24 offen offset:1024 sc1
    v_mfma_f32_16x16x32_bf16 v[28:31], a[12:15], a[44:47], v[28:31]
    ds_read_b64_tr_b16 a[32:33], v47 offset:4096
    v_mfma_f32_16x16x32_bf16 v[24:27], a[12:15], a[40:43], v[24:27]
    ds_read_b64_tr_b16 a[34:35], v47 offset:5120
    s_add_u32 s24, s24, 2048
    v_mfma_f32_16x16x32_bf16 v[32:35], a[16:19], a[40:43], v[32:35]
    ds_read_b128 a[36:39], v48 offset:128
    v_mfma_f32_16x16x32_bf16 v[36:39], a[16:19], a[44:47], v[36:39]
    s_waitcnt vmcnt(12) lgkmcnt(5)
    s_barrier
    v_mfma_f32_16x16x32_bf16 v[0:3], a[20:23], a[48:51], v[0:3]
    ds_read_b64_tr_b16 a[0:1], v44 offset:8192
    v_mfma_f32_16x16x32_bf16 v[4:7], a[20:23], a[52:55], v[4:7]
    ds_read_b64_tr_b16 a[2:3], v44 offset:9216
    v_mfma_f32_16x16x32_bf16 v[12:15], a[24:27], a[52:55], v[12:15]
    ds_read_b64_tr_b16 a[4:5], v45 offset:8192
    v_mfma_f32_16x16x32_bf16 v[8:11], a[24:27], a[48:51], v[8:11]
    ds_read_b64_tr_b16 a[6:7], v45 offset:9216
    s_waitcnt lgkmcnt(4)
    v_mfma_f32_16x16x32_bf16 v[16:19], a[28:31], a[48:51], v[16:19]
    ds_read_b64_tr_b16 a[8:9], v46 offset:8192
    v_mfma_f32_16x16x32_bf16 v[20:23], a[28:31], a[52:55], v[20:23]
    ds_read_b64_tr_b16 a[10:11], v46 offset:9216
    v_mfma_f32_16x16x32_bf16 v[28:31], a[32:35], a[52:55], v[28:31]
    ds_read_b64_tr_b16 a[12:13], v47 offset:8192
    v_mfma_f32_16x16x32_bf16 v[24:27], a[32:35], a[48:51], v[24:27]
    ds_read_b64_tr_b16 a[14:15], v47 offset:9216
    s_add_u32 m0, s26, 28672
    v_mfma_f32_16x16x32_bf16 v[32:35], a[36:39], a[48:51], v[32:35]
    ds_read_b128 a[16:19], v48 offset:256
    v_mfma_f32_16x16x32_bf16 v[36:39], a[36:39], a[52:55], v[36:39]
    s_waitcnt vmcnt(10) lgkmcnt(5)
    v_mfma_f32_16x16x32_bf16 v[0:3], a[0:3], a[56:59], v[0:3]
    ds_read_b64_tr_b16 a[20:21], v44 offset:12288
    v_mfma_f32_16x16x32_bf16 v[4:7], a[0:3], a[60:63], v[4:7]
    ds_read_b64_tr_b16 a[22:23], v44 offset:13312
    v_mfma_f32_16x16x32_bf16 v[12:15], a[4:7], a[60:63], v[12:15]
    ds_read_b64_tr_b16 a[24:25], v45 offset:12288
    v_mfma_f32_16x16x32_bf16 v[8:11], a[4:7], a[56:59], v[8:11]
    ds_read_b64_tr_b16 a[26:27], v45 offset:13312
    s_waitcnt lgkmcnt(4)
    v_mfma_f32_16x16x32_bf16 v[16:19], a[8:11], a[56:59], v[16:19]
    ds_read_b64_tr_b16 a[28:29], v46 offset:12288
    v_mfma_f32_16x16x32_bf16 v[20:23], a[8:11], a[60:63], v[20:23]
    ds_read_b64_tr_b16 a[30:31], v46 offset:13312
    v_mfma_f32_16x16x32_bf16 v[28:31], a[12:15], a[60:63], v[28:31]
    ds_read_b64_tr_b16 a[32:33], v47 offset:12288
    v_mfma_f32_16x16x32_bf16 v[24:27], a[12:15], a[56:59], v[24:27]
    ds_read_b64_tr_b16 a[34:35], v47 offset:13312
    buffer_load_dwordx4 v224, s[44:47], s25 offen offset:0 lds
    v_mfma_f32_16x16x32_bf16 v[32:35], a[16:19], a[56:59], v[32:35]
    ds_read_b128 a[36:39], v48 offset:384
    v_mfma_f32_16x16x32_bf16 v[36:39], a[16:19], a[60:63], v[36:39]
    s_waitcnt vmcnt(9) lgkmcnt(5)
    v_mfma_f32_16x16x32_bf16 v[0:3], a[20:23], a[64:67], v[0:3]
    ds_read_b64_tr_b16 a[0:1], v44 offset:16384
    v_mfma_f32_16x16x32_bf16 v[4:7], a[20:23], a[68:71], v[4:7]
    ds_read_b64_tr_b16 a[2:3], v44 offset:17408
    v_mfma_f32_16x16x32_bf16 v[12:15], a[24:27], a[68:71], v[12:15]
    ds_read_b64_tr_b16 a[4:5], v45 offset:16384
    v_mfma_f32_16x16x32_bf16 v[8:11], a[24:27], a[64:67], v[8:11]
    ds_read_b64_tr_b16 a[6:7], v45 offset:17408
    buffer_load_dwordx4 v225, s[44:47], s25 offen offset:1024 lds
    s_waitcnt lgkmcnt(4)
    v_mfma_f32_16x16x32_bf16 v[16:19], a[28:31], a[64:67], v[16:19]
    ds_read_b64_tr_b16 a[8:9], v46 offset:16384
    v_mfma_f32_16x16x32_bf16 v[20:23], a[28:31], a[68:71], v[20:23]
    ds_read_b64_tr_b16 a[10:11], v46 offset:17408
    v_mfma_f32_16x16x32_bf16 v[28:31], a[32:35], a[68:71], v[28:31]
    ds_read_b64_tr_b16 a[12:13], v47 offset:16384
    v_mfma_f32_16x16x32_bf16 v[24:27], a[32:35], a[64:67], v[24:27]
    ds_read_b64_tr_b16 a[14:15], v47 offset:17408
    buffer_load_dwordx4 v226, s[44:47], s25 offen offset:2048 lds
    v_mfma_f32_16x16x32_bf16 v[32:35], a[36:39], a[64:67], v[32:35]
    ds_read_b128 a[16:19], v48 offset:512
    v_mfma_f32_16x16x32_bf16 v[36:39], a[36:39], a[68:71], v[36:39]
    s_waitcnt vmcnt(9) lgkmcnt(5)
    v_mfma_f32_16x16x32_bf16 v[0:3], a[0:3], a[72:75], v[0:3]
    ds_read_b64_tr_b16 a[20:21], v44 offset:20480
    v_mfma_f32_16x16x32_bf16 v[4:7], a[0:3], a[76:79], v[4:7]
    ds_read_b64_tr_b16 a[22:23], v44 offset:21504
    v_mfma_f32_16x16x32_bf16 v[12:15], a[4:7], a[76:79], v[12:15]
    ds_read_b64_tr_b16 a[24:25], v45 offset:20480
    v_mfma_f32_16x16x32_bf16 v[8:11], a[4:7], a[72:75], v[8:11]
    ds_read_b64_tr_b16 a[26:27], v45 offset:21504
    s_waitcnt lgkmcnt(4)
    v_mfma_f32_16x16x32_bf16 v[16:19], a[8:11], a[72:75], v[16:19]
    ds_read_b64_tr_b16 a[28:29], v46 offset:20480
    v_mfma_f32_16x16x32_bf16 v[20:23], a[8:11], a[76:79], v[20:23]
    ds_read_b64_tr_b16 a[30:31], v46 offset:21504
    v_mfma_f32_16x16x32_bf16 v[28:31], a[12:15], a[76:79], v[28:31]
    ds_read_b64_tr_b16 a[32:33], v47 offset:20480
    v_mfma_f32_16x16x32_bf16 v[24:27], a[12:15], a[72:75], v[24:27]
    ds_read_b64_tr_b16 a[34:35], v47 offset:21504
    buffer_load_dwordx4 v227, s[44:47], s25 offen offset:3072 lds
    v_mfma_f32_16x16x32_bf16 v[32:35], a[16:19], a[72:75], v[32:35]
    ds_read_b128 a[36:39], v48 offset:640
    v_mfma_f32_16x16x32_bf16 v[36:39], a[16:19], a[76:79], v[36:39]
    s_waitcnt vmcnt(8) lgkmcnt(5)
    v_mfma_f32_16x16x32_bf16 v[0:3], a[20:23], a[80:83], v[0:3]
    ds_read_b64_tr_b16 a[0:1], v44 offset:24576
    v_mfma_f32_16x16x32_bf16 v[4:7], a[20:23], a[84:87], v[4:7]
    ds_read_b64_tr_b16 a[2:3], v44 offset:25600
    v_mfma_f32_16x16x32_bf16 v[12:15], a[24:27], a[84:87], v[12:15]
    ds_read_b64_tr_b16 a[4:5], v45 offset:24576
    v_mfma_f32_16x16x32_bf16 v[8:11], a[24:27], a[80:83], v[8:11]
    ds_read_b64_tr_b16 a[6:7], v45 offset:25600
    s_add_u32 m0, s26, 32768
    s_waitcnt lgkmcnt(4)
    v_mfma_f32_16x16x32_bf16 v[16:19], a[28:31], a[80:83], v[16:19]
    ds_read_b64_tr_b16 a[8:9], v46 offset:24576
    v_mfma_f32_16x16x32_bf16 v[20:23], a[28:31], a[84:87], v[20:23]
    ds_read_b64_tr_b16 a[10:11], v46 offset:25600
    v_mfma_f32_16x16x32_bf16 v[28:31], a[32:35], a[84:87], v[28:31]
    ds_read_b64_tr_b16 a[12:13], v47 offset:24576
    v_mfma_f32_16x16x32_bf16 v[24:27], a[32:35], a[80:83], v[24:27]
    ds_read_b64_tr_b16 a[14:15], v47 offset:25600
    buffer_load_dwordx4 v228, s[44:47], s25 offen offset:0 lds
    v_mfma_f32_16x16x32_bf16 v[32:35], a[36:39], a[80:83], v[32:35]
    ds_read_b128 a[16:19], v48 offset:768
    v_mfma_f32_16x16x32_bf16 v[36:39], a[36:39], a[84:87], v[36:39]
    s_waitcnt vmcnt(7) lgkmcnt(5)
    v_mfma_f32_16x16x32_bf16 v[0:3], a[0:3], a[88:91], v[0:3]
    ds_read_b64_tr_b16 a[20:21], v44 offset:28672
    v_mfma_f32_16x16x32_bf16 v[4:7], a[0:3], a[92:95], v[4:7]
    ds_read_b64_tr_b16 a[22:23], v44 offset:29696
    v_mfma_f32_16x16x32_bf16 v[12:15], a[4:7], a[92:95], v[12:15]
    ds_read_b64_tr_b16 a[24:25], v45 offset:28672
    v_mfma_f32_16x16x32_bf16 v[8:11], a[4:7], a[88:91], v[8:11]
    ds_read_b64_tr_b16 a[26:27], v45 offset:29696
    s_waitcnt lgkmcnt(4)
    v_mfma_f32_16x16x32_bf16 v[16:19], a[8:11], a[88:91], v[16:19]
    ds_read_b64_tr_b16 a[28:29], v46 offset:28672
    v_mfma_f32_16x16x32_bf16 v[20:23], a[8:11], a[92:95], v[20:23]
    ds_read_b64_tr_b16 a[30:31], v46 offset:29696
    v_mfma_f32_16x16x32_bf16 v[28:31], a[12:15], a[92:95], v[28:31]
    ds_read_b64_tr_b16 a[32:33], v47 offset:28672
    v_mfma_f32_16x16x32_bf16 v[24:27], a[12:15], a[88:91], v[24:27]
    ds_read_b64_tr_b16 a[34:35], v47 offset:29696
    buffer_load_dwordx4 v229, s[44:47], s25 offen offset:1024 lds
    v_mfma_f32_16x16x32_bf16 v[32:35], a[16:19], a[88:91], v[32:35]
    ds_read_b128 a[36:39], v48 offset:896
    v_mfma_f32_16x16x32_bf16 v[36:39], a[16:19], a[92:95], v[36:39]
    s_waitcnt vmcnt(6) lgkmcnt(5)
    v_mfma_f32_16x16x32_bf16 v[0:3], a[20:23], a[96:99], v[0:3]
    v_mfma_f32_16x16x32_bf16 v[4:7], a[20:23], a[100:103], v[4:7]
    v_mfma_f32_16x16x32_bf16 v[12:15], a[24:27], a[100:103], v[12:15]
    v_mfma_f32_16x16x32_bf16 v[8:11], a[24:27], a[96:99], v[8:11]
    buffer_load_dwordx4 v230, s[44:47], s25 offen offset:2048 lds
    s_waitcnt lgkmcnt(0)
    v_mfma_f32_16x16x32_bf16 v[16:19], a[28:31], a[96:99], v[16:19]
    v_mfma_f32_16x16x32_bf16 v[20:23], a[28:31], a[100:103], v[20:23]
    v_mfma_f32_16x16x32_bf16 v[28:31], a[32:35], a[100:103], v[28:31]
    v_mfma_f32_16x16x32_bf16 v[24:27], a[32:35], a[96:99], v[24:27]
    s_add_u32 s25, s25, 458752
    v_mfma_f32_16x16x32_bf16 v[32:35], a[36:39], a[96:99], v[32:35]
    v_mfma_f32_16x16x32_bf16 v[36:39], a[36:39], a[100:103], v[36:39]
    v_and_b32 v56, 15, v240
    v_lshrrev_b32 v57, 1, v56
    v_lshrrev_b32 v58, 5, v240
    v_xor_b32 v57, v57, v58
    v_lshlrev_b32 v56, 7, v56
    v_bfe_u32 v58, v240, 4, 1
    v_lshl_add_u32 v56, v58, 3, v56
    s_add_u32 s4, s33, 131072
    v_add_u32 v56, s4, v56
    v_xor_b32 v58, 0, v57
    v_lshl_add_u32 v58, v58, 4, v56
    ds_read_b64 v[66:67], v58 offset:0
    ds_read_b64 v[68:69], v58 offset:2048
    v_xor_b32 v58, 2, v57
    v_lshl_add_u32 v58, v58, 4, v56
    ds_read_b64 v[70:71], v58 offset:0
    ds_read_b64 v[72:73], v58 offset:2048
    v_xor_b32 v58, 4, v57
    v_lshl_add_u32 v58, v58, 4, v56
    ds_read_b64 v[74:75], v58 offset:0
    ds_read_b64 v[76:77], v58 offset:2048
    v_xor_b32 v58, 6, v57
    v_lshl_add_u32 v58, v58, 4, v56
    ds_read_b64 v[78:79], v58 offset:0
    ds_read_b64 v[80:81], v58 offset:2048
    v_add_f32 v32, v32, v33
    v_add_f32 v50, v50, v32
    v_add_f32 v36, v36, v37
    v_add_f32 v51, v51, v36
    s_lshr_b32 s4, s35, 1
    s_lshl_b32 s4, s4, 17
    s_and_b32 s5, s35, 1
    s_lshl_b32 s5, s5, 11
    s_add_u32 s4, s4, s5
    s_lshl_b32 s5, s23, 13
    s_add_u32 s4, s4, s5
    s_add_u32 s6, s4, 20971520
    s_add_u32 s7, s6, 4096
    s_waitcnt lgkmcnt(0)
    v_lshlrev_b32 v56, 16, v66
    v_and_b32 v57, 0xffff0000, v66
    v_lshlrev_b32 v58, 16, v67
    v_and_b32 v59, 0xffff0000, v67
    v_pk_add_f32 v[0:1], v[0:1], v[50:51] op_sel:[0,0] op_sel_hi:[1,0] neg_lo:[0,1] neg_hi:[0,1]
    v_pk_add_f32 v[2:3], v[2:3], v[50:51] op_sel:[0,0] op_sel_hi:[1,0] neg_lo:[0,1] neg_hi:[0,1]
    v_pk_add_f32 v[0:1], v[0:1], v[56:57]
    v_pk_add_f32 v[2:3], v[2:3], v[58:59]
    v_pk_mul_f32 v[60:61], v[0:1], v[0:1]
    v_pk_fma_f32 v[60:61], v[2:3], v[2:3], v[60:61]
    v_cvt_pk_bf16_f32 v82, v0, v1
    v_cvt_pk_bf16_f32 v83, v2, v3
    v_lshlrev_b32 v56, 16, v70
    v_and_b32 v57, 0xffff0000, v70
    v_lshlrev_b32 v58, 16, v71
    v_and_b32 v59, 0xffff0000, v71
    v_pk_add_f32 v[8:9], v[8:9], v[50:51] op_sel:[0,0] op_sel_hi:[1,0] neg_lo:[0,1] neg_hi:[0,1]
    v_pk_add_f32 v[10:11], v[10:11], v[50:51] op_sel:[0,0] op_sel_hi:[1,0] neg_lo:[0,1] neg_hi:[0,1]
    v_pk_add_f32 v[8:9], v[8:9], v[56:57]
    v_pk_add_f32 v[10:11], v[10:11], v[58:59]
    v_pk_fma_f32 v[60:61], v[8:9], v[8:9], v[60:61]
    v_pk_fma_f32 v[60:61], v[10:11], v[10:11], v[60:61]
    v_cvt_pk_bf16_f32 v84, v8, v9
    v_cvt_pk_bf16_f32 v85, v10, v11
    buffer_store_dwordx4 v[82:85], v241, s[8:11], s6 offen offset:0 sc1
    v_lshlrev_b32 v56, 16, v74
    v_and_b32 v57, 0xffff0000, v74
    v_lshlrev_b32 v58, 16, v75
    v_and_b32 v59, 0xffff0000, v75
    v_pk_add_f32 v[16:17], v[16:17], v[50:51] op_sel:[0,0] op_sel_hi:[1,0] neg_lo:[0,1] neg_hi:[0,1]
    v_pk_add_f32 v[18:19], v[18:19], v[50:51] op_sel:[0,0] op_sel_hi:[1,0] neg_lo:[0,1] neg_hi:[0,1]
    v_pk_add_f32 v[16:17], v[16:17], v[56:57]
    v_pk_add_f32 v[18:19], v[18:19], v[58:59]
    v_pk_fma_f32 v[60:61], v[16:17], v[16:17], v[60:61]
    v_pk_fma_f32 v[60:61], v[18:19], v[18:19], v[60:61]
    v_cvt_pk_bf16_f32 v86, v16, v17
    v_cvt_pk_bf16_f32 v87, v18, v19
    v_lshlrev_b32 v56, 16, v78
    v_and_b32 v57, 0xffff0000, v78
    v_lshlrev_b32 v58, 16, v79
    v_and_b32 v59, 0xffff0000, v79
    v_pk_add_f32 v[24:25], v[24:25], v[50:51] op_sel:[0,0] op_sel_hi:[1,0] neg_lo:[0,1] neg_hi:[0,1]
    v_pk_add_f32 v[26:27], v[26:27], v[50:51] op_sel:[0,0] op_sel_hi:[1,0] neg_lo:[0,1] neg_hi:[0,1]
    v_pk_add_f32 v[24:25], v[24:25], v[56:57]
    v_pk_add_f32 v[26:27], v[26:27], v[58:59]
    v_pk_fma_f32 v[60:61], v[24:25], v[24:25], v[60:61]
    v_pk_fma_f32 v[60:61], v[26:27], v[26:27], v[60:61]
    v_cvt_pk_bf16_f32 v88, v24, v25
    v_cvt_pk_bf16_f32 v89, v26, v27
    buffer_store_dwordx4 v[86:89], v241, s[8:11], s7 offen offset:0 sc1
    v_lshlrev_b32 v56, 16, v68
    v_and_b32 v57, 0xffff0000, v68
    v_lshlrev_b32 v58, 16, v69
    v_and_b32 v59, 0xffff0000, v69
    v_pk_add_f32 v[4:5], v[4:5], v[50:51] op_sel:[0,1] op_sel_hi:[1,1] neg_lo:[0,1] neg_hi:[0,1]
    v_pk_add_f32 v[6:7], v[6:7], v[50:51] op_sel:[0,1] op_sel_hi:[1,1] neg_lo:[0,1] neg_hi:[0,1]
    v_pk_add_f32 v[4:5], v[4:5], v[56:57]
    v_pk_add_f32 v[6:7], v[6:7], v[58:59]
    v_pk_mul_f32 v[62:63], v[4:5], v[4:5]
    v_pk_fma_f32 v[62:63], v[6:7], v[6:7], v[62:63]
    v_cvt_pk_bf16_f32 v90, v4, v5
    v_cvt_pk_bf16_f32 v91, v6, v7
    v_lshlrev_b32 v56, 16, v72
    v_and_b32 v57, 0xffff0000, v72
    v_lshlrev_b32 v58, 16, v73
    v_and_b32 v59, 0xffff0000, v73
    v_pk_add_f32 v[12:13], v[12:13], v[50:51] op_sel:[0,1] op_sel_hi:[1,1] neg_lo:[0,1] neg_hi:[0,1]
    v_pk_add_f32 v[14:15], v[14:15], v[50:51] op_sel:[0,1] op_sel_hi:[1,1] neg_lo:[0,1] neg_hi:[0,1]
    v_pk_add_f32 v[12:13], v[12:13], v[56:57]
    v_pk_add_f32 v[14:15], v[14:15], v[58:59]
    v_pk_fma_f32 v[62:63], v[12:13], v[12:13], v[62:63]
    v_pk_fma_f32 v[62:63], v[14:15], v[14:15], v[62:63]
    v_cvt_pk_bf16_f32 v92, v12, v13
    v_cvt_pk_bf16_f32 v93, v14, v15
    buffer_store_dwordx4 v[90:93], v241, s[8:11], s6 offen offset:1024 sc1
    v_lshlrev_b32 v56, 16, v76
    v_and_b32 v57, 0xffff0000, v76
    v_lshlrev_b32 v58, 16, v77
    v_and_b32 v59, 0xffff0000, v77
    v_pk_add_f32 v[20:21], v[20:21], v[50:51] op_sel:[0,1] op_sel_hi:[1,1] neg_lo:[0,1] neg_hi:[0,1]
    v_pk_add_f32 v[22:23], v[22:23], v[50:51] op_sel:[0,1] op_sel_hi:[1,1] neg_lo:[0,1] neg_hi:[0,1]
    v_pk_add_f32 v[20:21], v[20:21], v[56:57]
    v_pk_add_f32 v[22:23], v[22:23], v[58:59]
    v_pk_fma_f32 v[62:63], v[20:21], v[20:21], v[62:63]
    v_pk_fma_f32 v[62:63], v[22:23], v[22:23], v[62:63]
    v_cvt_pk_bf16_f32 v94, v20, v21
    v_cvt_pk_bf16_f32 v95, v22, v23
    v_lshlrev_b32 v56, 16, v80
    v_and_b32 v57, 0xffff0000, v80
    v_lshlrev_b32 v58, 16, v81
    v_and_b32 v59, 0xffff0000, v81
    v_pk_add_f32 v[28:29], v[28:29], v[50:51] op_sel:[0,1] op_sel_hi:[1,1] neg_lo:[0,1] neg_hi:[0,1]
    v_pk_add_f32 v[30:31], v[30:31], v[50:51] op_sel:[0,1] op_sel_hi:[1,1] neg_lo:[0,1] neg_hi:[0,1]
    v_pk_add_f32 v[28:29], v[28:29], v[56:57]
    v_pk_add_f32 v[30:31], v[30:31], v[58:59]
    v_pk_fma_f32 v[62:63], v[28:29], v[28:29], v[62:63]
    v_pk_fma_f32 v[62:63], v[30:31], v[30:31], v[62:63]
    v_cvt_pk_bf16_f32 v96, v28, v29
    v_cvt_pk_bf16_f32 v97, v30, v31
    buffer_store_dwordx4 v[94:97], v241, s[8:11], s7 offen offset:1024 sc1
    v_add_f32 v60, v60, v61
    v_add_f32 v62, v62, v63
    v_lshlrev_b32 v56, 2, v240
    v_mov_b32 v57, 0x7ffffff0
    v_permlane16_swap_b32 v60, v62
    v_cmp_gt_u32 vcc, 32, v240
    v_add_f32 v60, v60, v62
    v_mov_b32 v61, v60
    v_cndmask_b32 v56, v57, v56, vcc
    s_lshl_b32 s4, s35, 4
    v_permlane32_swap_b32 v60, v61
    v_add_f32 v60, v60, v61
    s_add_u32 s4, s4, s23
    s_lshl_b32 s4, s4, 7
    s_add_u32 s4, s4, 39911424
    buffer_store_dword v60, v56, s[8:11], s4 offen sc1
    s_cmp_lg_u32 s23, 0
    s_cbranch_scc1 mu2_done
    v_permlane16_swap_b32 v50, v51
    s_lshl_b32 s4, s35, 7
    s_add_u32 s4, s4, 39854080
    buffer_store_dword v50, v56, s[8:11], s4 offen sc1
mu2_done:
    s_lshl_b32 s3, s22, 4
    s_add_u32 s3, s3, s23
    s_lshl_b32 s3, s3, 7
    s_add_u32 s3, s3, 40435712
    s_waitcnt vmcnt(0)
    s_barrier
    buffer_store_dword v247, v246, s[8:11], s3 offen sc1
    s_mov_b32 s22, s100
    s_mov_b32 s23, s101
    s_lshl_b32 s35, s22, 2
    s_add_u32 s35, s35, s21
    s_lshl_b32 s24, s35, 17
    s_add_u32 s24, s24, 20971520
    s_lshl_b32 s28, s22, 12
    s_add_u32 s28, s28, 40435712
    s_add_u32 m0, s26, 57344
    s_nop 0
    buffer_load_dwordx4 v224, s[44:47], s25 offen offset:0 lds
    buffer_load_dwordx4 v225, s[44:47], s25 offen offset:1024 lds
    buffer_load_dwordx4 v226, s[44:47], s25 offen offset:2048 lds
    buffer_load_dwordx4 v227, s[44:47], s25 offen offset:3072 lds
    s_add_u32 m0, s26, 61440
    s_nop 0
    buffer_load_dwordx4 v228, s[44:47], s25 offen offset:0 lds
    buffer_load_dwordx4 v229, s[44:47], s25 offen offset:1024 lds
    buffer_load_dwordx4 v230, s[44:47], s25 offen offset:2048 lds
    s_add_u32 s25, s25, 458752
    s_add_u32 m0, s26, 0
    s_nop 0
    buffer_load_dwordx4 v224, s[44:47], s25 offen offset:0 lds
    buffer_load_dwordx4 v225, s[44:47], s25 offen offset:1024 lds
    buffer_load_dwordx4 v226, s[44:47], s25 offen offset:2048 lds
    buffer_load_dwordx4 v227, s[44:47], s25 offen offset:3072 lds
    ds_read_b64_tr_b16 a[0:1], v231 offset:28672
    ds_read_b64_tr_b16 a[2:3], v231 offset:32256
    ds_read_b64_tr_b16 a[4:5], v231 offset:28704
    ds_read_b64_tr_b16 a[6:7], v231 offset:32288
    ds_read_b64_tr_b16 a[8:9], v231 offset:28736
    ds_read_b64_tr_b16 a[10:11], v231 offset:32320
    ds_read_b64_tr_b16 a[12:13], v231 offset:28768
    ds_read_b64_tr_b16 a[14:15], v231 offset:32352
    ds_read_b64_tr_b16 a[16:17], v231 offset:28800
    ds_read_b64_tr_b16 a[18:19], v231 offset:32384
    ds_read_b64_tr_b16 a[20:21], v231 offset:28832
    ds_read_b64_tr_b16 a[22:23], v231 offset:32416
    ds_read_b64_tr_b16 a[24:25], v231 offset:28864
    ds_read_b64_tr_b16 a[26:27], v231 offset:32448
    ds_read_b64_tr_b16 a[28:29], v231 offset:43008
    ds_read_b64_tr_b16 a[30:31], v231 offset:46592
    ds_read_b64_tr_b16 a[32:33], v231 offset:43040
    ds_read_b64_tr_b16 a[34:35], v231 offset:46624
    ds_read_b64_tr_b16 a[36:37], v231 offset:43072
    ds_read_b64_tr_b16 a[38:39], v231 offset:46656
    ds_read_b64_tr_b16 a[40:41], v231 offset:43104
    ds_read_b64_tr_b16 a[42:43], v231 offset:46688
    ds_read_b64_tr_b16 a[44:45], v231 offset:43136
    ds_read_b64_tr_b16 a[46:47], v231 offset:46720
    ds_read_b64_tr_b16 a[48:49], v231 offset:43168
    ds_read_b64_tr_b16 a[50:51], v231 offset:46752
    ds_read_b64_tr_b16 a[52:53], v231 offset:43200
    ds_read_b64_tr_b16 a[54:55], v231 offset:46784
    s_and_b32 s12, s2, 1
    s_lshl_b32 s12, s12, 3
    s_bfe_u32 s5, s2, 0x30003
    s_add_u32 s12, s12, s5
    s_bfe_u32 s14, s2, 0x10002
    s_bfe_u32 s13, s2, 0x10001
    s_lshl_b32 s13, s13, 2
    s_lshr_b32 s4, s2, 6
    s_add_u32 s13, s13, s4
    s_lshl_b32 s13, s13, 1
    s_add_u32 s13, s13, s14
    s_lshl_b32 s15, s12, 2
    s_add_u32 s15, s15, s21
    s_lshl_b32 s6, s13, 7
    s_mul_i32 s4, s21, 196608
    s_add_u32 s34, s6, s4
    s_mul_i32 s4, s14, 3670016
    s_add_u32 s6, s34, s4
    s_add_u32 s34, s34, 196608
    s_mul_i32 s32, s15, 229376
    s_add_u32 s32, s32, 25165824
    s_add_u32 s56, s32, 196608
    s_lshl_b32 s4, s14, 14
    s_add_u32 s32, s32, s4
    s_lshl_b32 s30, s21, 11
    s_add_u32 s30, s30, 0x18000
    s_mov_b32 s40, s60
    s_mov_b32 s41, s61
    s_mov_b32 s42, 7340032
    s_add_u32 s4, s5, 0
    s_and_b32 s4, s4, 3
    s_add_u32 s4, s4, 0
    s_mul_i32 s48, s4, 917504
    s_lshl_b32 s52, s4, 12
    s_add_u32 s4, s5, 1
    s_and_b32 s4, s4, 3
    s_add_u32 s4, s4, 0
    s_mul_i32 s49, s4, 917504
    s_lshl_b32 s53, s4, 12
    s_add_u32 s4, s5, 2
    s_and_b32 s4, s4, 3
    s_add_u32 s4, s4, 0
    s_mul_i32 s50, s4, 917504
    s_lshl_b32 s54, s4, 12
    s_add_u32 s4, s5, 3
    s_and_b32 s4, s4, 3
    s_add_u32 s4, s4, 0
    s_mul_i32 s51, s4, 917504
    s_lshl_b32 s55, s4, 12
    s_add_u32 s27, s30, 32768
    v_and_b32 v245, 31, v240
    v_lshlrev_b32 v245, 7, v245
    s_mov_b32 s4, 0
hwait:
    buffer_load_dword v234, v245, s[8:11], s28 offen sc1
    s_add_u32 s4, s4, 1
    s_waitcnt vmcnt(0)
    v_cmp_ne_u32 vcc, s29, v234
    s_cbranch_vccz hwait_ok
    s_cmp_lt_u32 s4, 2097152
    s_cbranch_scc1 hwait
hwait_ok:
    buffer_load_dwordx4 a[112:115], v241, s[8:11], s24 offen offset:0 sc1
    buffer_load_dwordx4 a[116:119], v241, s[8:11], s24 offen offset:1024 sc1
    buffer_load_dwordx4 a[120:123], v241, s[8:11], s24 offen offset:2048 sc1
    buffer_load_dwordx4 a[124:127], v241, s[8:11], s24 offen offset:3072 sc1
    s_add_u32 s24, s24, 4096
    buffer_load_dwordx4 a[128:131], v241, s[8:11], s24 offen offset:0 sc1
    buffer_load_dwordx4 a[132:135], v241, s[8:11], s24 offen offset:1024 sc1
    buffer_load_dwordx4 a[136:139], v241, s[8:11], s24 offen offset:2048 sc1
    buffer_load_dwordx4 a[140:143], v241, s[8:11], s24 offen offset:3072 sc1
    s_add_u32 s24, s24, 4096
    s_mov_b32 s28, 32768
    s_waitcnt vmcnt(4) lgkmcnt(0)
    v_mfma_f32_16x16x32_bf16 v[0:3], a[0:3], a[112:115], 0
    ds_read_b64_tr_b16 a[56:57], v231 offset:35840
    v_mfma_f32_16x16x32_bf16 v[4:7], a[0:3], a[116:119], 0
    s_add_u32 m0, s26, 4096
    v_mfma_f32_16x16x32_bf16 v[8:11], a[0:3], a[120:123], 0
    ds_read_b64_tr_b16 a[58:59], v231 offset:39424
    v_mfma_f32_16x16x32_bf16 v[12:15], a[0:3], a[124:127], 0
    ds_read_b64_tr_b16 a[60:61], v231 offset:35872
    v_mfma_f32_16x16x32_bf16 v[28:31], a[4:7], a[124:127], 0
    buffer_load_dwordx4 v228, s[44:47], s25 offen offset:0 lds
    v_mfma_f32_16x16x32_bf16 v[24:27], a[4:7], a[120:123], 0
    v_mfma_f32_16x16x32_bf16 v[20:23], a[4:7], a[116:119], 0
    ds_read_b64_tr_b16 a[62:63], v231 offset:39456
    v_mfma_f32_16x16x32_bf16 v[16:19], a[4:7], a[112:115], 0
    ds_read_b64_tr_b16 a[64:65], v231 offset:35904
    v_mfma_f32_16x16x32_bf16 v[32:35], a[8:11], a[112:115], 0
    ds_read_b64_tr_b16 a[66:67], v231 offset:39488
    v_mfma_f32_16x16x32_bf16 v[36:39], a[8:11], a[116:119], 0
    buffer_load_dwordx4 v229, s[44:47], s25 offen offset:1024 lds
    v_mfma_f32_16x16x32_bf16 v[40:43], a[8:11], a[120:123], 0
    v_mfma_f32_16x16x32_bf16 v[44:47], a[8:11], a[124:127], 0
    ds_read_b64_tr_b16 a[68:69], v231 offset:35936
    v_mfma_f32_16x16x32_bf16 v[60:63], a[12:15], a[124:127], 0
    ds_read_b64_tr_b16 a[70:71], v231 offset:39520
    v_mfma_f32_16x16x32_bf16 v[56:59], a[12:15], a[120:123], 0
    ds_read_b64_tr_b16 a[72:73], v231 offset:35968
    v_mfma_f32_16x16x32_bf16 v[52:55], a[12:15], a[116:119], 0
    buffer_load_dwordx4 v230, s[44:47], s25 offen offset:2048 lds
    v_mfma_f32_16x16x32_bf16 v[48:51], a[12:15], a[112:115], 0
    v_mfma_f32_16x16x32_bf16 v[64:67], a[16:19], a[112:115], 0
    ds_read_b64_tr_b16 a[74:75], v231 offset:39552
    v_mfma_f32_16x16x32_bf16 v[68:71], a[16:19], a[116:119], 0
    ds_read_b64_tr_b16 a[76:77], v231 offset:36000
    v_mfma_f32_16x16x32_bf16 v[72:75], a[16:19], a[120:123], 0
    ds_read_b64_tr_b16 a[78:79], v231 offset:39584
    v_mfma_f32_16x16x32_bf16 v[76:79], a[16:19], a[124:127], 0
    s_add_u32 s25, s25, 458752
    v_mfma_f32_16x16x32_bf16 v[92:95], a[20:23], a[124:127], 0
    v_mfma_f32_16x16x32_bf16 v[88:91], a[20:23], a[120:123], 0
    ds_read_b64_tr_b16 a[80:81], v231 offset:36032
    v_mfma_f32_16x16x32_bf16 v[84:87], a[20:23], a[116:119], 0
    ds_read_b64_tr_b16 a[82:83], v231 offset:39616
    v_mfma_f32_16x16x32_bf16 v[80:83], a[20:23], a[112:115], 0
    ds_read_b64_tr_b16 a[84:85], v231 offset:50176
    v_mfma_f32_16x16x32_bf16 v[96:99], a[24:27], a[112:115], 0
    buffer_load_dwordx4 a[144:147], v241, s[8:11], s24 offen offset:0 sc1
    v_mfma_f32_16x16x32_bf16 v[100:103], a[24:27], a[116:119], 0
    ds_read_b64_tr_b16 a[86:87], v231 offset:53760
    v_mfma_f32_16x16x32_bf16 v[104:107], a[24:27], a[120:123], 0
    v_mfma_f32_16x16x32_bf16 v[108:111], a[24:27], a[124:127], 0
    ds_read_b64_tr_b16 a[88:89], v231 offset:50208
    v_mfma_f32_16x16x32_bf16 v[124:127], a[28:31], a[124:127], 0
    buffer_load_dwordx4 a[148:151], v241, s[8:11], s24 offen offset:1024 sc1
    v_mfma_f32_16x16x32_bf16 v[120:123], a[28:31], a[120:123], 0
    ds_read_b64_tr_b16 a[90:91], v231 offset:53792
    v_mfma_f32_16x16x32_bf16 v[116:119], a[28:31], a[116:119], 0
    ds_read_b64_tr_b16 a[92:93], v231 offset:50240
    v_mfma_f32_16x16x32_bf16 v[112:115], a[28:31], a[112:115], 0
    v_mfma_f32_16x16x32_bf16 v[128:131], a[32:35], a[112:115], 0
    ds_read_b64_tr_b16 a[94:95], v231 offset:53824
    v_mfma_f32_16x16x32_bf16 v[132:135], a[32:35], a[116:119], 0
    buffer_load_dwordx4 a[152:155], v241, s[8:11], s24 offen offset:2048 sc1
    v_mfma_f32_16x16x32_bf16 v[136:139], a[32:35], a[120:123], 0
    ds_read_b64_tr_b16 a[96:97], v231 offset:50272
    v_mfma_f32_16x16x32_bf16 v[140:143], a[32:35], a[124:127], 0
    ds_read_b64_tr_b16 a[98:99], v231 offset:53856
    v_mfma_f32_16x16x32_bf16 v[156:159], a[36:39], a[124:127], 0
    v_mfma_f32_16x16x32_bf16 v[152:155], a[36:39], a[120:123], 0
    ds_read_b64_tr_b16 a[100:101], v231 offset:50304
    v_mfma_f32_16x16x32_bf16 v[148:151], a[36:39], a[116:119], 0
    buffer_load_dwordx4 a[156:159], v241, s[8:11], s24 offen offset:3072 sc1
    v_mfma_f32_16x16x32_bf16 v[144:147], a[36:39], a[112:115], 0
    ds_read_b64_tr_b16 a[102:103], v231 offset:53888
    v_mfma_f32_16x16x32_bf16 v[160:163], a[40:43], a[112:115], 0
    ds_read_b64_tr_b16 a[104:105], v231 offset:50336
    v_mfma_f32_16x16x32_bf16 v[164:167], a[40:43], a[116:119], 0
    v_mfma_f32_16x16x32_bf16 v[168:171], a[40:43], a[120:123], 0
    ds_read_b64_tr_b16 a[106:107], v231 offset:53920
    v_mfma_f32_16x16x32_bf16 v[172:175], a[40:43], a[124:127], 0
    s_add_u32 s24, s24, 4096
    v_mfma_f32_16x16x32_bf16 v[188:191], a[44:47], a[124:127], 0
    ds_read_b64_tr_b16 a[108:109], v231 offset:50368
    v_mfma_f32_16x16x32_bf16 v[184:187], a[44:47], a[120:123], 0
    ds_read_b64_tr_b16 a[110:111], v231 offset:53952
    v_mfma_f32_16x16x32_bf16 v[180:183], a[44:47], a[116:119], 0
    v_mfma_f32_16x16x32_bf16 v[176:179], a[44:47], a[112:115], 0
    v_mfma_f32_16x16x32_bf16 v[192:195], a[48:51], a[112:115], 0
    v_mfma_f32_16x16x32_bf16 v[196:199], a[48:51], a[116:119], 0
    v_mfma_f32_16x16x32_bf16 v[200:203], a[48:51], a[120:123], 0
    v_mfma_f32_16x16x32_bf16 v[204:207], a[48:51], a[124:127], 0
    v_mfma_f32_16x16x32_bf16 v[220:223], a[52:55], a[124:127], 0
    v_mfma_f32_16x16x32_bf16 v[216:219], a[52:55], a[120:123], 0
    v_mfma_f32_16x16x32_bf16 v[212:215], a[52:55], a[116:119], 0
    v_mfma_f32_16x16x32_bf16 v[208:211], a[52:55], a[112:115], 0
    s_waitcnt vmcnt(7) lgkmcnt(0)
    s_barrier
    v_mfma_f32_16x16x32_bf16 v[0:3], a[56:59], a[128:131], v[0:3]
    ds_read_b64_tr_b16 a[0:1], v232 offset:0
    v_mfma_f32_16x16x32_bf16 v[4:7], a[56:59], a[132:135], v[4:7]
    s_add_u32 m0, s26, 28672
    v_mfma_f32_16x16x32_bf16 v[8:11], a[56:59], a[136:139], v[8:11]
    ds_read_b64_tr_b16 a[2:3], v232 offset:3584
    v_mfma_f32_16x16x32_bf16 v[12:15], a[56:59], a[140:143], v[12:15]
    ds_read_b64_tr_b16 a[4:5], v232 offset:32
    v_mfma_f32_16x16x32_bf16 v[28:31], a[60:63], a[140:143], v[28:31]
    buffer_load_dwordx4 v224, s[44:47], s25 offen offset:0 lds
    v_mfma_f32_16x16x32_bf16 v[24:27], a[60:63], a[136:139], v[24:27]
    v_mfma_f32_16x16x32_bf16 v[20:23], a[60:63], a[132:135], v[20:23]
    ds_read_b64_tr_b16 a[6:7], v232 offset:3616
    v_mfma_f32_16x16x32_bf16 v[16:19], a[60:63], a[128:131], v[16:19]
    ds_read_b64_tr_b16 a[8:9], v232 offset:64
    v_mfma_f32_16x16x32_bf16 v[32:35], a[64:67], a[128:131], v[32:35]
    ds_read_b64_tr_b16 a[10:11], v232 offset:3648
    v_mfma_f32_16x16x32_bf16 v[36:39], a[64:67], a[132:135], v[36:39]
    buffer_load_dwordx4 v225, s[44:47], s25 offen offset:1024 lds
    v_mfma_f32_16x16x32_bf16 v[40:43], a[64:67], a[136:139], v[40:43]
    v_mfma_f32_16x16x32_bf16 v[44:47], a[64:67], a[140:143], v[44:47]
    ds_read_b64_tr_b16 a[12:13], v232 offset:96
    v_mfma_f32_16x16x32_bf16 v[60:63], a[68:71], a[140:143], v[60:63]
    ds_read_b64_tr_b16 a[14:15], v232 offset:3680
    v_mfma_f32_16x16x32_bf16 v[56:59], a[68:71], a[136:139], v[56:59]
    ds_read_b64_tr_b16 a[16:17], v232 offset:128
    v_mfma_f32_16x16x32_bf16 v[52:55], a[68:71], a[132:135], v[52:55]
    buffer_load_dwordx4 v226, s[44:47], s25 offen offset:2048 lds
    v_mfma_f32_16x16x32_bf16 v[48:51], a[68:71], a[128:131], v[48:51]
    v_mfma_f32_16x16x32_bf16 v[64:67], a[72:75], a[128:131], v[64:67]
    ds_read_b64_tr_b16 a[18:19], v232 offset:3712
    v_mfma_f32_16x16x32_bf16 v[68:71], a[72:75], a[132:135], v[68:71]
    ds_read_b64_tr_b16 a[20:21], v232 offset:160
    v_mfma_f32_16x16x32_bf16 v[72:75], a[72:75], a[136:139], v[72:75]
    ds_read_b64_tr_b16 a[22:23], v232 offset:3744
    v_mfma_f32_16x16x32_bf16 v[76:79], a[72:75], a[140:143], v[76:79]
    buffer_load_dwordx4 v227, s[44:47], s25 offen offset:3072 lds
    v_mfma_f32_16x16x32_bf16 v[92:95], a[76:79], a[140:143], v[92:95]
    v_mfma_f32_16x16x32_bf16 v[88:91], a[76:79], a[136:139], v[88:91]
    ds_read_b64_tr_b16 a[24:25], v232 offset:192
    v_mfma_f32_16x16x32_bf16 v[84:87], a[76:79], a[132:135], v[84:87]
    ds_read_b64_tr_b16 a[26:27], v232 offset:3776
    v_mfma_f32_16x16x32_bf16 v[80:83], a[76:79], a[128:131], v[80:83]
    ds_read_b64_tr_b16 a[28:29], v232 offset:14336
    v_mfma_f32_16x16x32_bf16 v[96:99], a[80:83], a[128:131], v[96:99]
    buffer_load_dwordx4 a[112:115], v241, s[8:11], s24 offen offset:0 sc1
    v_mfma_f32_16x16x32_bf16 v[100:103], a[80:83], a[132:135], v[100:103]
    ds_read_b64_tr_b16 a[30:31], v232 offset:17920
    v_mfma_f32_16x16x32_bf16 v[104:107], a[80:83], a[136:139], v[104:107]
    v_mfma_f32_16x16x32_bf16 v[108:111], a[80:83], a[140:143], v[108:111]
    ds_read_b64_tr_b16 a[32:33], v232 offset:14368
    v_mfma_f32_16x16x32_bf16 v[124:127], a[84:87], a[140:143], v[124:127]
    buffer_load_dwordx4 a[116:119], v241, s[8:11], s24 offen offset:1024 sc1
    v_mfma_f32_16x16x32_bf16 v[120:123], a[84:87], a[136:139], v[120:123]
    ds_read_b64_tr_b16 a[34:35], v232 offset:17952
    v_mfma_f32_16x16x32_bf16 v[116:119], a[84:87], a[132:135], v[116:119]
    ds_read_b64_tr_b16 a[36:37], v232 offset:14400
    v_mfma_f32_16x16x32_bf16 v[112:115], a[84:87], a[128:131], v[112:115]
    v_mfma_f32_16x16x32_bf16 v[128:131], a[88:91], a[128:131], v[128:131]
    ds_read_b64_tr_b16 a[38:39], v232 offset:17984
    v_mfma_f32_16x16x32_bf16 v[132:135], a[88:91], a[132:135], v[132:135]
    buffer_load_dwordx4 a[120:123], v241, s[8:11], s24 offen offset:2048 sc1
    v_mfma_f32_16x16x32_bf16 v[136:139], a[88:91], a[136:139], v[136:139]
    ds_read_b64_tr_b16 a[40:41], v232 offset:14432
    v_mfma_f32_16x16x32_bf16 v[140:143], a[88:91], a[140:143], v[140:143]
    ds_read_b64_tr_b16 a[42:43], v232 offset:18016
    v_mfma_f32_16x16x32_bf16 v[156:159], a[92:95], a[140:143], v[156:159]
    v_mfma_f32_16x16x32_bf16 v[152:155], a[92:95], a[136:139], v[152:155]
    ds_read_b64_tr_b16 a[44:45], v232 offset:14464
    v_mfma_f32_16x16x32_bf16 v[148:151], a[92:95], a[132:135], v[148:151]
    buffer_load_dwordx4 a[124:127], v241, s[8:11], s24 offen offset:3072 sc1
    v_mfma_f32_16x16x32_bf16 v[144:147], a[92:95], a[128:131], v[144:147]
    ds_read_b64_tr_b16 a[46:47], v232 offset:18048
    v_mfma_f32_16x16x32_bf16 v[160:163], a[96:99], a[128:131], v[160:163]
    ds_read_b64_tr_b16 a[48:49], v232 offset:14496
    v_mfma_f32_16x16x32_bf16 v[164:167], a[96:99], a[132:135], v[164:167]
    v_mfma_f32_16x16x32_bf16 v[168:171], a[96:99], a[136:139], v[168:171]
    ds_read_b64_tr_b16 a[50:51], v232 offset:18080
    v_mfma_f32_16x16x32_bf16 v[172:175], a[96:99], a[140:143], v[172:175]
    s_add_u32 s24, s24, 4096
    v_mfma_f32_16x16x32_bf16 v[188:191], a[100:103], a[140:143], v[188:191]
    ds_read_b64_tr_b16 a[52:53], v232 offset:14528
    v_mfma_f32_16x16x32_bf16 v[184:187], a[100:103], a[136:139], v[184:187]
    ds_read_b64_tr_b16 a[54:55], v232 offset:18112
    v_mfma_f32_16x16x32_bf16 v[180:183], a[100:103], a[132:135], v[180:183]
    v_mfma_f32_16x16x32_bf16 v[176:179], a[100:103], a[128:131], v[176:179]
    v_mfma_f32_16x16x32_bf16 v[192:195], a[104:107], a[128:131], v[192:195]
    v_mfma_f32_16x16x32_bf16 v[196:199], a[104:107], a[132:135], v[196:199]
    v_mfma_f32_16x16x32_bf16 v[200:203], a[104:107], a[136:139], v[200:203]
    v_mfma_f32_16x16x32_bf16 v[204:207], a[104:107], a[140:143], v[204:207]
    v_mfma_f32_16x16x32_bf16 v[220:223], a[108:111], a[140:143], v[220:223]
    v_mfma_f32_16x16x32_bf16 v[216:219], a[108:111], a[136:139], v[216:219]
    v_mfma_f32_16x16x32_bf16 v[212:215], a[108:111], a[132:135], v[212:215]
    v_mfma_f32_16x16x32_bf16 v[208:211], a[108:111], a[128:131], v[208:211]
    s_mov_b32 s20, 4
.p2align 6
gateup_loop:
    s_waitcnt vmcnt(8) lgkmcnt(0)
    v_mfma_f32_16x16x32_bf16 v[0:3], a[0:3], a[144:147], v[0:3]
    ds_read_b64_tr_b16 a[56:57], v232 offset:7168
    v_mfma_f32_16x16x32_bf16 v[4:7], a[0:3], a[148:151], v[4:7]
    s_add_u32 m0, s26, 32768
    v_mfma_f32_16x16x32_bf16 v[8:11], a[0:3], a[152:155], v[8:11]
    ds_read_b64_tr_b16 a[58:59], v232 offset:10752
    v_mfma_f32_16x16x32_bf16 v[12:15], a[0:3], a[156:159], v[12:15]
    ds_read_b64_tr_b16 a[60:61], v232 offset:7200
    v_mfma_f32_16x16x32_bf16 v[28:31], a[4:7], a[156:159], v[28:31]
    buffer_load_dwordx4 v228, s[44:47], s25 offen offset:0 lds
    v_mfma_f32_16x16x32_bf16 v[24:27], a[4:7], a[152:155], v[24:27]
    ds_read_b64_tr_b16 a[62:63], v232 offset:10784
    v_mfma_f32_16x16x32_bf16 v[20:23], a[4:7], a[148:151], v[20:23]
    ds_read_b64_tr_b16 a[64:65], v232 offset:7232
    v_mfma_f32_16x16x32_bf16 v[16:19], a[4:7], a[144:147], v[16:19]
    buffer_load_dwordx4 v229, s[44:47], s25 offen offset:1024 lds
    v_mfma_f32_16x16x32_bf16 v[32:35], a[8:11], a[144:147], v[32:35]
    ds_read_b64_tr_b16 a[66:67], v232 offset:10816
    v_mfma_f32_16x16x32_bf16 v[36:39], a[8:11], a[148:151], v[36:39]
    v_mfma_f32_16x16x32_bf16 v[40:43], a[8:11], a[152:155], v[40:43]
    ds_read_b64_tr_b16 a[68:69], v232 offset:7264
    v_mfma_f32_16x16x32_bf16 v[44:47], a[8:11], a[156:159], v[44:47]
    buffer_load_dwordx4 v230, s[44:47], s25 offen offset:2048 lds
    v_mfma_f32_16x16x32_bf16 v[60:63], a[12:15], a[156:159], v[60:63]
    ds_read_b64_tr_b16 a[70:71], v232 offset:10848
    v_mfma_f32_16x16x32_bf16 v[56:59], a[12:15], a[152:155], v[56:59]
    ds_read_b64_tr_b16 a[72:73], v232 offset:7296
    v_mfma_f32_16x16x32_bf16 v[52:55], a[12:15], a[148:151], v[52:55]
    s_add_u32 s25, s25, 458752
    v_mfma_f32_16x16x32_bf16 v[48:51], a[12:15], a[144:147], v[48:51]
    ds_read_b64_tr_b16 a[74:75], v232 offset:10880
    v_mfma_f32_16x16x32_bf16 v[64:67], a[16:19], a[144:147], v[64:67]
    ds_read_b64_tr_b16 a[76:77], v232 offset:7328
    v_mfma_f32_16x16x32_bf16 v[68:71], a[16:19], a[148:151], v[68:71]
    buffer_load_dwordx4 a[128:131], v241, s[8:11], s24 offen offset:0 sc1
    v_mfma_f32_16x16x32_bf16 v[72:75], a[16:19], a[152:155], v[72:75]
    v_mfma_f32_16x16x32_bf16 v[76:79], a[16:19], a[156:159], v[76:79]
    ds_read_b64_tr_b16 a[78:79], v232 offset:10912
    v_mfma_f32_16x16x32_bf16 v[92:95], a[20:23], a[156:159], v[92:95]
    ds_read_b64_tr_b16 a[80:81], v232 offset:7360
    v_mfma_f32_16x16x32_bf16 v[88:91], a[20:23], a[152:155], v[88:91]
    buffer_load_dwordx4 a[132:135], v241, s[8:11], s24 offen offset:1024 sc1
    v_mfma_f32_16x16x32_bf16 v[84:87], a[20:23], a[148:151], v[84:87]
    ds_read_b64_tr_b16 a[82:83], v232 offset:10944
    v_mfma_f32_16x16x32_bf16 v[80:83], a[20:23], a[144:147], v[80:83]
    ds_read_b64_tr_b16 a[84:85], v232 offset:21504
    v_mfma_f32_16x16x32_bf16 v[96:99], a[24:27], a[144:147], v[96:99]
    buffer_load_dwordx4 a[136:139], v241, s[8:11], s24 offen offset:2048 sc1
    v_mfma_f32_16x16x32_bf16 v[100:103], a[24:27], a[148:151], v[100:103]
    ds_read_b64_tr_b16 a[86:87], v232 offset:25088
    v_mfma_f32_16x16x32_bf16 v[104:107], a[24:27], a[152:155], v[104:107]
    ds_read_b64_tr_b16 a[88:89], v232 offset:21536
    v_mfma_f32_16x16x32_bf16 v[108:111], a[24:27], a[156:159], v[108:111]
    buffer_load_dwordx4 a[140:143], v241, s[8:11], s24 offen offset:3072 sc1
    v_mfma_f32_16x16x32_bf16 v[124:127], a[28:31], a[156:159], v[124:127]
    v_mfma_f32_16x16x32_bf16 v[120:123], a[28:31], a[152:155], v[120:123]
    ds_read_b64_tr_b16 a[90:91], v232 offset:25120
    v_mfma_f32_16x16x32_bf16 v[116:119], a[28:31], a[148:151], v[116:119]
    ds_read_b64_tr_b16 a[92:93], v232 offset:21568
    v_mfma_f32_16x16x32_bf16 v[112:115], a[28:31], a[144:147], v[112:115]
    s_add_u32 s24, s24, 4096
    v_mfma_f32_16x16x32_bf16 v[128:131], a[32:35], a[144:147], v[128:131]
    ds_read_b64_tr_b16 a[94:95], v232 offset:25152
    v_mfma_f32_16x16x32_bf16 v[132:135], a[32:35], a[148:151], v[132:135]
    ds_read_b64_tr_b16 a[96:97], v232 offset:21600
    v_mfma_f32_16x16x32_bf16 v[136:139], a[32:35], a[152:155], v[136:139]
    s_add_u32 s7, s6, s48
    v_mfma_f32_16x16x32_bf16 v[140:143], a[32:35], a[156:159], v[140:143]
    ds_read_b64_tr_b16 a[98:99], v232 offset:25184
    v_mfma_f32_16x16x32_bf16 v[156:159], a[36:39], a[156:159], v[156:159]
    ds_read_b64_tr_b16 a[100:101], v232 offset:21632
    v_mfma_f32_16x16x32_bf16 v[152:155], a[36:39], a[152:155], v[152:155]
    v_mfma_f32_16x16x32_bf16 v[148:151], a[36:39], a[148:151], v[148:151]
    s_add_u32 m0, s27, 0
    v_mfma_f32_16x16x32_bf16 v[144:147], a[36:39], a[144:147], v[144:147]
    ds_read_b64_tr_b16 a[102:103], v232 offset:25216
    v_mfma_f32_16x16x32_bf16 v[160:163], a[40:43], a[144:147], v[160:163]
    ds_read_b64_tr_b16 a[104:105], v232 offset:21664
    v_mfma_f32_16x16x32_bf16 v[164:167], a[40:43], a[148:151], v[164:167]
    buffer_load_dwordx4 v249, s[40:43], s7 offen offset:0 lds
    v_mfma_f32_16x16x32_bf16 v[168:171], a[40:43], a[152:155], v[168:171]
    ds_read_b64_tr_b16 a[106:107], v232 offset:25248
    v_mfma_f32_16x16x32_bf16 v[172:175], a[40:43], a[156:159], v[172:175]
    ds_read_b64_tr_b16 a[108:109], v232 offset:21696
    v_mfma_f32_16x16x32_bf16 v[188:191], a[44:47], a[156:159], v[188:191]
    buffer_load_dwordx4 v250, s[40:43], s7 offen offset:1024 lds
    v_mfma_f32_16x16x32_bf16 v[184:187], a[44:47], a[152:155], v[184:187]
    ds_read_b64_tr_b16 a[110:111], v232 offset:25280
    v_mfma_f32_16x16x32_bf16 v[180:183], a[44:47], a[148:151], v[180:183]
    v_mfma_f32_16x16x32_bf16 v[176:179], a[44:47], a[144:147], v[176:179]
    v_mfma_f32_16x16x32_bf16 v[192:195], a[48:51], a[144:147], v[192:195]
    v_mfma_f32_16x16x32_bf16 v[196:199], a[48:51], a[148:151], v[196:199]
    v_mfma_f32_16x16x32_bf16 v[200:203], a[48:51], a[152:155], v[200:203]
    v_mfma_f32_16x16x32_bf16 v[204:207], a[48:51], a[156:159], v[204:207]
    v_mfma_f32_16x16x32_bf16 v[220:223], a[52:55], a[156:159], v[220:223]
    v_mfma_f32_16x16x32_bf16 v[216:219], a[52:55], a[152:155], v[216:219]
    v_mfma_f32_16x16x32_bf16 v[212:215], a[52:55], a[148:151], v[212:215]
    v_mfma_f32_16x16x32_bf16 v[208:211], a[52:55], a[144:147], v[208:211]
    s_waitcnt vmcnt(9) lgkmcnt(0)
    s_barrier
    v_mfma_f32_16x16x32_bf16 v[0:3], a[56:59], a[112:115], v[0:3]
    ds_read_b64_tr_b16 a[0:1], v231 offset:0
    v_mfma_f32_16x16x32_bf16 v[4:7], a[56:59], a[116:119], v[4:7]
    s_add_u32 m0, s26, 57344
    v_mfma_f32_16x16x32_bf16 v[8:11], a[56:59], a[120:123], v[8:11]
    ds_read_b64_tr_b16 a[2:3], v231 offset:3584
    v_mfma_f32_16x16x32_bf16 v[12:15], a[56:59], a[124:127], v[12:15]
    ds_read_b64_tr_b16 a[4:5], v231 offset:32
    v_mfma_f32_16x16x32_bf16 v[28:31], a[60:63], a[124:127], v[28:31]
    buffer_load_dwordx4 v224, s[44:47], s25 offen offset:0 lds
    v_mfma_f32_16x16x32_bf16 v[24:27], a[60:63], a[120:123], v[24:27]
    v_mfma_f32_16x16x32_bf16 v[20:23], a[60:63], a[116:119], v[20:23]
    ds_read_b64_tr_b16 a[6:7], v231 offset:3616
    v_mfma_f32_16x16x32_bf16 v[16:19], a[60:63], a[112:115], v[16:19]
    ds_read_b64_tr_b16 a[8:9], v231 offset:64
    v_mfma_f32_16x16x32_bf16 v[32:35], a[64:67], a[112:115], v[32:35]
    ds_read_b64_tr_b16 a[10:11], v231 offset:3648
    v_mfma_f32_16x16x32_bf16 v[36:39], a[64:67], a[116:119], v[36:39]
    buffer_load_dwordx4 v225, s[44:47], s25 offen offset:1024 lds
    v_mfma_f32_16x16x32_bf16 v[40:43], a[64:67], a[120:123], v[40:43]
    v_mfma_f32_16x16x32_bf16 v[44:47], a[64:67], a[124:127], v[44:47]
    ds_read_b64_tr_b16 a[12:13], v231 offset:96
    v_mfma_f32_16x16x32_bf16 v[60:63], a[68:71], a[124:127], v[60:63]
    ds_read_b64_tr_b16 a[14:15], v231 offset:3680
    v_mfma_f32_16x16x32_bf16 v[56:59], a[68:71], a[120:123], v[56:59]
    ds_read_b64_tr_b16 a[16:17], v231 offset:128
    v_mfma_f32_16x16x32_bf16 v[52:55], a[68:71], a[116:119], v[52:55]
    buffer_load_dwordx4 v226, s[44:47], s25 offen offset:2048 lds
    v_mfma_f32_16x16x32_bf16 v[48:51], a[68:71], a[112:115], v[48:51]
    v_mfma_f32_16x16x32_bf16 v[64:67], a[72:75], a[112:115], v[64:67]
    ds_read_b64_tr_b16 a[18:19], v231 offset:3712
    v_mfma_f32_16x16x32_bf16 v[68:71], a[72:75], a[116:119], v[68:71]
    ds_read_b64_tr_b16 a[20:21], v231 offset:160
    v_mfma_f32_16x16x32_bf16 v[72:75], a[72:75], a[120:123], v[72:75]
    ds_read_b64_tr_b16 a[22:23], v231 offset:3744
    v_mfma_f32_16x16x32_bf16 v[76:79], a[72:75], a[124:127], v[76:79]
    buffer_load_dwordx4 v227, s[44:47], s25 offen offset:3072 lds
    v_mfma_f32_16x16x32_bf16 v[92:95], a[76:79], a[124:127], v[92:95]
    v_mfma_f32_16x16x32_bf16 v[88:91], a[76:79], a[120:123], v[88:91]
    ds_read_b64_tr_b16 a[24:25], v231 offset:192
    v_mfma_f32_16x16x32_bf16 v[84:87], a[76:79], a[116:119], v[84:87]
    ds_read_b64_tr_b16 a[26:27], v231 offset:3776
    v_mfma_f32_16x16x32_bf16 v[80:83], a[76:79], a[112:115], v[80:83]
    ds_read_b64_tr_b16 a[28:29], v231 offset:14336
    v_mfma_f32_16x16x32_bf16 v[96:99], a[80:83], a[112:115], v[96:99]
    buffer_load_dwordx4 a[144:147], v241, s[8:11], s24 offen offset:0 sc1
    v_mfma_f32_16x16x32_bf16 v[100:103], a[80:83], a[116:119], v[100:103]
    ds_read_b64_tr_b16 a[30:31], v231 offset:17920
    v_mfma_f32_16x16x32_bf16 v[104:107], a[80:83], a[120:123], v[104:107]
    v_mfma_f32_16x16x32_bf16 v[108:111], a[80:83], a[124:127], v[108:111]
    ds_read_b64_tr_b16 a[32:33], v231 offset:14368
    v_mfma_f32_16x16x32_bf16 v[124:127], a[84:87], a[124:127], v[124:127]
    buffer_load_dwordx4 a[148:151], v241, s[8:11], s24 offen offset:1024 sc1
    v_mfma_f32_16x16x32_bf16 v[120:123], a[84:87], a[120:123], v[120:123]
    ds_read_b64_tr_b16 a[34:35], v231 offset:17952
    v_mfma_f32_16x16x32_bf16 v[116:119], a[84:87], a[116:119], v[116:119]
    ds_read_b64_tr_b16 a[36:37], v231 offset:14400
    v_mfma_f32_16x16x32_bf16 v[112:115], a[84:87], a[112:115], v[112:115]
    v_mfma_f32_16x16x32_bf16 v[128:131], a[88:91], a[112:115], v[128:131]
    ds_read_b64_tr_b16 a[38:39], v231 offset:17984
    v_mfma_f32_16x16x32_bf16 v[132:135], a[88:91], a[116:119], v[132:135]
    buffer_load_dwordx4 a[152:155], v241, s[8:11], s24 offen offset:2048 sc1
    v_mfma_f32_16x16x32_bf16 v[136:139], a[88:91], a[120:123], v[136:139]
    ds_read_b64_tr_b16 a[40:41], v231 offset:14432
    v_mfma_f32_16x16x32_bf16 v[140:143], a[88:91], a[124:127], v[140:143]
    ds_read_b64_tr_b16 a[42:43], v231 offset:18016
    v_mfma_f32_16x16x32_bf16 v[156:159], a[92:95], a[124:127], v[156:159]
    v_mfma_f32_16x16x32_bf16 v[152:155], a[92:95], a[120:123], v[152:155]
    ds_read_b64_tr_b16 a[44:45], v231 offset:14464
    v_mfma_f32_16x16x32_bf16 v[148:151], a[92:95], a[116:119], v[148:151]
    buffer_load_dwordx4 a[156:159], v241, s[8:11], s24 offen offset:3072 sc1
    v_mfma_f32_16x16x32_bf16 v[144:147], a[92:95], a[112:115], v[144:147]
    ds_read_b64_tr_b16 a[46:47], v231 offset:18048
    v_mfma_f32_16x16x32_bf16 v[160:163], a[96:99], a[112:115], v[160:163]
    ds_read_b64_tr_b16 a[48:49], v231 offset:14496
    v_mfma_f32_16x16x32_bf16 v[164:167], a[96:99], a[116:119], v[164:167]
    v_mfma_f32_16x16x32_bf16 v[168:171], a[96:99], a[120:123], v[168:171]
    ds_read_b64_tr_b16 a[50:51], v231 offset:18080
    v_mfma_f32_16x16x32_bf16 v[172:175], a[96:99], a[124:127], v[172:175]
    s_add_u32 s24, s24, 4096
    v_mfma_f32_16x16x32_bf16 v[188:191], a[100:103], a[124:127], v[188:191]
    ds_read_b64_tr_b16 a[52:53], v231 offset:14528
    v_mfma_f32_16x16x32_bf16 v[184:187], a[100:103], a[120:123], v[184:187]
    ds_read_b64_tr_b16 a[54:55], v231 offset:18112
    v_mfma_f32_16x16x32_bf16 v[180:183], a[100:103], a[116:119], v[180:183]
    v_mfma_f32_16x16x32_bf16 v[176:179], a[100:103], a[112:115], v[176:179]
    v_mfma_f32_16x16x32_bf16 v[192:195], a[104:107], a[112:115], v[192:195]
    v_mfma_f32_16x16x32_bf16 v[196:199], a[104:107], a[116:119], v[196:199]
    v_mfma_f32_16x16x32_bf16 v[200:203], a[104:107], a[120:123], v[200:203]
    v_mfma_f32_16x16x32_bf16 v[204:207], a[104:107], a[124:127], v[204:207]
    v_mfma_f32_16x16x32_bf16 v[220:223], a[108:111], a[124:127], v[220:223]
    v_mfma_f32_16x16x32_bf16 v[216:219], a[108:111], a[120:123], v[216:219]
    v_mfma_f32_16x16x32_bf16 v[212:215], a[108:111], a[116:119], v[212:215]
    v_mfma_f32_16x16x32_bf16 v[208:211], a[108:111], a[112:115], v[208:211]
    s_waitcnt vmcnt(10) lgkmcnt(0)
    v_mfma_f32_16x16x32_bf16 v[0:3], a[0:3], a[128:131], v[0:3]
    ds_read_b64_tr_b16 a[56:57], v231 offset:7168
    s_add_u32 m0, s26, 61440
    v_mfma_f32_16x16x32_bf16 v[4:7], a[0:3], a[132:135], v[4:7]
    ds_read_b64_tr_b16 a[58:59], v231 offset:10752
    v_mfma_f32_16x16x32_bf16 v[8:11], a[0:3], a[136:139], v[8:11]
    buffer_load_dwordx4 v228, s[44:47], s25 offen offset:0 lds
    v_mfma_f32_16x16x32_bf16 v[12:15], a[0:3], a[140:143], v[12:15]
    ds_read_b64_tr_b16 a[60:61], v231 offset:7200
    v_mfma_f32_16x16x32_bf16 v[28:31], a[4:7], a[140:143], v[28:31]
    buffer_load_dwordx4 v229, s[44:47], s25 offen offset:1024 lds
    v_mfma_f32_16x16x32_bf16 v[24:27], a[4:7], a[136:139], v[24:27]
    ds_read_b64_tr_b16 a[62:63], v231 offset:10784
    v_mfma_f32_16x16x32_bf16 v[20:23], a[4:7], a[132:135], v[20:23]
    buffer_load_dwordx4 v230, s[44:47], s25 offen offset:2048 lds
    v_mfma_f32_16x16x32_bf16 v[16:19], a[4:7], a[128:131], v[16:19]
    ds_read_b64_tr_b16 a[64:65], v231 offset:7232
    v_mfma_f32_16x16x32_bf16 v[32:35], a[8:11], a[128:131], v[32:35]
    ds_read_b64_tr_b16 a[66:67], v231 offset:10816
    v_mfma_f32_16x16x32_bf16 v[36:39], a[8:11], a[132:135], v[36:39]
    s_add_u32 s25, s25, 458752
    v_mfma_f32_16x16x32_bf16 v[40:43], a[8:11], a[136:139], v[40:43]
    ds_read_b64_tr_b16 a[68:69], v231 offset:7264
    v_mfma_f32_16x16x32_bf16 v[44:47], a[8:11], a[140:143], v[44:47]
    buffer_load_dwordx4 a[112:115], v241, s[8:11], s24 offen offset:0 sc1
    v_mfma_f32_16x16x32_bf16 v[60:63], a[12:15], a[140:143], v[60:63]
    ds_read_b64_tr_b16 a[70:71], v231 offset:10848
    v_mfma_f32_16x16x32_bf16 v[56:59], a[12:15], a[136:139], v[56:59]
    buffer_load_dwordx4 a[116:119], v241, s[8:11], s24 offen offset:1024 sc1
    v_mfma_f32_16x16x32_bf16 v[52:55], a[12:15], a[132:135], v[52:55]
    ds_read_b64_tr_b16 a[72:73], v231 offset:7296
    v_mfma_f32_16x16x32_bf16 v[48:51], a[12:15], a[128:131], v[48:51]
    buffer_load_dwordx4 a[120:123], v241, s[8:11], s24 offen offset:2048 sc1
    ds_read_b64_tr_b16 a[74:75], v231 offset:10880
    v_mfma_f32_16x16x32_bf16 v[64:67], a[16:19], a[128:131], v[64:67]
    ds_read_b64_tr_b16 a[76:77], v231 offset:7328
    v_mfma_f32_16x16x32_bf16 v[68:71], a[16:19], a[132:135], v[68:71]
    buffer_load_dwordx4 a[124:127], v241, s[8:11], s24 offen offset:3072 sc1
    v_mfma_f32_16x16x32_bf16 v[72:75], a[16:19], a[136:139], v[72:75]
    ds_read_b64_tr_b16 a[78:79], v231 offset:10912
    v_mfma_f32_16x16x32_bf16 v[76:79], a[16:19], a[140:143], v[76:79]
    s_add_u32 s24, s24, 4096
    v_mfma_f32_16x16x32_bf16 v[92:95], a[20:23], a[140:143], v[92:95]
    ds_read_b64_tr_b16 a[80:81], v231 offset:7360
    v_mfma_f32_16x16x32_bf16 v[88:91], a[20:23], a[136:139], v[88:91]
    s_xor_b32 s31, s7, 128
    v_mfma_f32_16x16x32_bf16 v[84:87], a[20:23], a[132:135], v[84:87]
    ds_read_b64_tr_b16 a[82:83], v231 offset:10944
    v_mfma_f32_16x16x32_bf16 v[80:83], a[20:23], a[128:131], v[80:83]
    ds_read_b64_tr_b16 a[84:85], v231 offset:21504
    v_mfma_f32_16x16x32_bf16 v[96:99], a[24:27], a[128:131], v[96:99]
    s_add_u32 m0, s27, 8192
    v_mfma_f32_16x16x32_bf16 v[100:103], a[24:27], a[132:135], v[100:103]
    ds_read_b64_tr_b16 a[86:87], v231 offset:25088
    v_mfma_f32_16x16x32_bf16 v[104:107], a[24:27], a[136:139], v[104:107]
    buffer_load_dwordx4 v249, s[40:43], s31 offen offset:0 lds
    v_mfma_f32_16x16x32_bf16 v[108:111], a[24:27], a[140:143], v[108:111]
    ds_read_b64_tr_b16 a[88:89], v231 offset:21536
    v_mfma_f32_16x16x32_bf16 v[124:127], a[28:31], a[140:143], v[124:127]
    buffer_load_dwordx4 v250, s[40:43], s31 offen offset:1024 lds
    v_mfma_f32_16x16x32_bf16 v[120:123], a[28:31], a[136:139], v[120:123]
    ds_read_b64_tr_b16 a[90:91], v231 offset:25120
    v_mfma_f32_16x16x32_bf16 v[116:119], a[28:31], a[132:135], v[116:119]
    s_mov_b32 s4, s48
    v_mfma_f32_16x16x32_bf16 v[112:115], a[28:31], a[128:131], v[112:115]
    ds_read_b64_tr_b16 a[92:93], v231 offset:21568
    ds_read_b64_tr_b16 a[94:95], v231 offset:25152
    v_mfma_f32_16x16x32_bf16 v[128:131], a[32:35], a[128:131], v[128:131]
    s_mov_b32 s48, s49
    v_mfma_f32_16x16x32_bf16 v[132:135], a[32:35], a[132:135], v[132:135]
    ds_read_b64_tr_b16 a[96:97], v231 offset:21600
    v_mfma_f32_16x16x32_bf16 v[136:139], a[32:35], a[136:139], v[136:139]
    s_mov_b32 s49, s50
    v_mfma_f32_16x16x32_bf16 v[140:143], a[32:35], a[140:143], v[140:143]
    ds_read_b64_tr_b16 a[98:99], v231 offset:25184
    v_mfma_f32_16x16x32_bf16 v[156:159], a[36:39], a[140:143], v[156:159]
    s_mov_b32 s50, s51
    v_mfma_f32_16x16x32_bf16 v[152:155], a[36:39], a[136:139], v[152:155]
    ds_read_b64_tr_b16 a[100:101], v231 offset:21632
    v_mfma_f32_16x16x32_bf16 v[148:151], a[36:39], a[132:135], v[148:151]
    s_mov_b32 s51, s4
    v_mfma_f32_16x16x32_bf16 v[144:147], a[36:39], a[128:131], v[144:147]
    ds_read_b64_tr_b16 a[102:103], v231 offset:25216
    v_mfma_f32_16x16x32_bf16 v[160:163], a[40:43], a[128:131], v[160:163]
    ds_read_b64_tr_b16 a[104:105], v231 offset:21664
    v_mfma_f32_16x16x32_bf16 v[164:167], a[40:43], a[132:135], v[164:167]
    s_add_u32 s28, s28, 16384
    v_mfma_f32_16x16x32_bf16 v[168:171], a[40:43], a[136:139], v[168:171]
    ds_read_b64_tr_b16 a[106:107], v231 offset:25248
    v_mfma_f32_16x16x32_bf16 v[172:175], a[40:43], a[140:143], v[172:175]
    s_and_b32 s28, s28, 0xffff
    v_mfma_f32_16x16x32_bf16 v[188:191], a[44:47], a[140:143], v[188:191]
    ds_read_b64_tr_b16 a[108:109], v231 offset:21696
    v_mfma_f32_16x16x32_bf16 v[184:187], a[44:47], a[136:139], v[184:187]
    s_add_u32 s27, s28, s30
    v_mfma_f32_16x16x32_bf16 v[180:183], a[44:47], a[132:135], v[180:183]
    ds_read_b64_tr_b16 a[110:111], v231 offset:25280
    v_mfma_f32_16x16x32_bf16 v[176:179], a[44:47], a[128:131], v[176:179]
    v_mfma_f32_16x16x32_bf16 v[192:195], a[48:51], a[128:131], v[192:195]
    v_mfma_f32_16x16x32_bf16 v[196:199], a[48:51], a[132:135], v[196:199]
    v_mfma_f32_16x16x32_bf16 v[200:203], a[48:51], a[136:139], v[200:203]
    v_mfma_f32_16x16x32_bf16 v[204:207], a[48:51], a[140:143], v[204:207]
    v_mfma_f32_16x16x32_bf16 v[220:223], a[52:55], a[140:143], v[220:223]
    v_mfma_f32_16x16x32_bf16 v[216:219], a[52:55], a[136:139], v[216:219]
    v_mfma_f32_16x16x32_bf16 v[212:215], a[52:55], a[132:135], v[212:215]
    v_mfma_f32_16x16x32_bf16 v[208:211], a[52:55], a[128:131], v[208:211]
    s_waitcnt vmcnt(9) lgkmcnt(0)
    s_barrier
    v_mfma_f32_16x16x32_bf16 v[0:3], a[56:59], a[144:147], v[0:3]
    ds_read_b64_tr_b16 a[0:1], v231 offset:28672
    v_mfma_f32_16x16x32_bf16 v[4:7], a[56:59], a[148:151], v[4:7]
    s_add_u32 m0, s26, 0
    v_mfma_f32_16x16x32_bf16 v[8:11], a[56:59], a[152:155], v[8:11]
    ds_read_b64_tr_b16 a[2:3], v231 offset:32256
    v_mfma_f32_16x16x32_bf16 v[12:15], a[56:59], a[156:159], v[12:15]
    ds_read_b64_tr_b16 a[4:5], v231 offset:28704
    v_mfma_f32_16x16x32_bf16 v[28:31], a[60:63], a[156:159], v[28:31]
    buffer_load_dwordx4 v224, s[44:47], s25 offen offset:0 lds
    v_mfma_f32_16x16x32_bf16 v[24:27], a[60:63], a[152:155], v[24:27]
    v_mfma_f32_16x16x32_bf16 v[20:23], a[60:63], a[148:151], v[20:23]
    ds_read_b64_tr_b16 a[6:7], v231 offset:32288
    v_mfma_f32_16x16x32_bf16 v[16:19], a[60:63], a[144:147], v[16:19]
    ds_read_b64_tr_b16 a[8:9], v231 offset:28736
    v_mfma_f32_16x16x32_bf16 v[32:35], a[64:67], a[144:147], v[32:35]
    ds_read_b64_tr_b16 a[10:11], v231 offset:32320
    v_mfma_f32_16x16x32_bf16 v[36:39], a[64:67], a[148:151], v[36:39]
    buffer_load_dwordx4 v225, s[44:47], s25 offen offset:1024 lds
    v_mfma_f32_16x16x32_bf16 v[40:43], a[64:67], a[152:155], v[40:43]
    v_mfma_f32_16x16x32_bf16 v[44:47], a[64:67], a[156:159], v[44:47]
    ds_read_b64_tr_b16 a[12:13], v231 offset:28768
    v_mfma_f32_16x16x32_bf16 v[60:63], a[68:71], a[156:159], v[60:63]
    ds_read_b64_tr_b16 a[14:15], v231 offset:32352
    v_mfma_f32_16x16x32_bf16 v[56:59], a[68:71], a[152:155], v[56:59]
    ds_read_b64_tr_b16 a[16:17], v231 offset:28800
    v_mfma_f32_16x16x32_bf16 v[52:55], a[68:71], a[148:151], v[52:55]
    buffer_load_dwordx4 v226, s[44:47], s25 offen offset:2048 lds
    v_mfma_f32_16x16x32_bf16 v[48:51], a[68:71], a[144:147], v[48:51]
    v_mfma_f32_16x16x32_bf16 v[64:67], a[72:75], a[144:147], v[64:67]
    ds_read_b64_tr_b16 a[18:19], v231 offset:32384
    v_mfma_f32_16x16x32_bf16 v[68:71], a[72:75], a[148:151], v[68:71]
    ds_read_b64_tr_b16 a[20:21], v231 offset:28832
    v_mfma_f32_16x16x32_bf16 v[72:75], a[72:75], a[152:155], v[72:75]
    ds_read_b64_tr_b16 a[22:23], v231 offset:32416
    v_mfma_f32_16x16x32_bf16 v[76:79], a[72:75], a[156:159], v[76:79]
    buffer_load_dwordx4 v227, s[44:47], s25 offen offset:3072 lds
    v_mfma_f32_16x16x32_bf16 v[92:95], a[76:79], a[156:159], v[92:95]
    v_mfma_f32_16x16x32_bf16 v[88:91], a[76:79], a[152:155], v[88:91]
    ds_read_b64_tr_b16 a[24:25], v231 offset:28864
    v_mfma_f32_16x16x32_bf16 v[84:87], a[76:79], a[148:151], v[84:87]
    ds_read_b64_tr_b16 a[26:27], v231 offset:32448
    v_mfma_f32_16x16x32_bf16 v[80:83], a[76:79], a[144:147], v[80:83]
    ds_read_b64_tr_b16 a[28:29], v231 offset:43008
    v_mfma_f32_16x16x32_bf16 v[96:99], a[80:83], a[144:147], v[96:99]
    buffer_load_dwordx4 a[128:131], v241, s[8:11], s24 offen offset:0 sc1
    v_mfma_f32_16x16x32_bf16 v[100:103], a[80:83], a[148:151], v[100:103]
    ds_read_b64_tr_b16 a[30:31], v231 offset:46592
    v_mfma_f32_16x16x32_bf16 v[104:107], a[80:83], a[152:155], v[104:107]
    v_mfma_f32_16x16x32_bf16 v[108:111], a[80:83], a[156:159], v[108:111]
    ds_read_b64_tr_b16 a[32:33], v231 offset:43040
    v_mfma_f32_16x16x32_bf16 v[124:127], a[84:87], a[156:159], v[124:127]
    buffer_load_dwordx4 a[132:135], v241, s[8:11], s24 offen offset:1024 sc1
    v_mfma_f32_16x16x32_bf16 v[120:123], a[84:87], a[152:155], v[120:123]
    ds_read_b64_tr_b16 a[34:35], v231 offset:46624
    v_mfma_f32_16x16x32_bf16 v[116:119], a[84:87], a[148:151], v[116:119]
    ds_read_b64_tr_b16 a[36:37], v231 offset:43072
    v_mfma_f32_16x16x32_bf16 v[112:115], a[84:87], a[144:147], v[112:115]
    v_mfma_f32_16x16x32_bf16 v[128:131], a[88:91], a[144:147], v[128:131]
    ds_read_b64_tr_b16 a[38:39], v231 offset:46656
    v_mfma_f32_16x16x32_bf16 v[132:135], a[88:91], a[148:151], v[132:135]
    buffer_load_dwordx4 a[136:139], v241, s[8:11], s24 offen offset:2048 sc1
    v_mfma_f32_16x16x32_bf16 v[136:139], a[88:91], a[152:155], v[136:139]
    ds_read_b64_tr_b16 a[40:41], v231 offset:43104
    v_mfma_f32_16x16x32_bf16 v[140:143], a[88:91], a[156:159], v[140:143]
    ds_read_b64_tr_b16 a[42:43], v231 offset:46688
    v_mfma_f32_16x16x32_bf16 v[156:159], a[92:95], a[156:159], v[156:159]
    v_mfma_f32_16x16x32_bf16 v[152:155], a[92:95], a[152:155], v[152:155]
    ds_read_b64_tr_b16 a[44:45], v231 offset:43136
    v_mfma_f32_16x16x32_bf16 v[148:151], a[92:95], a[148:151], v[148:151]
    buffer_load_dwordx4 a[140:143], v241, s[8:11], s24 offen offset:3072 sc1
    v_mfma_f32_16x16x32_bf16 v[144:147], a[92:95], a[144:147], v[144:147]
    ds_read_b64_tr_b16 a[46:47], v231 offset:46720
    v_mfma_f32_16x16x32_bf16 v[160:163], a[96:99], a[144:147], v[160:163]
    ds_read_b64_tr_b16 a[48:49], v231 offset:43168
    v_mfma_f32_16x16x32_bf16 v[164:167], a[96:99], a[148:151], v[164:167]
    v_mfma_f32_16x16x32_bf16 v[168:171], a[96:99], a[152:155], v[168:171]
    ds_read_b64_tr_b16 a[50:51], v231 offset:46752
    v_mfma_f32_16x16x32_bf16 v[172:175], a[96:99], a[156:159], v[172:175]
    s_add_u32 s24, s24, 4096
    v_mfma_f32_16x16x32_bf16 v[188:191], a[100:103], a[156:159], v[188:191]
    ds_read_b64_tr_b16 a[52:53], v231 offset:43200
    v_mfma_f32_16x16x32_bf16 v[184:187], a[100:103], a[152:155], v[184:187]
    ds_read_b64_tr_b16 a[54:55], v231 offset:46784
    v_mfma_f32_16x16x32_bf16 v[180:183], a[100:103], a[148:151], v[180:183]
    v_mfma_f32_16x16x32_bf16 v[176:179], a[100:103], a[144:147], v[176:179]
    v_mfma_f32_16x16x32_bf16 v[192:195], a[104:107], a[144:147], v[192:195]
    v_mfma_f32_16x16x32_bf16 v[196:199], a[104:107], a[148:151], v[196:199]
    v_mfma_f32_16x16x32_bf16 v[200:203], a[104:107], a[152:155], v[200:203]
    v_mfma_f32_16x16x32_bf16 v[204:207], a[104:107], a[156:159], v[204:207]
    v_mfma_f32_16x16x32_bf16 v[220:223], a[108:111], a[156:159], v[220:223]
    v_mfma_f32_16x16x32_bf16 v[216:219], a[108:111], a[152:155], v[216:219]
    v_mfma_f32_16x16x32_bf16 v[212:215], a[108:111], a[148:151], v[212:215]
    v_mfma_f32_16x16x32_bf16 v[208:211], a[108:111], a[144:147], v[208:211]
    s_waitcnt vmcnt(10) lgkmcnt(0)
    v_mfma_f32_16x16x32_bf16 v[0:3], a[0:3], a[112:115], v[0:3]
    ds_read_b64_tr_b16 a[56:57], v231 offset:35840
    v_mfma_f32_16x16x32_bf16 v[4:7], a[0:3], a[116:119], v[4:7]
    s_add_u32 m0, s26, 4096
    v_mfma_f32_16x16x32_bf16 v[8:11], a[0:3], a[120:123], v[8:11]
    ds_read_b64_tr_b16 a[58:59], v231 offset:39424
    v_mfma_f32_16x16x32_bf16 v[12:15], a[0:3], a[124:127], v[12:15]
    ds_read_b64_tr_b16 a[60:61], v231 offset:35872
    v_mfma_f32_16x16x32_bf16 v[28:31], a[4:7], a[124:127], v[28:31]
    buffer_load_dwordx4 v228, s[44:47], s25 offen offset:0 lds
    v_mfma_f32_16x16x32_bf16 v[24:27], a[4:7], a[120:123], v[24:27]
    v_mfma_f32_16x16x32_bf16 v[20:23], a[4:7], a[116:119], v[20:23]
    ds_read_b64_tr_b16 a[62:63], v231 offset:39456
    v_mfma_f32_16x16x32_bf16 v[16:19], a[4:7], a[112:115], v[16:19]
    ds_read_b64_tr_b16 a[64:65], v231 offset:35904
    v_mfma_f32_16x16x32_bf16 v[32:35], a[8:11], a[112:115], v[32:35]
    ds_read_b64_tr_b16 a[66:67], v231 offset:39488
    v_mfma_f32_16x16x32_bf16 v[36:39], a[8:11], a[116:119], v[36:39]
    buffer_load_dwordx4 v229, s[44:47], s25 offen offset:1024 lds
    v_mfma_f32_16x16x32_bf16 v[40:43], a[8:11], a[120:123], v[40:43]
    v_mfma_f32_16x16x32_bf16 v[44:47], a[8:11], a[124:127], v[44:47]
    ds_read_b64_tr_b16 a[68:69], v231 offset:35936
    v_mfma_f32_16x16x32_bf16 v[60:63], a[12:15], a[124:127], v[60:63]
    ds_read_b64_tr_b16 a[70:71], v231 offset:39520
    v_mfma_f32_16x16x32_bf16 v[56:59], a[12:15], a[120:123], v[56:59]
    ds_read_b64_tr_b16 a[72:73], v231 offset:35968
    v_mfma_f32_16x16x32_bf16 v[52:55], a[12:15], a[116:119], v[52:55]
    buffer_load_dwordx4 v230, s[44:47], s25 offen offset:2048 lds
    v_mfma_f32_16x16x32_bf16 v[48:51], a[12:15], a[112:115], v[48:51]
    v_mfma_f32_16x16x32_bf16 v[64:67], a[16:19], a[112:115], v[64:67]
    ds_read_b64_tr_b16 a[74:75], v231 offset:39552
    v_mfma_f32_16x16x32_bf16 v[68:71], a[16:19], a[116:119], v[68:71]
    ds_read_b64_tr_b16 a[76:77], v231 offset:36000
    v_mfma_f32_16x16x32_bf16 v[72:75], a[16:19], a[120:123], v[72:75]
    ds_read_b64_tr_b16 a[78:79], v231 offset:39584
    v_mfma_f32_16x16x32_bf16 v[76:79], a[16:19], a[124:127], v[76:79]
    s_add_u32 s25, s25, 458752
    v_mfma_f32_16x16x32_bf16 v[92:95], a[20:23], a[124:127], v[92:95]
    v_mfma_f32_16x16x32_bf16 v[88:91], a[20:23], a[120:123], v[88:91]
    ds_read_b64_tr_b16 a[80:81], v231 offset:36032
    v_mfma_f32_16x16x32_bf16 v[84:87], a[20:23], a[116:119], v[84:87]
    ds_read_b64_tr_b16 a[82:83], v231 offset:39616
    v_mfma_f32_16x16x32_bf16 v[80:83], a[20:23], a[112:115], v[80:83]
    ds_read_b64_tr_b16 a[84:85], v231 offset:50176
    v_mfma_f32_16x16x32_bf16 v[96:99], a[24:27], a[112:115], v[96:99]
    buffer_load_dwordx4 a[144:147], v241, s[8:11], s24 offen offset:0 sc1
    v_mfma_f32_16x16x32_bf16 v[100:103], a[24:27], a[116:119], v[100:103]
    ds_read_b64_tr_b16 a[86:87], v231 offset:53760
    v_mfma_f32_16x16x32_bf16 v[104:107], a[24:27], a[120:123], v[104:107]
    v_mfma_f32_16x16x32_bf16 v[108:111], a[24:27], a[124:127], v[108:111]
    ds_read_b64_tr_b16 a[88:89], v231 offset:50208
    v_mfma_f32_16x16x32_bf16 v[124:127], a[28:31], a[124:127], v[124:127]
    buffer_load_dwordx4 a[148:151], v241, s[8:11], s24 offen offset:1024 sc1
    v_mfma_f32_16x16x32_bf16 v[120:123], a[28:31], a[120:123], v[120:123]
    ds_read_b64_tr_b16 a[90:91], v231 offset:53792
    v_mfma_f32_16x16x32_bf16 v[116:119], a[28:31], a[116:119], v[116:119]
    ds_read_b64_tr_b16 a[92:93], v231 offset:50240
    v_mfma_f32_16x16x32_bf16 v[112:115], a[28:31], a[112:115], v[112:115]
    v_mfma_f32_16x16x32_bf16 v[128:131], a[32:35], a[112:115], v[128:131]
    ds_read_b64_tr_b16 a[94:95], v231 offset:53824
    v_mfma_f32_16x16x32_bf16 v[132:135], a[32:35], a[116:119], v[132:135]
    buffer_load_dwordx4 a[152:155], v241, s[8:11], s24 offen offset:2048 sc1
    v_mfma_f32_16x16x32_bf16 v[136:139], a[32:35], a[120:123], v[136:139]
    ds_read_b64_tr_b16 a[96:97], v231 offset:50272
    v_mfma_f32_16x16x32_bf16 v[140:143], a[32:35], a[124:127], v[140:143]
    ds_read_b64_tr_b16 a[98:99], v231 offset:53856
    v_mfma_f32_16x16x32_bf16 v[156:159], a[36:39], a[124:127], v[156:159]
    v_mfma_f32_16x16x32_bf16 v[152:155], a[36:39], a[120:123], v[152:155]
    ds_read_b64_tr_b16 a[100:101], v231 offset:50304
    v_mfma_f32_16x16x32_bf16 v[148:151], a[36:39], a[116:119], v[148:151]
    buffer_load_dwordx4 a[156:159], v241, s[8:11], s24 offen offset:3072 sc1
    v_mfma_f32_16x16x32_bf16 v[144:147], a[36:39], a[112:115], v[144:147]
    ds_read_b64_tr_b16 a[102:103], v231 offset:53888
    v_mfma_f32_16x16x32_bf16 v[160:163], a[40:43], a[112:115], v[160:163]
    ds_read_b64_tr_b16 a[104:105], v231 offset:50336
    v_mfma_f32_16x16x32_bf16 v[164:167], a[40:43], a[116:119], v[164:167]
    v_mfma_f32_16x16x32_bf16 v[168:171], a[40:43], a[120:123], v[168:171]
    ds_read_b64_tr_b16 a[106:107], v231 offset:53920
    v_mfma_f32_16x16x32_bf16 v[172:175], a[40:43], a[124:127], v[172:175]
    s_add_u32 s24, s24, 4096
    v_mfma_f32_16x16x32_bf16 v[188:191], a[44:47], a[124:127], v[188:191]
    ds_read_b64_tr_b16 a[108:109], v231 offset:50368
    v_mfma_f32_16x16x32_bf16 v[184:187], a[44:47], a[120:123], v[184:187]
    ds_read_b64_tr_b16 a[110:111], v231 offset:53952
    v_mfma_f32_16x16x32_bf16 v[180:183], a[44:47], a[116:119], v[180:183]
    v_mfma_f32_16x16x32_bf16 v[176:179], a[44:47], a[112:115], v[176:179]
    v_mfma_f32_16x16x32_bf16 v[192:195], a[48:51], a[112:115], v[192:195]
    v_mfma_f32_16x16x32_bf16 v[196:199], a[48:51], a[116:119], v[196:199]
    v_mfma_f32_16x16x32_bf16 v[200:203], a[48:51], a[120:123], v[200:203]
    v_mfma_f32_16x16x32_bf16 v[204:207], a[48:51], a[124:127], v[204:207]
    v_mfma_f32_16x16x32_bf16 v[220:223], a[52:55], a[124:127], v[220:223]
    v_mfma_f32_16x16x32_bf16 v[216:219], a[52:55], a[120:123], v[216:219]
    v_mfma_f32_16x16x32_bf16 v[212:215], a[52:55], a[116:119], v[212:215]
    v_mfma_f32_16x16x32_bf16 v[208:211], a[52:55], a[112:115], v[208:211]
    s_waitcnt vmcnt(7) lgkmcnt(0)
    s_barrier
    v_mfma_f32_16x16x32_bf16 v[0:3], a[56:59], a[128:131], v[0:3]
    ds_read_b64_tr_b16 a[0:1], v232 offset:0
    v_mfma_f32_16x16x32_bf16 v[4:7], a[56:59], a[132:135], v[4:7]
    s_add_u32 m0, s26, 28672
    v_mfma_f32_16x16x32_bf16 v[8:11], a[56:59], a[136:139], v[8:11]
    ds_read_b64_tr_b16 a[2:3], v232 offset:3584
    v_mfma_f32_16x16x32_bf16 v[12:15], a[56:59], a[140:143], v[12:15]
    ds_read_b64_tr_b16 a[4:5], v232 offset:32
    v_mfma_f32_16x16x32_bf16 v[28:31], a[60:63], a[140:143], v[28:31]
    buffer_load_dwordx4 v224, s[44:47], s25 offen offset:0 lds
    v_mfma_f32_16x16x32_bf16 v[24:27], a[60:63], a[136:139], v[24:27]
    v_mfma_f32_16x16x32_bf16 v[20:23], a[60:63], a[132:135], v[20:23]
    ds_read_b64_tr_b16 a[6:7], v232 offset:3616
    v_mfma_f32_16x16x32_bf16 v[16:19], a[60:63], a[128:131], v[16:19]
    ds_read_b64_tr_b16 a[8:9], v232 offset:64
    v_mfma_f32_16x16x32_bf16 v[32:35], a[64:67], a[128:131], v[32:35]
    ds_read_b64_tr_b16 a[10:11], v232 offset:3648
    v_mfma_f32_16x16x32_bf16 v[36:39], a[64:67], a[132:135], v[36:39]
    buffer_load_dwordx4 v225, s[44:47], s25 offen offset:1024 lds
    v_mfma_f32_16x16x32_bf16 v[40:43], a[64:67], a[136:139], v[40:43]
    v_mfma_f32_16x16x32_bf16 v[44:47], a[64:67], a[140:143], v[44:47]
    ds_read_b64_tr_b16 a[12:13], v232 offset:96
    v_mfma_f32_16x16x32_bf16 v[60:63], a[68:71], a[140:143], v[60:63]
    ds_read_b64_tr_b16 a[14:15], v232 offset:3680
    v_mfma_f32_16x16x32_bf16 v[56:59], a[68:71], a[136:139], v[56:59]
    ds_read_b64_tr_b16 a[16:17], v232 offset:128
    v_mfma_f32_16x16x32_bf16 v[52:55], a[68:71], a[132:135], v[52:55]
    buffer_load_dwordx4 v226, s[44:47], s25 offen offset:2048 lds
    v_mfma_f32_16x16x32_bf16 v[48:51], a[68:71], a[128:131], v[48:51]
    v_mfma_f32_16x16x32_bf16 v[64:67], a[72:75], a[128:131], v[64:67]
    ds_read_b64_tr_b16 a[18:19], v232 offset:3712
    v_mfma_f32_16x16x32_bf16 v[68:71], a[72:75], a[132:135], v[68:71]
    ds_read_b64_tr_b16 a[20:21], v232 offset:160
    v_mfma_f32_16x16x32_bf16 v[72:75], a[72:75], a[136:139], v[72:75]
    ds_read_b64_tr_b16 a[22:23], v232 offset:3744
    v_mfma_f32_16x16x32_bf16 v[76:79], a[72:75], a[140:143], v[76:79]
    buffer_load_dwordx4 v227, s[44:47], s25 offen offset:3072 lds
    v_mfma_f32_16x16x32_bf16 v[92:95], a[76:79], a[140:143], v[92:95]
    v_mfma_f32_16x16x32_bf16 v[88:91], a[76:79], a[136:139], v[88:91]
    ds_read_b64_tr_b16 a[24:25], v232 offset:192
    v_mfma_f32_16x16x32_bf16 v[84:87], a[76:79], a[132:135], v[84:87]
    ds_read_b64_tr_b16 a[26:27], v232 offset:3776
    v_mfma_f32_16x16x32_bf16 v[80:83], a[76:79], a[128:131], v[80:83]
    ds_read_b64_tr_b16 a[28:29], v232 offset:14336
    v_mfma_f32_16x16x32_bf16 v[96:99], a[80:83], a[128:131], v[96:99]
    buffer_load_dwordx4 a[112:115], v241, s[8:11], s24 offen offset:0 sc1
    v_mfma_f32_16x16x32_bf16 v[100:103], a[80:83], a[132:135], v[100:103]
    ds_read_b64_tr_b16 a[30:31], v232 offset:17920
    v_mfma_f32_16x16x32_bf16 v[104:107], a[80:83], a[136:139], v[104:107]
    v_mfma_f32_16x16x32_bf16 v[108:111], a[80:83], a[140:143], v[108:111]
    ds_read_b64_tr_b16 a[32:33], v232 offset:14368
    v_mfma_f32_16x16x32_bf16 v[124:127], a[84:87], a[140:143], v[124:127]
    buffer_load_dwordx4 a[116:119], v241, s[8:11], s24 offen offset:1024 sc1
    v_mfma_f32_16x16x32_bf16 v[120:123], a[84:87], a[136:139], v[120:123]
    ds_read_b64_tr_b16 a[34:35], v232 offset:17952
    v_mfma_f32_16x16x32_bf16 v[116:119], a[84:87], a[132:135], v[116:119]
    ds_read_b64_tr_b16 a[36:37], v232 offset:14400
    v_mfma_f32_16x16x32_bf16 v[112:115], a[84:87], a[128:131], v[112:115]
    v_mfma_f32_16x16x32_bf16 v[128:131], a[88:91], a[128:131], v[128:131]
    ds_read_b64_tr_b16 a[38:39], v232 offset:17984
    v_mfma_f32_16x16x32_bf16 v[132:135], a[88:91], a[132:135], v[132:135]
    buffer_load_dwordx4 a[120:123], v241, s[8:11], s24 offen offset:2048 sc1
    v_mfma_f32_16x16x32_bf16 v[136:139], a[88:91], a[136:139], v[136:139]
    ds_read_b64_tr_b16 a[40:41], v232 offset:14432
    v_mfma_f32_16x16x32_bf16 v[140:143], a[88:91], a[140:143], v[140:143]
    ds_read_b64_tr_b16 a[42:43], v232 offset:18016
    v_mfma_f32_16x16x32_bf16 v[156:159], a[92:95], a[140:143], v[156:159]
    v_mfma_f32_16x16x32_bf16 v[152:155], a[92:95], a[136:139], v[152:155]
    ds_read_b64_tr_b16 a[44:45], v232 offset:14464
    v_mfma_f32_16x16x32_bf16 v[148:151], a[92:95], a[132:135], v[148:151]
    buffer_load_dwordx4 a[124:127], v241, s[8:11], s24 offen offset:3072 sc1
    v_mfma_f32_16x16x32_bf16 v[144:147], a[92:95], a[128:131], v[144:147]
    ds_read_b64_tr_b16 a[46:47], v232 offset:18048
    v_mfma_f32_16x16x32_bf16 v[160:163], a[96:99], a[128:131], v[160:163]
    ds_read_b64_tr_b16 a[48:49], v232 offset:14496
    v_mfma_f32_16x16x32_bf16 v[164:167], a[96:99], a[132:135], v[164:167]
    v_mfma_f32_16x16x32_bf16 v[168:171], a[96:99], a[136:139], v[168:171]
    ds_read_b64_tr_b16 a[50:51], v232 offset:18080
    v_mfma_f32_16x16x32_bf16 v[172:175], a[96:99], a[140:143], v[172:175]
    s_add_u32 s24, s24, 4096
    v_mfma_f32_16x16x32_bf16 v[188:191], a[100:103], a[140:143], v[188:191]
    ds_read_b64_tr_b16 a[52:53], v232 offset:14528
    v_mfma_f32_16x16x32_bf16 v[184:187], a[100:103], a[136:139], v[184:187]
    ds_read_b64_tr_b16 a[54:55], v232 offset:18112
    v_mfma_f32_16x16x32_bf16 v[180:183], a[100:103], a[132:135], v[180:183]
    v_mfma_f32_16x16x32_bf16 v[176:179], a[100:103], a[128:131], v[176:179]
    v_mfma_f32_16x16x32_bf16 v[192:195], a[104:107], a[128:131], v[192:195]
    v_mfma_f32_16x16x32_bf16 v[196:199], a[104:107], a[132:135], v[196:199]
    v_mfma_f32_16x16x32_bf16 v[200:203], a[104:107], a[136:139], v[200:203]
    v_mfma_f32_16x16x32_bf16 v[204:207], a[104:107], a[140:143], v[204:207]
    v_mfma_f32_16x16x32_bf16 v[220:223], a[108:111], a[140:143], v[220:223]
    v_mfma_f32_16x16x32_bf16 v[216:219], a[108:111], a[136:139], v[216:219]
    v_mfma_f32_16x16x32_bf16 v[212:215], a[108:111], a[132:135], v[212:215]
    s_sub_u32 s20, s20, 1
    v_mfma_f32_16x16x32_bf16 v[208:211], a[108:111], a[128:131], v[208:211]
    s_cmp_lg_u32 s20, 0
    s_cbranch_scc1 gateup_loop
    s_waitcnt vmcnt(8) lgkmcnt(0)
    v_mfma_f32_16x16x32_bf16 v[0:3], a[0:3], a[144:147], v[0:3]
    ds_read_b64_tr_b16 a[56:57], v232 offset:7168
    v_mfma_f32_16x16x32_bf16 v[4:7], a[0:3], a[148:151], v[4:7]
    s_add_u32 m0, s26, 32768
    v_mfma_f32_16x16x32_bf16 v[8:11], a[0:3], a[152:155], v[8:11]
    ds_read_b64_tr_b16 a[58:59], v232 offset:10752
    v_mfma_f32_16x16x32_bf16 v[12:15], a[0:3], a[156:159], v[12:15]
    buffer_load_dwordx4 v228, s[44:47], s25 offen offset:0 lds
    v_mfma_f32_16x16x32_bf16 v[28:31], a[4:7], a[156:159], v[28:31]
    ds_read_b64_tr_b16 a[60:61], v232 offset:7200
    v_mfma_f32_16x16x32_bf16 v[24:27], a[4:7], a[152:155], v[24:27]
    ds_read_b64_tr_b16 a[62:63], v232 offset:10784
    v_mfma_f32_16x16x32_bf16 v[20:23], a[4:7], a[148:151], v[20:23]
    buffer_load_dwordx4 v229, s[44:47], s25 offen offset:1024 lds
    v_mfma_f32_16x16x32_bf16 v[16:19], a[4:7], a[144:147], v[16:19]
    ds_read_b64_tr_b16 a[64:65], v232 offset:7232
    v_mfma_f32_16x16x32_bf16 v[32:35], a[8:11], a[144:147], v[32:35]
    ds_read_b64_tr_b16 a[66:67], v232 offset:10816
    v_mfma_f32_16x16x32_bf16 v[36:39], a[8:11], a[148:151], v[36:39]
    buffer_load_dwordx4 v230, s[44:47], s25 offen offset:2048 lds
    v_mfma_f32_16x16x32_bf16 v[40:43], a[8:11], a[152:155], v[40:43]
    ds_read_b64_tr_b16 a[68:69], v232 offset:7264
    v_mfma_f32_16x16x32_bf16 v[44:47], a[8:11], a[156:159], v[44:47]
    v_mfma_f32_16x16x32_bf16 v[60:63], a[12:15], a[156:159], v[60:63]
    ds_read_b64_tr_b16 a[70:71], v232 offset:10848
    v_mfma_f32_16x16x32_bf16 v[56:59], a[12:15], a[152:155], v[56:59]
    s_add_u32 s25, s25, 458752
    v_mfma_f32_16x16x32_bf16 v[52:55], a[12:15], a[148:151], v[52:55]
    ds_read_b64_tr_b16 a[72:73], v232 offset:7296
    v_mfma_f32_16x16x32_bf16 v[48:51], a[12:15], a[144:147], v[48:51]
    ds_read_b64_tr_b16 a[74:75], v232 offset:10880
    v_mfma_f32_16x16x32_bf16 v[64:67], a[16:19], a[144:147], v[64:67]
    buffer_load_dwordx4 a[160:163], v241, s[8:11], s24 offen offset:0 sc1
    v_mfma_f32_16x16x32_bf16 v[68:71], a[16:19], a[148:151], v[68:71]
    ds_read_b64_tr_b16 a[76:77], v232 offset:7328
    v_mfma_f32_16x16x32_bf16 v[72:75], a[16:19], a[152:155], v[72:75]
    ds_read_b64_tr_b16 a[78:79], v232 offset:10912
    v_mfma_f32_16x16x32_bf16 v[76:79], a[16:19], a[156:159], v[76:79]
    buffer_load_dwordx4 a[164:167], v241, s[8:11], s24 offen offset:1024 sc1
    v_mfma_f32_16x16x32_bf16 v[92:95], a[20:23], a[156:159], v[92:95]
    ds_read_b64_tr_b16 a[80:81], v232 offset:7360
    v_mfma_f32_16x16x32_bf16 v[88:91], a[20:23], a[152:155], v[88:91]
    ds_read_b64_tr_b16 a[82:83], v232 offset:10944
    v_mfma_f32_16x16x32_bf16 v[84:87], a[20:23], a[148:151], v[84:87]
    buffer_load_dwordx4 a[168:171], v241, s[8:11], s24 offen offset:2048 sc1
    v_mfma_f32_16x16x32_bf16 v[80:83], a[20:23], a[144:147], v[80:83]
    v_mfma_f32_16x16x32_bf16 v[96:99], a[24:27], a[144:147], v[96:99]
    ds_read_b64_tr_b16 a[84:85], v232 offset:21504
    v_mfma_f32_16x16x32_bf16 v[100:103], a[24:27], a[148:151], v[100:103]
    buffer_load_dwordx4 a[172:175], v241, s[8:11], s24 offen offset:3072 sc1
    v_mfma_f32_16x16x32_bf16 v[104:107], a[24:27], a[152:155], v[104:107]
    ds_read_b64_tr_b16 a[86:87], v232 offset:25088
    v_mfma_f32_16x16x32_bf16 v[108:111], a[24:27], a[156:159], v[108:111]
    ds_read_b64_tr_b16 a[88:89], v232 offset:21536
    v_mfma_f32_16x16x32_bf16 v[124:127], a[28:31], a[156:159], v[124:127]
    s_add_u32 s24, s24, 4096
    v_mfma_f32_16x16x32_bf16 v[120:123], a[28:31], a[152:155], v[120:123]
    ds_read_b64_tr_b16 a[90:91], v232 offset:25120
    v_mfma_f32_16x16x32_bf16 v[116:119], a[28:31], a[148:151], v[116:119]
    ds_read_b64_tr_b16 a[92:93], v232 offset:21568
    v_mfma_f32_16x16x32_bf16 v[112:115], a[28:31], a[144:147], v[112:115]
    buffer_load_dwordx4 a[176:179], v241, s[8:11], s24 offen offset:0 sc1
    v_mfma_f32_16x16x32_bf16 v[128:131], a[32:35], a[144:147], v[128:131]
    ds_read_b64_tr_b16 a[94:95], v232 offset:25152
    v_mfma_f32_16x16x32_bf16 v[132:135], a[32:35], a[148:151], v[132:135]
    ds_read_b64_tr_b16 a[96:97], v232 offset:21600
    v_mfma_f32_16x16x32_bf16 v[136:139], a[32:35], a[152:155], v[136:139]
    buffer_load_dwordx4 a[180:183], v241, s[8:11], s24 offen offset:1024 sc1
    v_mfma_f32_16x16x32_bf16 v[140:143], a[32:35], a[156:159], v[140:143]
    v_mfma_f32_16x16x32_bf16 v[156:159], a[36:39], a[156:159], v[156:159]
    ds_read_b64_tr_b16 a[98:99], v232 offset:25184
    v_mfma_f32_16x16x32_bf16 v[152:155], a[36:39], a[152:155], v[152:155]
    ds_read_b64_tr_b16 a[100:101], v232 offset:21632
    v_mfma_f32_16x16x32_bf16 v[148:151], a[36:39], a[148:151], v[148:151]
    buffer_load_dwordx4 a[184:187], v241, s[8:11], s24 offen offset:2048 sc1
    v_mfma_f32_16x16x32_bf16 v[144:147], a[36:39], a[144:147], v[144:147]
    ds_read_b64_tr_b16 a[102:103], v232 offset:25216
    v_mfma_f32_16x16x32_bf16 v[160:163], a[40:43], a[144:147], v[160:163]
    ds_read_b64_tr_b16 a[104:105], v232 offset:21664
    v_mfma_f32_16x16x32_bf16 v[164:167], a[40:43], a[148:151], v[164:167]
    buffer_load_dwordx4 a[188:191], v241, s[8:11], s24 offen offset:3072 sc1
    v_mfma_f32_16x16x32_bf16 v[168:171], a[40:43], a[152:155], v[168:171]
    ds_read_b64_tr_b16 a[106:107], v232 offset:25248
    v_mfma_f32_16x16x32_bf16 v[172:175], a[40:43], a[156:159], v[172:175]
    ds_read_b64_tr_b16 a[108:109], v232 offset:21696
    v_mfma_f32_16x16x32_bf16 v[188:191], a[44:47], a[156:159], v[188:191]
    s_add_u32 s24, s24, 4096
    v_mfma_f32_16x16x32_bf16 v[184:187], a[44:47], a[152:155], v[184:187]
    ds_read_b64_tr_b16 a[110:111], v232 offset:25280
    v_mfma_f32_16x16x32_bf16 v[180:183], a[44:47], a[148:151], v[180:183]
    v_mfma_f32_16x16x32_bf16 v[176:179], a[44:47], a[144:147], v[176:179]
    v_mfma_f32_16x16x32_bf16 v[192:195], a[48:51], a[144:147], v[192:195]
    v_mfma_f32_16x16x32_bf16 v[196:199], a[48:51], a[148:151], v[196:199]
    v_mfma_f32_16x16x32_bf16 v[200:203], a[48:51], a[152:155], v[200:203]
    v_mfma_f32_16x16x32_bf16 v[204:207], a[48:51], a[156:159], v[204:207]
    v_mfma_f32_16x16x32_bf16 v[220:223], a[52:55], a[156:159], v[220:223]
    v_mfma_f32_16x16x32_bf16 v[216:219], a[52:55], a[152:155], v[216:219]
    v_mfma_f32_16x16x32_bf16 v[212:215], a[52:55], a[148:151], v[212:215]
    v_mfma_f32_16x16x32_bf16 v[208:211], a[52:55], a[144:147], v[208:211]
    s_waitcnt vmcnt(11) lgkmcnt(0)
    s_barrier
    v_mfma_f32_16x16x32_bf16 v[0:3], a[56:59], a[112:115], v[0:3]
    ds_read_b64_tr_b16 a[0:1], v231 offset:0
    v_mfma_f32_16x16x32_bf16 v[4:7], a[56:59], a[116:119], v[4:7]
    buffer_load_dwordx4 a[192:195], v241, s[8:11], s24 offen offset:0 sc1
    v_mfma_f32_16x16x32_bf16 v[8:11], a[56:59], a[120:123], v[8:11]
    v_mfma_f32_16x16x32_bf16 v[12:15], a[56:59], a[124:127], v[12:15]
    buffer_load_dwordx4 a[196:199], v241, s[8:11], s24 offen offset:1024 sc1
    v_mfma_f32_16x16x32_bf16 v[28:31], a[60:63], a[124:127], v[28:31]
    ds_read_b64_tr_b16 a[2:3], v231 offset:3584
    v_mfma_f32_16x16x32_bf16 v[24:27], a[60:63], a[120:123], v[24:27]
    v_mfma_f32_16x16x32_bf16 v[20:23], a[60:63], a[116:119], v[20:23]
    buffer_load_dwordx4 a[200:203], v241, s[8:11], s24 offen offset:2048 sc1
    v_mfma_f32_16x16x32_bf16 v[16:19], a[60:63], a[112:115], v[16:19]
    ds_read_b64_tr_b16 a[4:5], v231 offset:14336
    v_mfma_f32_16x16x32_bf16 v[32:35], a[64:67], a[112:115], v[32:35]
    v_mfma_f32_16x16x32_bf16 v[36:39], a[64:67], a[116:119], v[36:39]
    buffer_load_dwordx4 a[204:207], v241, s[8:11], s24 offen offset:3072 sc1
    v_mfma_f32_16x16x32_bf16 v[40:43], a[64:67], a[120:123], v[40:43]
    ds_read_b64_tr_b16 a[6:7], v231 offset:17920
    v_mfma_f32_16x16x32_bf16 v[44:47], a[64:67], a[124:127], v[44:47]
    v_mfma_f32_16x16x32_bf16 v[60:63], a[68:71], a[124:127], v[60:63]
    s_add_u32 s24, s24, 4096
    v_mfma_f32_16x16x32_bf16 v[56:59], a[68:71], a[120:123], v[56:59]
    v_mfma_f32_16x16x32_bf16 v[52:55], a[68:71], a[116:119], v[52:55]
    ds_read_b64_tr_b16 a[8:9], v231 offset:7168
    v_mfma_f32_16x16x32_bf16 v[48:51], a[68:71], a[112:115], v[48:51]
    buffer_load_dwordx4 a[208:211], v241, s[8:11], s24 offen offset:0 sc1
    v_mfma_f32_16x16x32_bf16 v[64:67], a[72:75], a[112:115], v[64:67]
    v_mfma_f32_16x16x32_bf16 v[68:71], a[72:75], a[116:119], v[68:71]
    buffer_load_dwordx4 a[212:215], v241, s[8:11], s24 offen offset:1024 sc1
    v_mfma_f32_16x16x32_bf16 v[72:75], a[72:75], a[120:123], v[72:75]
    ds_read_b64_tr_b16 a[10:11], v231 offset:10752
    v_mfma_f32_16x16x32_bf16 v[76:79], a[72:75], a[124:127], v[76:79]
    v_mfma_f32_16x16x32_bf16 v[92:95], a[76:79], a[124:127], v[92:95]
    buffer_load_dwordx4 a[216:219], v241, s[8:11], s24 offen offset:2048 sc1
    v_mfma_f32_16x16x32_bf16 v[88:91], a[76:79], a[120:123], v[88:91]
    ds_read_b64_tr_b16 a[12:13], v231 offset:21504
    v_mfma_f32_16x16x32_bf16 v[84:87], a[76:79], a[116:119], v[84:87]
    v_mfma_f32_16x16x32_bf16 v[80:83], a[76:79], a[112:115], v[80:83]
    buffer_load_dwordx4 a[220:223], v241, s[8:11], s24 offen offset:3072 sc1
    v_mfma_f32_16x16x32_bf16 v[96:99], a[80:83], a[112:115], v[96:99]
    ds_read_b64_tr_b16 a[14:15], v231 offset:25088
    v_mfma_f32_16x16x32_bf16 v[100:103], a[80:83], a[116:119], v[100:103]
    v_mfma_f32_16x16x32_bf16 v[104:107], a[80:83], a[120:123], v[104:107]
    s_add_u32 s24, s24, 4096
    v_mfma_f32_16x16x32_bf16 v[108:111], a[80:83], a[124:127], v[108:111]
    s_waitcnt vmcnt(16)
    s_barrier
    v_mfma_f32_16x16x32_bf16 v[124:127], a[84:87], a[124:127], v[124:127]
    ds_read_b64_tr_b16 a[16:17], v231 offset:28672
    v_mfma_f32_16x16x32_bf16 v[120:123], a[84:87], a[120:123], v[120:123]
    ds_read_b64_tr_b16 a[18:19], v231 offset:32256
    v_mfma_f32_16x16x32_bf16 v[116:119], a[84:87], a[116:119], v[116:119]
    v_mfma_f32_16x16x32_bf16 v[112:115], a[84:87], a[112:115], v[112:115]
    ds_read_b64_tr_b16 a[20:21], v231 offset:43008
    v_mfma_f32_16x16x32_bf16 v[128:131], a[88:91], a[112:115], v[128:131]
    v_mfma_f32_16x16x32_bf16 v[132:135], a[88:91], a[116:119], v[132:135]
    ds_read_b64_tr_b16 a[22:23], v231 offset:46592
    v_mfma_f32_16x16x32_bf16 v[136:139], a[88:91], a[120:123], v[136:139]
    v_mfma_f32_16x16x32_bf16 v[140:143], a[88:91], a[124:127], v[140:143]
    ds_read_b64_tr_b16 a[24:25], v231 offset:35840
    v_mfma_f32_16x16x32_bf16 v[156:159], a[92:95], a[124:127], v[156:159]
    ds_read_b64_tr_b16 a[26:27], v231 offset:39424
    v_mfma_f32_16x16x32_bf16 v[152:155], a[92:95], a[120:123], v[152:155]
    v_mfma_f32_16x16x32_bf16 v[148:151], a[92:95], a[116:119], v[148:151]
    ds_read_b64_tr_b16 a[28:29], v231 offset:50176
    v_mfma_f32_16x16x32_bf16 v[144:147], a[92:95], a[112:115], v[144:147]
    v_mfma_f32_16x16x32_bf16 v[160:163], a[96:99], a[112:115], v[160:163]
    ds_read_b64_tr_b16 a[30:31], v231 offset:53760
    v_mfma_f32_16x16x32_bf16 v[164:167], a[96:99], a[116:119], v[164:167]
    v_mfma_f32_16x16x32_bf16 v[168:171], a[96:99], a[120:123], v[168:171]
    v_mfma_f32_16x16x32_bf16 v[172:175], a[96:99], a[124:127], v[172:175]
    v_mfma_f32_16x16x32_bf16 v[188:191], a[100:103], a[124:127], v[188:191]
    v_mfma_f32_16x16x32_bf16 v[184:187], a[100:103], a[120:123], v[184:187]
    v_mfma_f32_16x16x32_bf16 v[180:183], a[100:103], a[116:119], v[180:183]
    v_mfma_f32_16x16x32_bf16 v[176:179], a[100:103], a[112:115], v[176:179]
    v_mfma_f32_16x16x32_bf16 v[192:195], a[104:107], a[112:115], v[192:195]
    v_mfma_f32_16x16x32_bf16 v[196:199], a[104:107], a[116:119], v[196:199]
    v_mfma_f32_16x16x32_bf16 v[200:203], a[104:107], a[120:123], v[200:203]
    v_mfma_f32_16x16x32_bf16 v[204:207], a[104:107], a[124:127], v[204:207]
    v_mfma_f32_16x16x32_bf16 v[220:223], a[108:111], a[124:127], v[220:223]
    v_mfma_f32_16x16x32_bf16 v[216:219], a[108:111], a[120:123], v[216:219]
    v_mfma_f32_16x16x32_bf16 v[212:215], a[108:111], a[116:119], v[212:215]
    v_mfma_f32_16x16x32_bf16 v[208:211], a[108:111], a[112:115], v[208:211]
    s_xor_b32 s30, s30, 0x10000
    s_add_u32 s6, s6, 32768
    s_mul_i32 s27, s35, 458752
    s_add_u32 s27, s27, 25165824
    s_lshr_b32 s4, s23, 1
    s_lshl_b32 s4, s4, 11
    s_add_u32 s27, s27, s4
    s_and_b32 s4, s23, 1
    s_lshl_b32 s4, s4, 9
    s_add_u32 s27, s27, s4
    s_lshl_b32 s28, s22, 5
    s_add_u32 s28, s28, s23
    s_lshl_b32 s28, s28, 7
    s_add_u32 s57, s28, 40501248
    s_add_u32 s28, s28, 40468480
    s_waitcnt vmcnt(0) lgkmcnt(0)
    v_mfma_f32_16x16x32_bf16 v[0:3], a[0:3], a[160:163], v[0:3]
    v_mfma_f32_16x16x32_bf16 v[4:7], a[0:3], a[164:167], v[4:7]
    ds_read_b64_tr_b16 a[56:57], v231 offset:32
    v_mfma_f32_16x16x32_bf16 v[8:11], a[0:3], a[168:171], v[8:11]
    s_add_u32 s7, s6, s48
    v_mfma_f32_16x16x32_bf16 v[12:15], a[0:3], a[172:175], v[12:15]
    ds_read_b64_tr_b16 a[58:59], v231 offset:3616
    v_mfma_f32_16x16x32_bf16 v[124:127], a[4:7], a[172:175], v[124:127]
    ds_read_b64_tr_b16 a[60:61], v231 offset:14368
    v_mfma_f32_16x16x32_bf16 v[120:123], a[4:7], a[168:171], v[120:123]
    s_add_u32 m0, s30, 32768
    v_mfma_f32_16x16x32_bf16 v[116:119], a[4:7], a[164:167], v[116:119]
    ds_read_b64_tr_b16 a[62:63], v231 offset:17952
    v_mfma_f32_16x16x32_bf16 v[112:115], a[4:7], a[160:163], v[112:115]
    ds_read_b64_tr_b16 a[64:65], v231 offset:7200
    v_mfma_f32_16x16x32_bf16 v[0:3], a[8:11], a[176:179], v[0:3]
    buffer_load_dwordx4 v249, s[40:43], s7 offen offset:0 lds
    v_mfma_f32_16x16x32_bf16 v[4:7], a[8:11], a[180:183], v[4:7]
    ds_read_b64_tr_b16 a[66:67], v231 offset:10784
    v_mfma_f32_16x16x32_bf16 v[8:11], a[8:11], a[184:187], v[8:11]
    ds_read_b64_tr_b16 a[68:69], v231 offset:21536
    v_mfma_f32_16x16x32_bf16 v[12:15], a[8:11], a[188:191], v[12:15]
    buffer_load_dwordx4 v250, s[40:43], s7 offen offset:1024 lds
    v_mfma_f32_16x16x32_bf16 v[124:127], a[12:15], a[188:191], v[124:127]
    ds_read_b64_tr_b16 a[70:71], v231 offset:25120
    v_mfma_f32_16x16x32_bf16 v[120:123], a[12:15], a[184:187], v[120:123]
    v_mfma_f32_16x16x32_bf16 v[116:119], a[12:15], a[180:183], v[116:119]
    ds_read_b64_tr_b16 a[72:73], v231 offset:28704
    v_mfma_f32_16x16x32_bf16 v[112:115], a[12:15], a[176:179], v[112:115]
    s_xor_b32 s31, s7, 128
    v_mfma_f32_16x16x32_bf16 v[0:3], a[16:19], a[192:195], v[0:3]
    ds_read_b64_tr_b16 a[74:75], v231 offset:32288
    v_mfma_f32_16x16x32_bf16 v[4:7], a[16:19], a[196:199], v[4:7]
    ds_read_b64_tr_b16 a[76:77], v231 offset:43040
    v_mfma_f32_16x16x32_bf16 v[8:11], a[16:19], a[200:203], v[8:11]
    s_add_u32 m0, s30, 40960
    v_mfma_f32_16x16x32_bf16 v[12:15], a[16:19], a[204:207], v[12:15]
    ds_read_b64_tr_b16 a[78:79], v231 offset:46624
    v_mfma_f32_16x16x32_bf16 v[124:127], a[20:23], a[204:207], v[124:127]
    ds_read_b64_tr_b16 a[80:81], v231 offset:35872
    v_mfma_f32_16x16x32_bf16 v[120:123], a[20:23], a[200:203], v[120:123]
    buffer_load_dwordx4 v249, s[40:43], s31 offen offset:0 lds
    v_mfma_f32_16x16x32_bf16 v[116:119], a[20:23], a[196:199], v[116:119]
    ds_read_b64_tr_b16 a[82:83], v231 offset:39456
    v_mfma_f32_16x16x32_bf16 v[112:115], a[20:23], a[192:195], v[112:115]
    ds_read_b64_tr_b16 a[84:85], v231 offset:50208
    v_mfma_f32_16x16x32_bf16 v[0:3], a[24:27], a[208:211], v[0:3]
    buffer_load_dwordx4 v250, s[40:43], s31 offen offset:1024 lds
    v_mfma_f32_16x16x32_bf16 v[4:7], a[24:27], a[212:215], v[4:7]
    ds_read_b64_tr_b16 a[86:87], v231 offset:53792
    v_mfma_f32_16x16x32_bf16 v[8:11], a[24:27], a[216:219], v[8:11]
    v_mfma_f32_16x16x32_bf16 v[12:15], a[24:27], a[220:223], v[12:15]
    v_mfma_f32_16x16x32_bf16 v[124:127], a[28:31], a[220:223], v[124:127]
    v_mfma_f32_16x16x32_bf16 v[120:123], a[28:31], a[216:219], v[120:123]
    v_mfma_f32_16x16x32_bf16 v[116:119], a[28:31], a[212:215], v[116:119]
    v_mfma_f32_16x16x32_bf16 v[112:115], a[28:31], a[208:211], v[112:115]
    s_waitcnt lgkmcnt(0)
    v_mfma_f32_16x16x32_bf16 v[16:19], a[56:59], a[160:163], v[16:19]
    v_mfma_f32_16x16x32_bf16 v[20:23], a[56:59], a[164:167], v[20:23]
    ds_read_b64_tr_b16 a[0:1], v231 offset:64
    v_mfma_f32_16x16x32_bf16 v[24:27], a[56:59], a[168:171], v[24:27]
    s_add_u32 s7, s6, s49
    v_mfma_f32_16x16x32_bf16 v[28:31], a[56:59], a[172:175], v[28:31]
    ds_read_b64_tr_b16 a[2:3], v231 offset:3648
    v_mfma_f32_16x16x32_bf16 v[140:143], a[60:63], a[172:175], v[140:143]
    ds_read_b64_tr_b16 a[4:5], v231 offset:14400
    v_mfma_f32_16x16x32_bf16 v[136:139], a[60:63], a[168:171], v[136:139]
    s_add_u32 m0, s30, 49152
    v_mul_f32 v0, v0, v112
    v_mfma_f32_16x16x32_bf16 v[132:135], a[60:63], a[164:167], v[132:135]
    ds_read_b64_tr_b16 a[6:7], v231 offset:17984
    v_mul_f32 v1, v1, v113
    v_mfma_f32_16x16x32_bf16 v[128:131], a[60:63], a[160:163], v[128:131]
    ds_read_b64_tr_b16 a[8:9], v231 offset:7232
    v_mul_f32 v2, v2, v114
    v_mfma_f32_16x16x32_bf16 v[16:19], a[64:67], a[176:179], v[16:19]
    buffer_load_dwordx4 v249, s[40:43], s7 offen offset:0 lds
    v_mul_f32 v3, v3, v115
    v_mfma_f32_16x16x32_bf16 v[20:23], a[64:67], a[180:183], v[20:23]
    ds_read_b64_tr_b16 a[10:11], v231 offset:10816
    v_cvt_pk_bf16_f32 v0, v0, v1
    v_mfma_f32_16x16x32_bf16 v[24:27], a[64:67], a[184:187], v[24:27]
    ds_read_b64_tr_b16 a[12:13], v231 offset:21568
    v_cvt_pk_bf16_f32 v1, v2, v3
    v_mul_f32 v4, v4, v116
    v_mfma_f32_16x16x32_bf16 v[28:31], a[64:67], a[188:191], v[28:31]
    buffer_load_dwordx4 v250, s[40:43], s7 offen offset:1024 lds
    v_mul_f32 v5, v5, v117
    v_mfma_f32_16x16x32_bf16 v[140:143], a[68:71], a[188:191], v[140:143]
    ds_read_b64_tr_b16 a[14:15], v231 offset:25152
    v_mul_f32 v6, v6, v118
    v_mfma_f32_16x16x32_bf16 v[136:139], a[68:71], a[184:187], v[136:139]
    v_mul_f32 v7, v7, v119
    v_mfma_f32_16x16x32_bf16 v[132:135], a[68:71], a[180:183], v[132:135]
    ds_read_b64_tr_b16 a[16:17], v231 offset:28736
    v_cvt_pk_bf16_f32 v2, v4, v5
    v_mfma_f32_16x16x32_bf16 v[128:131], a[68:71], a[176:179], v[128:131]
    s_xor_b32 s31, s7, 128
    v_cvt_pk_bf16_f32 v3, v6, v7
    v_mul_f32 v8, v8, v120
    v_mfma_f32_16x16x32_bf16 v[16:19], a[72:75], a[192:195], v[16:19]
    ds_read_b64_tr_b16 a[18:19], v231 offset:32320
    v_mul_f32 v9, v9, v121
    v_mfma_f32_16x16x32_bf16 v[20:23], a[72:75], a[196:199], v[20:23]
    ds_read_b64_tr_b16 a[20:21], v231 offset:43072
    v_mul_f32 v10, v10, v122
    v_mfma_f32_16x16x32_bf16 v[24:27], a[72:75], a[200:203], v[24:27]
    s_add_u32 m0, s30, 57344
    v_mul_f32 v11, v11, v123
    v_mfma_f32_16x16x32_bf16 v[28:31], a[72:75], a[204:207], v[28:31]
    ds_read_b64_tr_b16 a[22:23], v231 offset:46656
    v_cvt_pk_bf16_f32 v8, v8, v9
    v_mfma_f32_16x16x32_bf16 v[140:143], a[76:79], a[204:207], v[140:143]
    ds_read_b64_tr_b16 a[24:25], v231 offset:35904
    v_cvt_pk_bf16_f32 v9, v10, v11
    v_mfma_f32_16x16x32_bf16 v[136:139], a[76:79], a[200:203], v[136:139]
    buffer_load_dwordx4 v249, s[40:43], s31 offen offset:0 lds
    v_mul_f32 v12, v12, v124
    v_mul_f32 v13, v13, v125
    v_mfma_f32_16x16x32_bf16 v[132:135], a[76:79], a[196:199], v[132:135]
    ds_read_b64_tr_b16 a[26:27], v231 offset:39488
    v_mul_f32 v14, v14, v126
    v_mfma_f32_16x16x32_bf16 v[128:131], a[76:79], a[192:195], v[128:131]
    ds_read_b64_tr_b16 a[28:29], v231 offset:50240
    v_mul_f32 v15, v15, v127
    v_mfma_f32_16x16x32_bf16 v[16:19], a[80:83], a[208:211], v[16:19]
    buffer_load_dwordx4 v250, s[40:43], s31 offen offset:1024 lds
    v_cvt_pk_bf16_f32 v10, v12, v13
    v_mfma_f32_16x16x32_bf16 v[20:23], a[80:83], a[212:215], v[20:23]
    ds_read_b64_tr_b16 a[30:31], v231 offset:53824
    v_cvt_pk_bf16_f32 v11, v14, v15
    v_mfma_f32_16x16x32_bf16 v[24:27], a[80:83], a[216:219], v[24:27]
    s_nop 0
    v_permlane32_swap_b32 v0, v2
    v_mfma_f32_16x16x32_bf16 v[28:31], a[80:83], a[220:223], v[28:31]
    v_permlane32_swap_b32 v1, v3
    v_mfma_f32_16x16x32_bf16 v[140:143], a[84:87], a[220:223], v[140:143]
    buffer_store_dwordx4 v[0:3], v237, s[8:11], s27 offen sc1
    v_mfma_f32_16x16x32_bf16 v[136:139], a[84:87], a[216:219], v[136:139]
    v_permlane32_swap_b32 v8, v10
    v_mfma_f32_16x16x32_bf16 v[132:135], a[84:87], a[212:215], v[132:135]
    v_permlane32_swap_b32 v9, v11
    v_mfma_f32_16x16x32_bf16 v[128:131], a[84:87], a[208:211], v[128:131]
    buffer_store_dwordx4 v[8:11], v238, s[8:11], s27 offen sc1
    s_add_u32 s27, s27, 32768
    s_waitcnt lgkmcnt(0)
    v_mfma_f32_16x16x32_bf16 v[32:35], a[0:3], a[160:163], v[32:35]
    v_mfma_f32_16x16x32_bf16 v[36:39], a[0:3], a[164:167], v[36:39]
    ds_read_b64_tr_b16 a[56:57], v231 offset:96
    v_mfma_f32_16x16x32_bf16 v[40:43], a[0:3], a[168:171], v[40:43]
    v_mfma_f32_16x16x32_bf16 v[44:47], a[0:3], a[172:175], v[44:47]
    ds_read_b64_tr_b16 a[58:59], v231 offset:3680
    v_mfma_f32_16x16x32_bf16 v[156:159], a[4:7], a[172:175], v[156:159]
    ds_read_b64_tr_b16 a[60:61], v231 offset:14432
    v_mfma_f32_16x16x32_bf16 v[152:155], a[4:7], a[168:171], v[152:155]
    v_mul_f32 v16, v16, v128
    v_mfma_f32_16x16x32_bf16 v[148:151], a[4:7], a[164:167], v[148:151]
    ds_read_b64_tr_b16 a[62:63], v231 offset:18016
    v_mul_f32 v17, v17, v129
    v_mfma_f32_16x16x32_bf16 v[144:147], a[4:7], a[160:163], v[144:147]
    v_mul_f32 v18, v18, v130
    v_mfma_f32_16x16x32_bf16 v[32:35], a[8:11], a[176:179], v[32:35]
    ds_read_b64_tr_b16 a[64:65], v231 offset:7264
    v_mul_f32 v19, v19, v131
    v_mfma_f32_16x16x32_bf16 v[36:39], a[8:11], a[180:183], v[36:39]
    ds_read_b64_tr_b16 a[66:67], v231 offset:10848
    v_cvt_pk_bf16_f32 v16, v16, v17
    v_mfma_f32_16x16x32_bf16 v[40:43], a[8:11], a[184:187], v[40:43]
    v_cvt_pk_bf16_f32 v17, v18, v19
    v_mul_f32 v20, v20, v132
    v_mfma_f32_16x16x32_bf16 v[44:47], a[8:11], a[188:191], v[44:47]
    ds_read_b64_tr_b16 a[68:69], v231 offset:21600
    v_mul_f32 v21, v21, v133
    v_mfma_f32_16x16x32_bf16 v[156:159], a[12:15], a[188:191], v[156:159]
    ds_read_b64_tr_b16 a[70:71], v231 offset:25184
    v_mul_f32 v22, v22, v134
    v_mfma_f32_16x16x32_bf16 v[152:155], a[12:15], a[184:187], v[152:155]
    v_mul_f32 v23, v23, v135
    v_mfma_f32_16x16x32_bf16 v[148:151], a[12:15], a[180:183], v[148:151]
    ds_read_b64_tr_b16 a[72:73], v231 offset:28768
    v_cvt_pk_bf16_f32 v18, v20, v21
    v_mfma_f32_16x16x32_bf16 v[144:147], a[12:15], a[176:179], v[144:147]
    v_cvt_pk_bf16_f32 v19, v22, v23
    v_mul_f32 v24, v24, v136
    v_mfma_f32_16x16x32_bf16 v[32:35], a[16:19], a[192:195], v[32:35]
    ds_read_b64_tr_b16 a[74:75], v231 offset:32352
    v_mul_f32 v25, v25, v137
    v_mfma_f32_16x16x32_bf16 v[36:39], a[16:19], a[196:199], v[36:39]
    ds_read_b64_tr_b16 a[76:77], v231 offset:43104
    v_mul_f32 v26, v26, v138
    v_mfma_f32_16x16x32_bf16 v[40:43], a[16:19], a[200:203], v[40:43]
    v_mul_f32 v27, v27, v139
    v_mfma_f32_16x16x32_bf16 v[44:47], a[16:19], a[204:207], v[44:47]
    ds_read_b64_tr_b16 a[78:79], v231 offset:46688
    v_cvt_pk_bf16_f32 v24, v24, v25
    v_mfma_f32_16x16x32_bf16 v[156:159], a[20:23], a[204:207], v[156:159]
    v_cvt_pk_bf16_f32 v25, v26, v27
    v_mfma_f32_16x16x32_bf16 v[152:155], a[20:23], a[200:203], v[152:155]
    ds_read_b64_tr_b16 a[80:81], v231 offset:35936
    v_mul_f32 v28, v28, v140
    v_mul_f32 v29, v29, v141
    v_mfma_f32_16x16x32_bf16 v[148:151], a[20:23], a[196:199], v[148:151]
    ds_read_b64_tr_b16 a[82:83], v231 offset:39520
    v_mul_f32 v30, v30, v142
    v_mfma_f32_16x16x32_bf16 v[144:147], a[20:23], a[192:195], v[144:147]
    v_mul_f32 v31, v31, v143
    v_mfma_f32_16x16x32_bf16 v[32:35], a[24:27], a[208:211], v[32:35]
    ds_read_b64_tr_b16 a[84:85], v231 offset:50272
    v_cvt_pk_bf16_f32 v26, v28, v29
    v_mfma_f32_16x16x32_bf16 v[36:39], a[24:27], a[212:215], v[36:39]
    ds_read_b64_tr_b16 a[86:87], v231 offset:53856
    v_cvt_pk_bf16_f32 v27, v30, v31
    v_mfma_f32_16x16x32_bf16 v[40:43], a[24:27], a[216:219], v[40:43]
    s_nop 0
    v_permlane32_swap_b32 v16, v18
    v_mfma_f32_16x16x32_bf16 v[44:47], a[24:27], a[220:223], v[44:47]
    v_permlane32_swap_b32 v17, v19
    v_mfma_f32_16x16x32_bf16 v[156:159], a[28:31], a[220:223], v[156:159]
    buffer_store_dwordx4 v[16:19], v237, s[8:11], s27 offen sc1
    v_mfma_f32_16x16x32_bf16 v[152:155], a[28:31], a[216:219], v[152:155]
    v_permlane32_swap_b32 v24, v26
    v_mfma_f32_16x16x32_bf16 v[148:151], a[28:31], a[212:215], v[148:151]
    v_permlane32_swap_b32 v25, v27
    v_mfma_f32_16x16x32_bf16 v[144:147], a[28:31], a[208:211], v[144:147]
    buffer_store_dwordx4 v[24:27], v238, s[8:11], s27 offen sc1
    s_add_u32 s27, s27, 32768
    s_waitcnt lgkmcnt(0)
    v_mfma_f32_16x16x32_bf16 v[48:51], a[56:59], a[160:163], v[48:51]
    v_mfma_f32_16x16x32_bf16 v[52:55], a[56:59], a[164:167], v[52:55]
    ds_read_b64_tr_b16 a[0:1], v231 offset:128
    v_mfma_f32_16x16x32_bf16 v[56:59], a[56:59], a[168:171], v[56:59]
    v_mfma_f32_16x16x32_bf16 v[60:63], a[56:59], a[172:175], v[60:63]
    ds_read_b64_tr_b16 a[2:3], v231 offset:3712
    v_mfma_f32_16x16x32_bf16 v[172:175], a[60:63], a[172:175], v[172:175]
    ds_read_b64_tr_b16 a[4:5], v231 offset:14464
    v_mfma_f32_16x16x32_bf16 v[168:171], a[60:63], a[168:171], v[168:171]
    v_mul_f32 v32, v32, v144
    v_mfma_f32_16x16x32_bf16 v[164:167], a[60:63], a[164:167], v[164:167]
    ds_read_b64_tr_b16 a[6:7], v231 offset:18048
    v_mul_f32 v33, v33, v145
    v_mfma_f32_16x16x32_bf16 v[160:163], a[60:63], a[160:163], v[160:163]
    v_mul_f32 v34, v34, v146
    v_mfma_f32_16x16x32_bf16 v[48:51], a[64:67], a[176:179], v[48:51]
    ds_read_b64_tr_b16 a[8:9], v231 offset:7296
    v_mul_f32 v35, v35, v147
    v_mfma_f32_16x16x32_bf16 v[52:55], a[64:67], a[180:183], v[52:55]
    ds_read_b64_tr_b16 a[10:11], v231 offset:10880
    v_cvt_pk_bf16_f32 v32, v32, v33
    v_mfma_f32_16x16x32_bf16 v[56:59], a[64:67], a[184:187], v[56:59]
    v_cvt_pk_bf16_f32 v33, v34, v35
    v_mul_f32 v36, v36, v148
    v_mfma_f32_16x16x32_bf16 v[60:63], a[64:67], a[188:191], v[60:63]
    ds_read_b64_tr_b16 a[12:13], v231 offset:21632
    v_mul_f32 v37, v37, v149
    v_mfma_f32_16x16x32_bf16 v[172:175], a[68:71], a[188:191], v[172:175]
    ds_read_b64_tr_b16 a[14:15], v231 offset:25216
    v_mul_f32 v38, v38, v150
    v_mfma_f32_16x16x32_bf16 v[168:171], a[68:71], a[184:187], v[168:171]
    v_mul_f32 v39, v39, v151
    v_mfma_f32_16x16x32_bf16 v[164:167], a[68:71], a[180:183], v[164:167]
    ds_read_b64_tr_b16 a[16:17], v231 offset:28800
    v_cvt_pk_bf16_f32 v34, v36, v37
    v_mfma_f32_16x16x32_bf16 v[160:163], a[68:71], a[176:179], v[160:163]
    v_cvt_pk_bf16_f32 v35, v38, v39
    v_mul_f32 v40, v40, v152
    v_mfma_f32_16x16x32_bf16 v[48:51], a[72:75], a[192:195], v[48:51]
    ds_read_b64_tr_b16 a[18:19], v231 offset:32384
    v_mul_f32 v41, v41, v153
    v_mfma_f32_16x16x32_bf16 v[52:55], a[72:75], a[196:199], v[52:55]
    ds_read_b64_tr_b16 a[20:21], v231 offset:43136
    v_mul_f32 v42, v42, v154
    v_mfma_f32_16x16x32_bf16 v[56:59], a[72:75], a[200:203], v[56:59]
    v_mul_f32 v43, v43, v155
    v_mfma_f32_16x16x32_bf16 v[60:63], a[72:75], a[204:207], v[60:63]
    ds_read_b64_tr_b16 a[22:23], v231 offset:46720
    v_cvt_pk_bf16_f32 v40, v40, v41
    v_mfma_f32_16x16x32_bf16 v[172:175], a[76:79], a[204:207], v[172:175]
    v_cvt_pk_bf16_f32 v41, v42, v43
    v_mfma_f32_16x16x32_bf16 v[168:171], a[76:79], a[200:203], v[168:171]
    ds_read_b64_tr_b16 a[24:25], v231 offset:35968
    v_mul_f32 v44, v44, v156
    v_mul_f32 v45, v45, v157
    v_mfma_f32_16x16x32_bf16 v[164:167], a[76:79], a[196:199], v[164:167]
    ds_read_b64_tr_b16 a[26:27], v231 offset:39552
    v_mul_f32 v46, v46, v158
    v_mfma_f32_16x16x32_bf16 v[160:163], a[76:79], a[192:195], v[160:163]
    v_mul_f32 v47, v47, v159
    v_mfma_f32_16x16x32_bf16 v[48:51], a[80:83], a[208:211], v[48:51]
    ds_read_b64_tr_b16 a[28:29], v231 offset:50304
    v_cvt_pk_bf16_f32 v42, v44, v45
    v_mfma_f32_16x16x32_bf16 v[52:55], a[80:83], a[212:215], v[52:55]
    ds_read_b64_tr_b16 a[30:31], v231 offset:53888
    v_cvt_pk_bf16_f32 v43, v46, v47
    v_mfma_f32_16x16x32_bf16 v[56:59], a[80:83], a[216:219], v[56:59]
    s_nop 0
    v_permlane32_swap_b32 v32, v34
    v_mfma_f32_16x16x32_bf16 v[60:63], a[80:83], a[220:223], v[60:63]
    v_permlane32_swap_b32 v33, v35
    v_mfma_f32_16x16x32_bf16 v[172:175], a[84:87], a[220:223], v[172:175]
    buffer_store_dwordx4 v[32:35], v237, s[8:11], s27 offen sc1
    v_mfma_f32_16x16x32_bf16 v[168:171], a[84:87], a[216:219], v[168:171]
    v_permlane32_swap_b32 v40, v42
    v_mfma_f32_16x16x32_bf16 v[164:167], a[84:87], a[212:215], v[164:167]
    v_permlane32_swap_b32 v41, v43
    v_mfma_f32_16x16x32_bf16 v[160:163], a[84:87], a[208:211], v[160:163]
    buffer_store_dwordx4 v[40:43], v238, s[8:11], s27 offen sc1
    s_add_u32 s27, s27, 32768
    s_waitcnt lgkmcnt(0)
    v_mfma_f32_16x16x32_bf16 v[64:67], a[0:3], a[160:163], v[64:67]
    v_mfma_f32_16x16x32_bf16 v[68:71], a[0:3], a[164:167], v[68:71]
    ds_read_b64_tr_b16 a[56:57], v231 offset:160
    v_mfma_f32_16x16x32_bf16 v[72:75], a[0:3], a[168:171], v[72:75]
    v_mfma_f32_16x16x32_bf16 v[76:79], a[0:3], a[172:175], v[76:79]
    ds_read_b64_tr_b16 a[58:59], v231 offset:3744
    v_mfma_f32_16x16x32_bf16 v[188:191], a[4:7], a[172:175], v[188:191]
    ds_read_b64_tr_b16 a[60:61], v231 offset:14496
    v_mfma_f32_16x16x32_bf16 v[184:187], a[4:7], a[168:171], v[184:187]
    v_mul_f32 v48, v48, v160
    v_mfma_f32_16x16x32_bf16 v[180:183], a[4:7], a[164:167], v[180:183]
    ds_read_b64_tr_b16 a[62:63], v231 offset:18080
    v_mul_f32 v49, v49, v161
    v_mfma_f32_16x16x32_bf16 v[176:179], a[4:7], a[160:163], v[176:179]
    v_mul_f32 v50, v50, v162
    v_mfma_f32_16x16x32_bf16 v[64:67], a[8:11], a[176:179], v[64:67]
    ds_read_b64_tr_b16 a[64:65], v231 offset:7328
    v_mul_f32 v51, v51, v163
    v_mfma_f32_16x16x32_bf16 v[68:71], a[8:11], a[180:183], v[68:71]
    ds_read_b64_tr_b16 a[66:67], v231 offset:10912
    v_cvt_pk_bf16_f32 v48, v48, v49
    v_mfma_f32_16x16x32_bf16 v[72:75], a[8:11], a[184:187], v[72:75]
    v_cvt_pk_bf16_f32 v49, v50, v51
    v_mul_f32 v52, v52, v164
    v_mfma_f32_16x16x32_bf16 v[76:79], a[8:11], a[188:191], v[76:79]
    ds_read_b64_tr_b16 a[68:69], v231 offset:21664
    v_mul_f32 v53, v53, v165
    v_mfma_f32_16x16x32_bf16 v[188:191], a[12:15], a[188:191], v[188:191]
    ds_read_b64_tr_b16 a[70:71], v231 offset:25248
    v_mul_f32 v54, v54, v166
    v_mfma_f32_16x16x32_bf16 v[184:187], a[12:15], a[184:187], v[184:187]
    v_mul_f32 v55, v55, v167
    v_mfma_f32_16x16x32_bf16 v[180:183], a[12:15], a[180:183], v[180:183]
    ds_read_b64_tr_b16 a[72:73], v231 offset:28832
    v_cvt_pk_bf16_f32 v50, v52, v53
    v_mfma_f32_16x16x32_bf16 v[176:179], a[12:15], a[176:179], v[176:179]
    v_cvt_pk_bf16_f32 v51, v54, v55
    v_mul_f32 v56, v56, v168
    v_mfma_f32_16x16x32_bf16 v[64:67], a[16:19], a[192:195], v[64:67]
    ds_read_b64_tr_b16 a[74:75], v231 offset:32416
    v_mul_f32 v57, v57, v169
    v_mfma_f32_16x16x32_bf16 v[68:71], a[16:19], a[196:199], v[68:71]
    ds_read_b64_tr_b16 a[76:77], v231 offset:43168
    v_mul_f32 v58, v58, v170
    v_mfma_f32_16x16x32_bf16 v[72:75], a[16:19], a[200:203], v[72:75]
    v_mul_f32 v59, v59, v171
    v_mfma_f32_16x16x32_bf16 v[76:79], a[16:19], a[204:207], v[76:79]
    ds_read_b64_tr_b16 a[78:79], v231 offset:46752
    v_cvt_pk_bf16_f32 v56, v56, v57
    v_mfma_f32_16x16x32_bf16 v[188:191], a[20:23], a[204:207], v[188:191]
    v_cvt_pk_bf16_f32 v57, v58, v59
    v_mfma_f32_16x16x32_bf16 v[184:187], a[20:23], a[200:203], v[184:187]
    ds_read_b64_tr_b16 a[80:81], v231 offset:36000
    v_mul_f32 v60, v60, v172
    v_mul_f32 v61, v61, v173
    v_mfma_f32_16x16x32_bf16 v[180:183], a[20:23], a[196:199], v[180:183]
    ds_read_b64_tr_b16 a[82:83], v231 offset:39584
    v_mul_f32 v62, v62, v174
    v_mfma_f32_16x16x32_bf16 v[176:179], a[20:23], a[192:195], v[176:179]
    v_mul_f32 v63, v63, v175
    v_mfma_f32_16x16x32_bf16 v[64:67], a[24:27], a[208:211], v[64:67]
    ds_read_b64_tr_b16 a[84:85], v231 offset:50336
    v_cvt_pk_bf16_f32 v58, v60, v61
    v_mfma_f32_16x16x32_bf16 v[68:71], a[24:27], a[212:215], v[68:71]
    ds_read_b64_tr_b16 a[86:87], v231 offset:53920
    v_cvt_pk_bf16_f32 v59, v62, v63
    v_mfma_f32_16x16x32_bf16 v[72:75], a[24:27], a[216:219], v[72:75]
    s_nop 0
    v_permlane32_swap_b32 v48, v50
    v_mfma_f32_16x16x32_bf16 v[76:79], a[24:27], a[220:223], v[76:79]
    v_permlane32_swap_b32 v49, v51
    v_mfma_f32_16x16x32_bf16 v[188:191], a[28:31], a[220:223], v[188:191]
    buffer_store_dwordx4 v[48:51], v237, s[8:11], s27 offen sc1
    v_mfma_f32_16x16x32_bf16 v[184:187], a[28:31], a[216:219], v[184:187]
    v_permlane32_swap_b32 v56, v58
    v_mfma_f32_16x16x32_bf16 v[180:183], a[28:31], a[212:215], v[180:183]
    v_permlane32_swap_b32 v57, v59
    v_mfma_f32_16x16x32_bf16 v[176:179], a[28:31], a[208:211], v[176:179]
    buffer_store_dwordx4 v[56:59], v238, s[8:11], s27 offen sc1
    s_add_u32 s27, s27, 32768
    s_waitcnt vmcnt(4) lgkmcnt(0)
    s_barrier
    buffer_store_dword v247, v246, s[8:11], s28 offen sc1
    v_mfma_f32_16x16x32_bf16 v[80:83], a[56:59], a[160:163], v[80:83]
    v_mfma_f32_16x16x32_bf16 v[84:87], a[56:59], a[164:167], v[84:87]
    ds_read_b64_tr_b16 a[0:1], v231 offset:192
    v_mfma_f32_16x16x32_bf16 v[88:91], a[56:59], a[168:171], v[88:91]
    v_mfma_f32_16x16x32_bf16 v[92:95], a[56:59], a[172:175], v[92:95]
    ds_read_b64_tr_b16 a[2:3], v231 offset:3776
    v_mfma_f32_16x16x32_bf16 v[204:207], a[60:63], a[172:175], v[204:207]
    ds_read_b64_tr_b16 a[4:5], v231 offset:14528
    v_mfma_f32_16x16x32_bf16 v[200:203], a[60:63], a[168:171], v[200:203]
    v_mul_f32 v64, v64, v176
    v_mfma_f32_16x16x32_bf16 v[196:199], a[60:63], a[164:167], v[196:199]
    ds_read_b64_tr_b16 a[6:7], v231 offset:18112
    v_mul_f32 v65, v65, v177
    v_mfma_f32_16x16x32_bf16 v[192:195], a[60:63], a[160:163], v[192:195]
    v_mul_f32 v66, v66, v178
    v_mfma_f32_16x16x32_bf16 v[80:83], a[64:67], a[176:179], v[80:83]
    ds_read_b64_tr_b16 a[8:9], v231 offset:7360
    v_mul_f32 v67, v67, v179
    v_mfma_f32_16x16x32_bf16 v[84:87], a[64:67], a[180:183], v[84:87]
    ds_read_b64_tr_b16 a[10:11], v231 offset:10944
    v_cvt_pk_bf16_f32 v64, v64, v65
    v_mfma_f32_16x16x32_bf16 v[88:91], a[64:67], a[184:187], v[88:91]
    v_cvt_pk_bf16_f32 v65, v66, v67
    v_mul_f32 v68, v68, v180
    v_mfma_f32_16x16x32_bf16 v[92:95], a[64:67], a[188:191], v[92:95]
    ds_read_b64_tr_b16 a[12:13], v231 offset:21696
    v_mul_f32 v69, v69, v181
    v_mfma_f32_16x16x32_bf16 v[204:207], a[68:71], a[188:191], v[204:207]
    ds_read_b64_tr_b16 a[14:15], v231 offset:25280
    v_mul_f32 v70, v70, v182
    v_mfma_f32_16x16x32_bf16 v[200:203], a[68:71], a[184:187], v[200:203]
    v_mul_f32 v71, v71, v183
    v_mfma_f32_16x16x32_bf16 v[196:199], a[68:71], a[180:183], v[196:199]
    ds_read_b64_tr_b16 a[16:17], v231 offset:28864
    v_cvt_pk_bf16_f32 v66, v68, v69
    v_mfma_f32_16x16x32_bf16 v[192:195], a[68:71], a[176:179], v[192:195]
    v_cvt_pk_bf16_f32 v67, v70, v71
    v_mul_f32 v72, v72, v184
    v_mfma_f32_16x16x32_bf16 v[80:83], a[72:75], a[192:195], v[80:83]
    ds_read_b64_tr_b16 a[18:19], v231 offset:32448
    v_mul_f32 v73, v73, v185
    v_mfma_f32_16x16x32_bf16 v[84:87], a[72:75], a[196:199], v[84:87]
    ds_read_b64_tr_b16 a[20:21], v231 offset:43200
    v_mul_f32 v74, v74, v186
    v_mfma_f32_16x16x32_bf16 v[88:91], a[72:75], a[200:203], v[88:91]
    v_mul_f32 v75, v75, v187
    v_mfma_f32_16x16x32_bf16 v[92:95], a[72:75], a[204:207], v[92:95]
    ds_read_b64_tr_b16 a[22:23], v231 offset:46784
    v_cvt_pk_bf16_f32 v72, v72, v73
    v_mfma_f32_16x16x32_bf16 v[204:207], a[76:79], a[204:207], v[204:207]
    v_cvt_pk_bf16_f32 v73, v74, v75
    v_mfma_f32_16x16x32_bf16 v[200:203], a[76:79], a[200:203], v[200:203]
    ds_read_b64_tr_b16 a[24:25], v231 offset:36032
    v_mul_f32 v76, v76, v188
    v_mul_f32 v77, v77, v189
    v_mfma_f32_16x16x32_bf16 v[196:199], a[76:79], a[196:199], v[196:199]
    ds_read_b64_tr_b16 a[26:27], v231 offset:39616
    v_mul_f32 v78, v78, v190
    v_mfma_f32_16x16x32_bf16 v[192:195], a[76:79], a[192:195], v[192:195]
    v_mul_f32 v79, v79, v191
    v_mfma_f32_16x16x32_bf16 v[80:83], a[80:83], a[208:211], v[80:83]
    ds_read_b64_tr_b16 a[28:29], v231 offset:50368
    v_cvt_pk_bf16_f32 v74, v76, v77
    v_mfma_f32_16x16x32_bf16 v[84:87], a[80:83], a[212:215], v[84:87]
    ds_read_b64_tr_b16 a[30:31], v231 offset:53952
    v_cvt_pk_bf16_f32 v75, v78, v79
    v_mfma_f32_16x16x32_bf16 v[88:91], a[80:83], a[216:219], v[88:91]
    s_nop 0
    v_permlane32_swap_b32 v64, v66
    v_mfma_f32_16x16x32_bf16 v[92:95], a[80:83], a[220:223], v[92:95]
    v_permlane32_swap_b32 v65, v67
    v_mfma_f32_16x16x32_bf16 v[204:207], a[84:87], a[220:223], v[204:207]
    buffer_store_dwordx4 v[64:67], v237, s[8:11], s27 offen sc1
    v_mfma_f32_16x16x32_bf16 v[200:203], a[84:87], a[216:219], v[200:203]
    v_permlane32_swap_b32 v72, v74
    v_mfma_f32_16x16x32_bf16 v[196:199], a[84:87], a[212:215], v[196:199]
    v_permlane32_swap_b32 v73, v75
    v_mfma_f32_16x16x32_bf16 v[192:195], a[84:87], a[208:211], v[192:195]
    buffer_store_dwordx4 v[72:75], v238, s[8:11], s27 offen sc1
    s_add_u32 s27, s27, 32768
    s_waitcnt lgkmcnt(0)
    v_mfma_f32_16x16x32_bf16 v[96:99], a[0:3], a[160:163], v[96:99]
    s_lshr_b32 s58, s12, 1
    s_lshl_b32 s58, s58, 12
    v_mfma_f32_16x16x32_bf16 v[100:103], a[0:3], a[164:167], v[100:103]
    s_add_u32 s59, s58, 40501248
    s_lshl_b32 s4, s14, 11
    v_mfma_f32_16x16x32_bf16 v[104:107], a[0:3], a[168:171], v[104:107]
    s_add_u32 s58, s58, s4
    s_add_u32 s58, s58, 40468480
    v_mfma_f32_16x16x32_bf16 v[108:111], a[0:3], a[172:175], v[108:111]
    v_and_b32 v132, 15, v240
    v_lshlrev_b32 v132, 7, v132
    v_mfma_f32_16x16x32_bf16 v[220:223], a[4:7], a[172:175], v[220:223]
    v_bfe_u32 v128, v240, 2, 3
    v_lshrrev_b32 v129, 1, v128
    v_mfma_f32_16x16x32_bf16 v[216:219], a[4:7], a[168:171], v[216:219]
    v_lshrrev_b32 v130, 5, v240
    v_lshl_add_u32 v128, v130, 4, v128
    v_mul_f32 v80, v80, v192
    v_mfma_f32_16x16x32_bf16 v[212:215], a[4:7], a[164:167], v[212:215]
    v_lshlrev_b32 v128, 7, v128
    v_and_b32 v130, 3, v240
    v_mul_f32 v81, v81, v193
    v_mfma_f32_16x16x32_bf16 v[208:211], a[4:7], a[160:163], v[208:211]
    v_lshl_add_u32 v128, v130, 3, v128
    v_xor_b32 v130, 0, v129
    v_mul_f32 v82, v82, v194
    v_mfma_f32_16x16x32_bf16 v[96:99], a[8:11], a[176:179], v[96:99]
    v_lshl_add_u32 v224, v130, 5, v128
    v_xor_b32 v130, 1, v129
    v_lshl_add_u32 v225, v130, 5, v128
    v_mul_f32 v83, v83, v195
    v_mfma_f32_16x16x32_bf16 v[100:103], a[8:11], a[180:183], v[100:103]
    v_xor_b32 v130, 2, v129
    v_lshl_add_u32 v226, v130, 5, v128
    v_cvt_pk_bf16_f32 v80, v80, v81
    v_cvt_pk_bf16_f32 v81, v82, v83
    v_mfma_f32_16x16x32_bf16 v[104:107], a[8:11], a[184:187], v[104:107]
    v_xor_b32 v130, 3, v129
    v_lshl_add_u32 v227, v130, 5, v128
    v_mul_f32 v84, v84, v196
    v_mfma_f32_16x16x32_bf16 v[108:111], a[8:11], a[188:191], v[108:111]
    v_add_u32 v224, 0x18000, v224
    v_add_u32 v225, 0x18000, v225
    v_mul_f32 v85, v85, v197
    v_mfma_f32_16x16x32_bf16 v[220:223], a[12:15], a[188:191], v[220:223]
    v_add_u32 v226, 0x18000, v226
    v_add_u32 v227, 0x18000, v227
    v_mul_f32 v86, v86, v198
    v_mfma_f32_16x16x32_bf16 v[216:219], a[12:15], a[184:187], v[216:219]
    s_mov_b32 s16, s62
    s_mov_b32 s17, s63
    v_mul_f32 v87, v87, v199
    v_cvt_pk_bf16_f32 v82, v84, v85
    v_mfma_f32_16x16x32_bf16 v[212:215], a[12:15], a[180:183], v[212:215]
    s_lshr_b32 s4, s15, 1
    s_lshl_b32 s4, s4, 17
    v_cvt_pk_bf16_f32 v83, v86, v87
    v_mfma_f32_16x16x32_bf16 v[208:211], a[12:15], a[176:179], v[208:211]
    s_and_b32 s5, s15, 1
    s_lshl_b32 s5, s5, 11
    v_mul_f32 v88, v88, v200
    v_mfma_f32_16x16x32_bf16 v[96:99], a[16:19], a[192:195], v[96:99]
    s_add_u32 s4, s4, s5
    s_lshl_b32 s5, s13, 13
    v_mul_f32 v89, v89, v201
    v_mfma_f32_16x16x32_bf16 v[100:103], a[16:19], a[196:199], v[100:103]
    s_add_u32 s4, s4, s5
    s_add_u32 s44, s4, 20971520
    s_add_u32 s45, s44, 4096
    v_mul_f32 v90, v90, v202
    v_mfma_f32_16x16x32_bf16 v[104:107], a[16:19], a[200:203], v[104:107]
    s_lshl_b32 s46, s15, 7
    s_add_u32 s46, s46, 39854080
    v_mul_f32 v91, v91, v203
    v_cvt_pk_bf16_f32 v88, v88, v89
    v_mfma_f32_16x16x32_bf16 v[108:111], a[16:19], a[204:207], v[108:111]
    s_lshl_b32 s22, s15, 11
    s_add_u32 s22, s22, 39911424
    v_cvt_pk_bf16_f32 v89, v90, v91
    v_mfma_f32_16x16x32_bf16 v[220:223], a[20:23], a[204:207], v[220:223]
    s_lshl_b32 s4, s2, 2
    s_add_u32 s4, s4, s21
    v_mul_f32 v92, v92, v204
    v_mfma_f32_16x16x32_bf16 v[216:219], a[20:23], a[200:203], v[216:219]
    s_lshl_b32 s23, s4, 13
    s_add_u32 s23, s23, 0
    v_mul_f32 v93, v93, v205
    v_mfma_f32_16x16x32_bf16 v[212:215], a[20:23], a[196:199], v[212:215]
    s_xor_b32 s4, s4, 16
    s_lshl_b32 s35, s4, 13
    v_mul_f32 v94, v94, v206
    v_mul_f32 v95, v95, v207
    v_mfma_f32_16x16x32_bf16 v[208:211], a[20:23], a[192:195], v[208:211]
    s_add_u32 s35, s35, 0
    v_and_b32 v128, 15, v240
    v_cvt_pk_bf16_f32 v90, v92, v93
    v_mfma_f32_16x16x32_bf16 v[96:99], a[24:27], a[208:211], v[96:99]
    v_lshlrev_b32 v134, 2, v128
    v_lshrrev_b32 v129, 4, v240
    v_cvt_pk_bf16_f32 v91, v94, v95
    v_mfma_f32_16x16x32_bf16 v[100:103], a[24:27], a[212:215], v[100:103]
    v_lshl_add_u32 v135, v129, 9, v134
    v_and_b32 v245, 31, v240
    v_lshlrev_b32 v245, 7, v245
    s_nop 0
    v_mfma_f32_16x16x32_bf16 v[104:107], a[24:27], a[216:219], v[104:107]
    v_permlane32_swap_b32 v80, v82
    v_mfma_f32_16x16x32_bf16 v[108:111], a[24:27], a[220:223], v[108:111]
    v_permlane32_swap_b32 v81, v83
    buffer_store_dwordx4 v[80:83], v237, s[8:11], s27 offen sc1
    v_mfma_f32_16x16x32_bf16 v[220:223], a[28:31], a[220:223], v[220:223]
    v_permlane32_swap_b32 v88, v90
    v_mfma_f32_16x16x32_bf16 v[216:219], a[28:31], a[216:219], v[216:219]
    v_permlane32_swap_b32 v89, v91
    v_mfma_f32_16x16x32_bf16 v[212:215], a[28:31], a[212:215], v[212:215]
    buffer_store_dwordx4 v[88:91], v238, s[8:11], s27 offen sc1
    v_mfma_f32_16x16x32_bf16 v[208:211], a[28:31], a[208:211], v[208:211]
    s_add_u32 s27, s27, 32768
    buffer_load_dword v133, v132, s[8:11], s58 offen sc1
    s_waitcnt vmcnt(0)
    v_cmp_ne_u32 vcc, s29, v133
    s_cbranch_vccz await_ok
    s_mov_b32 s4, 0
await:
    buffer_load_dword v133, v132, s[8:11], s58 offen sc1
    s_add_u32 s4, s4, 1
    s_waitcnt vmcnt(0)
    v_cmp_ne_u32 vcc, s29, v133
    s_cbranch_vccz await_ok
    s_cmp_lt_u32 s4, 2097152
    s_cbranch_scc1 await
await_ok:
    s_add_u32 s33, s32, s52
    buffer_load_dwordx4 a[64:67], v241, s[8:11], s33 offen offset:0 sc1
    buffer_load_dwordx4 a[68:71], v241, s[8:11], s33 offen offset:1024 sc1
    buffer_load_dwordx4 a[72:75], v241, s[8:11], s33 offen offset:2048 sc1
    buffer_load_dwordx4 a[76:79], v241, s[8:11], s33 offen offset:3072 sc1
    s_add_u32 s33, s32, s53
    buffer_load_dwordx4 a[80:83], v241, s[8:11], s33 offen offset:0 sc1
    buffer_load_dwordx4 a[84:87], v241, s[8:11], s33 offen offset:1024 sc1
    buffer_load_dwordx4 a[88:91], v241, s[8:11], s33 offen offset:2048 sc1
    buffer_load_dwordx4 a[92:95], v241, s[8:11], s33 offen offset:3072 sc1
    s_add_u32 s33, s32, s54
    buffer_load_dwordx4 a[96:99], v241, s[8:11], s33 offen offset:0 sc1
    buffer_load_dwordx4 a[100:103], v241, s[8:11], s33 offen offset:1024 sc1
    ds_read_b64_tr_b16 a[0:1], v224 offset:32768
    ds_read_b64_tr_b16 a[2:3], v224 offset:33792
    ds_read_b64_tr_b16 a[4:5], v225 offset:32768
    ds_read_b64_tr_b16 a[6:7], v225 offset:33792
    ds_read_b64_tr_b16 a[8:9], v226 offset:32768
    ds_read_b64_tr_b16 a[10:11], v226 offset:33792
    ds_read_b64_tr_b16 a[12:13], v227 offset:32768
    ds_read_b64_tr_b16 a[14:15], v227 offset:33792
    ds_read_b64_tr_b16 a[16:17], v224 offset:40960
    ds_read_b64_tr_b16 a[18:19], v224 offset:41984
    ds_read_b64_tr_b16 a[20:21], v225 offset:40960
    ds_read_b64_tr_b16 a[22:23], v225 offset:41984
    ds_read_b64_tr_b16 a[24:25], v226 offset:40960
    ds_read_b64_tr_b16 a[26:27], v226 offset:41984
    ds_read_b64_tr_b16 a[28:29], v227 offset:40960
    ds_read_b64_tr_b16 a[30:31], v227 offset:41984
    v_mul_f32 v96, v96, v208
    v_mul_f32 v97, v97, v209
    v_mul_f32 v98, v98, v210
    v_mul_f32 v99, v99, v211
    v_cvt_pk_bf16_f32 v96, v96, v97
    v_cvt_pk_bf16_f32 v97, v98, v99
    v_mul_f32 v100, v100, v212
    v_mul_f32 v101, v101, v213
    v_mul_f32 v102, v102, v214
    v_mul_f32 v103, v103, v215
    v_cvt_pk_bf16_f32 v98, v100, v101
    v_cvt_pk_bf16_f32 v99, v102, v103
    v_mul_f32 v104, v104, v216
    v_mul_f32 v105, v105, v217
    v_mul_f32 v106, v106, v218
    v_mul_f32 v107, v107, v219
    v_cvt_pk_bf16_f32 v104, v104, v105
    v_cvt_pk_bf16_f32 v105, v106, v107
    v_mul_f32 v108, v108, v220
    v_mul_f32 v109, v109, v221
    v_mul_f32 v110, v110, v222
    v_mul_f32 v111, v111, v223
    v_cvt_pk_bf16_f32 v106, v108, v109
    v_cvt_pk_bf16_f32 v107, v110, v111
    s_nop 0
    v_permlane32_swap_b32 v96, v98
    v_permlane32_swap_b32 v97, v99
    buffer_store_dwordx4 v[96:99], v237, s[8:11], s27 offen sc1
    v_permlane32_swap_b32 v104, v106
    v_permlane32_swap_b32 v105, v107
    buffer_store_dwordx4 v[104:107], v238, s[8:11], s27 offen sc1
    s_add_u32 s27, s27, 32768
    s_waitcnt vmcnt(10) lgkmcnt(8)
    v_mfma_f32_16x16x32_bf16 v[0:3], a[0:3], a[64:67], 0
    ds_read_b64_tr_b16 a[32:33], v224 offset:36864
    v_mfma_f32_16x16x32_bf16 v[4:7], a[0:3], a[68:71], 0
    ds_read_b64_tr_b16 a[34:35], v224 offset:37888
    v_mfma_f32_16x16x32_bf16 v[12:15], a[4:7], a[68:71], 0
    ds_read_b64_tr_b16 a[36:37], v225 offset:36864
    buffer_load_dwordx4 a[104:107], v241, s[8:11], s33 offen offset:2048 sc1
    v_mfma_f32_16x16x32_bf16 v[8:11], a[4:7], a[64:67], 0
    ds_read_b64_tr_b16 a[38:39], v225 offset:37888
    v_mfma_f32_16x16x32_bf16 v[16:19], a[8:11], a[64:67], 0
    ds_read_b64_tr_b16 a[40:41], v226 offset:36864
    v_mfma_f32_16x16x32_bf16 v[20:23], a[8:11], a[68:71], 0
    ds_read_b64_tr_b16 a[42:43], v226 offset:37888
    buffer_load_dwordx4 a[108:111], v241, s[8:11], s33 offen offset:3072 sc1
    v_mfma_f32_16x16x32_bf16 v[28:31], a[12:15], a[68:71], 0
    ds_read_b64_tr_b16 a[44:45], v227 offset:36864
    v_mfma_f32_16x16x32_bf16 v[24:27], a[12:15], a[64:67], 0
    ds_read_b64_tr_b16 a[46:47], v227 offset:37888
    s_waitcnt lgkmcnt(8)
    v_mfma_f32_16x16x32_bf16 v[32:35], a[16:19], a[64:67], 0
    ds_read_b64_tr_b16 a[48:49], v224 offset:45056
    s_add_u32 s33, s32, s55
    v_mfma_f32_16x16x32_bf16 v[36:39], a[16:19], a[68:71], 0
    ds_read_b64_tr_b16 a[50:51], v224 offset:46080
    v_mfma_f32_16x16x32_bf16 v[44:47], a[20:23], a[68:71], 0
    ds_read_b64_tr_b16 a[52:53], v225 offset:45056
    v_mfma_f32_16x16x32_bf16 v[40:43], a[20:23], a[64:67], 0
    ds_read_b64_tr_b16 a[54:55], v225 offset:46080
    buffer_load_dwordx4 a[112:115], v241, s[8:11], s33 offen offset:0 sc1
    v_mfma_f32_16x16x32_bf16 v[48:51], a[24:27], a[64:67], 0
    ds_read_b64_tr_b16 a[56:57], v226 offset:45056
    v_mfma_f32_16x16x32_bf16 v[52:55], a[24:27], a[68:71], 0
    ds_read_b64_tr_b16 a[58:59], v226 offset:46080
    v_mfma_f32_16x16x32_bf16 v[60:63], a[28:31], a[68:71], 0
    ds_read_b64_tr_b16 a[60:61], v227 offset:45056
    buffer_load_dwordx4 a[116:119], v241, s[8:11], s33 offen offset:1024 sc1
    v_mfma_f32_16x16x32_bf16 v[56:59], a[28:31], a[64:67], 0
    ds_read_b64_tr_b16 a[62:63], v227 offset:46080
    s_waitcnt vmcnt(12) lgkmcnt(8)
    s_barrier
    v_mfma_f32_16x16x32_bf16 v[0:3], a[32:35], a[72:75], v[0:3]
    ds_read_b64_tr_b16 a[0:1], v224 offset:49152
    v_mfma_f32_16x16x32_bf16 v[4:7], a[32:35], a[76:79], v[4:7]
    ds_read_b64_tr_b16 a[2:3], v224 offset:50176
    buffer_load_dwordx4 a[120:123], v241, s[8:11], s33 offen offset:2048 sc1
    v_mfma_f32_16x16x32_bf16 v[12:15], a[36:39], a[76:79], v[12:15]
    ds_read_b64_tr_b16 a[4:5], v225 offset:49152
    buffer_load_dwordx4 a[124:127], v241, s[8:11], s33 offen offset:3072 sc1
    v_mfma_f32_16x16x32_bf16 v[8:11], a[36:39], a[72:75], v[8:11]
    ds_read_b64_tr_b16 a[6:7], v225 offset:50176
    s_add_u32 s32, s32, 32768
    v_mfma_f32_16x16x32_bf16 v[16:19], a[40:43], a[72:75], v[16:19]
    ds_read_b64_tr_b16 a[8:9], v226 offset:49152
    s_add_u32 s33, s32, s52
    v_mfma_f32_16x16x32_bf16 v[20:23], a[40:43], a[76:79], v[20:23]
    ds_read_b64_tr_b16 a[10:11], v226 offset:50176
    buffer_load_dwordx4 a[64:67], v241, s[8:11], s33 offen offset:0 sc1
    v_mfma_f32_16x16x32_bf16 v[28:31], a[44:47], a[76:79], v[28:31]
    ds_read_b64_tr_b16 a[12:13], v227 offset:49152
    buffer_load_dwordx4 a[68:71], v241, s[8:11], s33 offen offset:1024 sc1
    v_mfma_f32_16x16x32_bf16 v[24:27], a[44:47], a[72:75], v[24:27]
    ds_read_b64_tr_b16 a[14:15], v227 offset:50176
    s_add_u32 s7, s6, s50
    s_waitcnt lgkmcnt(8)
    v_mfma_f32_16x16x32_bf16 v[32:35], a[48:51], a[72:75], v[32:35]
    ds_read_b64_tr_b16 a[16:17], v224 offset:57344
    s_add_u32 m0, s30, 0
    v_mfma_f32_16x16x32_bf16 v[36:39], a[48:51], a[76:79], v[36:39]
    ds_read_b64_tr_b16 a[18:19], v224 offset:58368
    buffer_load_dwordx4 v249, s[40:43], s7 offen offset:0 lds
    v_mfma_f32_16x16x32_bf16 v[44:47], a[52:55], a[76:79], v[44:47]
    ds_read_b64_tr_b16 a[20:21], v225 offset:57344
    buffer_load_dwordx4 v250, s[40:43], s7 offen offset:1024 lds
    v_mfma_f32_16x16x32_bf16 v[40:43], a[52:55], a[72:75], v[40:43]
    ds_read_b64_tr_b16 a[22:23], v225 offset:58368
    s_xor_b32 s31, s7, 128
    v_mfma_f32_16x16x32_bf16 v[48:51], a[56:59], a[72:75], v[48:51]
    ds_read_b64_tr_b16 a[24:25], v226 offset:57344
    s_add_u32 m0, s30, 8192
    v_mfma_f32_16x16x32_bf16 v[52:55], a[56:59], a[76:79], v[52:55]
    ds_read_b64_tr_b16 a[26:27], v226 offset:58368
    buffer_load_dwordx4 v249, s[40:43], s31 offen offset:0 lds
    v_mfma_f32_16x16x32_bf16 v[60:63], a[60:63], a[76:79], v[60:63]
    ds_read_b64_tr_b16 a[28:29], v227 offset:57344
    buffer_load_dwordx4 v250, s[40:43], s31 offen offset:1024 lds
    v_mfma_f32_16x16x32_bf16 v[56:59], a[60:63], a[72:75], v[56:59]
    ds_read_b64_tr_b16 a[30:31], v227 offset:58368
    s_waitcnt vmcnt(18) lgkmcnt(8)
    v_mfma_f32_16x16x32_bf16 v[0:3], a[0:3], a[80:83], v[0:3]
    ds_read_b64_tr_b16 a[32:33], v224 offset:53248
    v_mfma_f32_16x16x32_bf16 v[4:7], a[0:3], a[84:87], v[4:7]
    ds_read_b64_tr_b16 a[34:35], v224 offset:54272
    buffer_load_dwordx4 a[72:75], v241, s[8:11], s33 offen offset:2048 sc1
    v_mfma_f32_16x16x32_bf16 v[12:15], a[4:7], a[84:87], v[12:15]
    ds_read_b64_tr_b16 a[36:37], v225 offset:53248
    buffer_load_dwordx4 a[76:79], v241, s[8:11], s33 offen offset:3072 sc1
    v_mfma_f32_16x16x32_bf16 v[8:11], a[4:7], a[80:83], v[8:11]
    ds_read_b64_tr_b16 a[38:39], v225 offset:54272
    s_add_u32 s7, s6, s51
    v_mfma_f32_16x16x32_bf16 v[16:19], a[8:11], a[80:83], v[16:19]
    ds_read_b64_tr_b16 a[40:41], v226 offset:53248
    s_add_u32 m0, s30, 16384
    v_mfma_f32_16x16x32_bf16 v[20:23], a[8:11], a[84:87], v[20:23]
    ds_read_b64_tr_b16 a[42:43], v226 offset:54272
    v_mfma_f32_16x16x32_bf16 v[28:31], a[12:15], a[84:87], v[28:31]
    ds_read_b64_tr_b16 a[44:45], v227 offset:53248
    buffer_load_dwordx4 v249, s[40:43], s7 offen offset:0 lds
    v_mfma_f32_16x16x32_bf16 v[24:27], a[12:15], a[80:83], v[24:27]
    ds_read_b64_tr_b16 a[46:47], v227 offset:54272
    buffer_load_dwordx4 v250, s[40:43], s7 offen offset:1024 lds
    s_waitcnt lgkmcnt(8)
    v_mfma_f32_16x16x32_bf16 v[32:35], a[16:19], a[80:83], v[32:35]
    ds_read_b64_tr_b16 a[48:49], v224 offset:61440
    s_xor_b32 s31, s7, 128
    v_mfma_f32_16x16x32_bf16 v[36:39], a[16:19], a[84:87], v[36:39]
    ds_read_b64_tr_b16 a[50:51], v224 offset:62464
    s_add_u32 m0, s30, 24576
    v_mfma_f32_16x16x32_bf16 v[44:47], a[20:23], a[84:87], v[44:47]
    ds_read_b64_tr_b16 a[52:53], v225 offset:61440
    v_mfma_f32_16x16x32_bf16 v[40:43], a[20:23], a[80:83], v[40:43]
    ds_read_b64_tr_b16 a[54:55], v225 offset:62464
    buffer_load_dwordx4 v249, s[40:43], s31 offen offset:0 lds
    v_mfma_f32_16x16x32_bf16 v[48:51], a[24:27], a[80:83], v[48:51]
    ds_read_b64_tr_b16 a[56:57], v226 offset:61440
    buffer_load_dwordx4 v250, s[40:43], s31 offen offset:1024 lds
    v_mfma_f32_16x16x32_bf16 v[52:55], a[24:27], a[84:87], v[52:55]
    ds_read_b64_tr_b16 a[58:59], v226 offset:62464
    s_xor_b32 s30, s30, 0x10000
    v_mfma_f32_16x16x32_bf16 v[60:63], a[28:31], a[84:87], v[60:63]
    ds_read_b64_tr_b16 a[60:61], v227 offset:61440
    s_add_u32 s6, s6, 32768
    v_mfma_f32_16x16x32_bf16 v[56:59], a[28:31], a[80:83], v[56:59]
    ds_read_b64_tr_b16 a[62:63], v227 offset:62464
    s_waitcnt vmcnt(22) lgkmcnt(8)
    s_barrier
    v_mfma_f32_16x16x32_bf16 v[0:3], a[32:35], a[88:91], v[0:3]
    ds_read_b64_tr_b16 a[0:1], v224 offset:0
    v_mfma_f32_16x16x32_bf16 v[4:7], a[32:35], a[92:95], v[4:7]
    ds_read_b64_tr_b16 a[2:3], v224 offset:1024
    v_mfma_f32_16x16x32_bf16 v[12:15], a[36:39], a[92:95], v[12:15]
    ds_read_b64_tr_b16 a[4:5], v225 offset:0
    s_add_u32 s7, s6, s48
    v_mfma_f32_16x16x32_bf16 v[8:11], a[36:39], a[88:91], v[8:11]
    ds_read_b64_tr_b16 a[6:7], v225 offset:1024
    v_mfma_f32_16x16x32_bf16 v[16:19], a[40:43], a[88:91], v[16:19]
    ds_read_b64_tr_b16 a[8:9], v226 offset:0
    s_add_u32 m0, s30, 32768
    v_mfma_f32_16x16x32_bf16 v[20:23], a[40:43], a[92:95], v[20:23]
    ds_read_b64_tr_b16 a[10:11], v226 offset:1024
    v_mfma_f32_16x16x32_bf16 v[28:31], a[44:47], a[92:95], v[28:31]
    ds_read_b64_tr_b16 a[12:13], v227 offset:0
    buffer_load_dwordx4 v249, s[40:43], s7 offen offset:0 lds
    v_mfma_f32_16x16x32_bf16 v[24:27], a[44:47], a[88:91], v[24:27]
    ds_read_b64_tr_b16 a[14:15], v227 offset:1024
    s_waitcnt lgkmcnt(8)
    v_mfma_f32_16x16x32_bf16 v[32:35], a[48:51], a[88:91], v[32:35]
    ds_read_b64_tr_b16 a[16:17], v224 offset:8192
    buffer_load_dwordx4 v250, s[40:43], s7 offen offset:1024 lds
    v_mfma_f32_16x16x32_bf16 v[36:39], a[48:51], a[92:95], v[36:39]
    ds_read_b64_tr_b16 a[18:19], v224 offset:9216
    v_mfma_f32_16x16x32_bf16 v[44:47], a[52:55], a[92:95], v[44:47]
    ds_read_b64_tr_b16 a[20:21], v225 offset:8192
    s_add_u32 s33, s32, s53
    v_mfma_f32_16x16x32_bf16 v[40:43], a[52:55], a[88:91], v[40:43]
    ds_read_b64_tr_b16 a[22:23], v225 offset:9216
    v_mfma_f32_16x16x32_bf16 v[48:51], a[56:59], a[88:91], v[48:51]
    ds_read_b64_tr_b16 a[24:25], v226 offset:8192
    buffer_load_dwordx4 a[80:83], v241, s[8:11], s33 offen offset:0 sc1
    v_mfma_f32_16x16x32_bf16 v[52:55], a[56:59], a[92:95], v[52:55]
    ds_read_b64_tr_b16 a[26:27], v226 offset:9216
    v_mfma_f32_16x16x32_bf16 v[60:63], a[60:63], a[92:95], v[60:63]
    ds_read_b64_tr_b16 a[28:29], v227 offset:8192
    buffer_load_dwordx4 a[84:87], v241, s[8:11], s33 offen offset:1024 sc1
    v_mfma_f32_16x16x32_bf16 v[56:59], a[60:63], a[88:91], v[56:59]
    ds_read_b64_tr_b16 a[30:31], v227 offset:9216
    s_waitcnt vmcnt(24) lgkmcnt(8)
    v_mfma_f32_16x16x32_bf16 v[0:3], a[0:3], a[96:99], v[0:3]
    ds_read_b64_tr_b16 a[32:33], v224 offset:4096
    v_mfma_f32_16x16x32_bf16 v[4:7], a[0:3], a[100:103], v[4:7]
    ds_read_b64_tr_b16 a[34:35], v224 offset:5120
    v_mfma_f32_16x16x32_bf16 v[12:15], a[4:7], a[100:103], v[12:15]
    ds_read_b64_tr_b16 a[36:37], v225 offset:4096
    s_xor_b32 s31, s7, 128
    v_mfma_f32_16x16x32_bf16 v[8:11], a[4:7], a[96:99], v[8:11]
    ds_read_b64_tr_b16 a[38:39], v225 offset:5120
    v_mfma_f32_16x16x32_bf16 v[16:19], a[8:11], a[96:99], v[16:19]
    ds_read_b64_tr_b16 a[40:41], v226 offset:4096
    s_add_u32 m0, s30, 40960
    v_mfma_f32_16x16x32_bf16 v[20:23], a[8:11], a[100:103], v[20:23]
    ds_read_b64_tr_b16 a[42:43], v226 offset:5120
    v_mfma_f32_16x16x32_bf16 v[28:31], a[12:15], a[100:103], v[28:31]
    ds_read_b64_tr_b16 a[44:45], v227 offset:4096
    v_mfma_f32_16x16x32_bf16 v[24:27], a[12:15], a[96:99], v[24:27]
    ds_read_b64_tr_b16 a[46:47], v227 offset:5120
    buffer_load_dwordx4 v249, s[40:43], s31 offen offset:0 lds
    s_waitcnt lgkmcnt(8)
    v_mfma_f32_16x16x32_bf16 v[32:35], a[16:19], a[96:99], v[32:35]
    ds_read_b64_tr_b16 a[48:49], v224 offset:12288
    v_mfma_f32_16x16x32_bf16 v[36:39], a[16:19], a[100:103], v[36:39]
    ds_read_b64_tr_b16 a[50:51], v224 offset:13312
    buffer_load_dwordx4 v250, s[40:43], s31 offen offset:1024 lds
    v_mfma_f32_16x16x32_bf16 v[44:47], a[20:23], a[100:103], v[44:47]
    ds_read_b64_tr_b16 a[52:53], v225 offset:12288
    v_mfma_f32_16x16x32_bf16 v[40:43], a[20:23], a[96:99], v[40:43]
    ds_read_b64_tr_b16 a[54:55], v225 offset:13312
    v_mfma_f32_16x16x32_bf16 v[48:51], a[24:27], a[96:99], v[48:51]
    ds_read_b64_tr_b16 a[56:57], v226 offset:12288
    buffer_load_dwordx4 a[88:91], v241, s[8:11], s33 offen offset:2048 sc1
    v_mfma_f32_16x16x32_bf16 v[52:55], a[24:27], a[100:103], v[52:55]
    ds_read_b64_tr_b16 a[58:59], v226 offset:13312
    v_mfma_f32_16x16x32_bf16 v[60:63], a[28:31], a[100:103], v[60:63]
    ds_read_b64_tr_b16 a[60:61], v227 offset:12288
    buffer_load_dwordx4 a[92:95], v241, s[8:11], s33 offen offset:3072 sc1
    v_mfma_f32_16x16x32_bf16 v[56:59], a[28:31], a[96:99], v[56:59]
    ds_read_b64_tr_b16 a[62:63], v227 offset:13312
    s_waitcnt vmcnt(24) lgkmcnt(8)
    s_barrier
    v_mfma_f32_16x16x32_bf16 v[0:3], a[32:35], a[104:107], v[0:3]
    ds_read_b64_tr_b16 a[0:1], v224 offset:16384
    v_mfma_f32_16x16x32_bf16 v[4:7], a[32:35], a[108:111], v[4:7]
    ds_read_b64_tr_b16 a[2:3], v224 offset:17408
    s_add_u32 s7, s6, s49
    v_mfma_f32_16x16x32_bf16 v[12:15], a[36:39], a[108:111], v[12:15]
    ds_read_b64_tr_b16 a[4:5], v225 offset:16384
    v_mfma_f32_16x16x32_bf16 v[8:11], a[36:39], a[104:107], v[8:11]
    ds_read_b64_tr_b16 a[6:7], v225 offset:17408
    s_add_u32 m0, s30, 49152
    v_mfma_f32_16x16x32_bf16 v[16:19], a[40:43], a[104:107], v[16:19]
    ds_read_b64_tr_b16 a[8:9], v226 offset:16384
    v_mfma_f32_16x16x32_bf16 v[20:23], a[40:43], a[108:111], v[20:23]
    ds_read_b64_tr_b16 a[10:11], v226 offset:17408
    buffer_load_dwordx4 v249, s[40:43], s7 offen offset:0 lds
    v_mfma_f32_16x16x32_bf16 v[28:31], a[44:47], a[108:111], v[28:31]
    ds_read_b64_tr_b16 a[12:13], v227 offset:16384
    v_mfma_f32_16x16x32_bf16 v[24:27], a[44:47], a[104:107], v[24:27]
    ds_read_b64_tr_b16 a[14:15], v227 offset:17408
    buffer_load_dwordx4 v250, s[40:43], s7 offen offset:1024 lds
    s_waitcnt lgkmcnt(8)
    v_mfma_f32_16x16x32_bf16 v[32:35], a[48:51], a[104:107], v[32:35]
    ds_read_b64_tr_b16 a[16:17], v224 offset:24576
    v_mfma_f32_16x16x32_bf16 v[36:39], a[48:51], a[108:111], v[36:39]
    ds_read_b64_tr_b16 a[18:19], v224 offset:25600
    s_add_u32 s33, s32, s54
    v_mfma_f32_16x16x32_bf16 v[44:47], a[52:55], a[108:111], v[44:47]
    ds_read_b64_tr_b16 a[20:21], v225 offset:24576
    v_mfma_f32_16x16x32_bf16 v[40:43], a[52:55], a[104:107], v[40:43]
    ds_read_b64_tr_b16 a[22:23], v225 offset:25600
    buffer_load_dwordx4 a[96:99], v241, s[8:11], s33 offen offset:0 sc1
    v_mfma_f32_16x16x32_bf16 v[48:51], a[56:59], a[104:107], v[48:51]
    ds_read_b64_tr_b16 a[24:25], v226 offset:24576
    v_mfma_f32_16x16x32_bf16 v[52:55], a[56:59], a[108:111], v[52:55]
    ds_read_b64_tr_b16 a[26:27], v226 offset:25600
    buffer_load_dwordx4 a[100:103], v241, s[8:11], s33 offen offset:1024 sc1
    v_mfma_f32_16x16x32_bf16 v[60:63], a[60:63], a[108:111], v[60:63]
    ds_read_b64_tr_b16 a[28:29], v227 offset:24576
    buffer_store_dword v247, v246, s[8:11], s57 offen sc1
    v_mfma_f32_16x16x32_bf16 v[56:59], a[60:63], a[104:107], v[56:59]
    ds_read_b64_tr_b16 a[30:31], v227 offset:25600
    s_waitcnt vmcnt(27) lgkmcnt(8)
    v_mfma_f32_16x16x32_bf16 v[0:3], a[0:3], a[112:115], v[0:3]
    ds_read_b64_tr_b16 a[32:33], v224 offset:20480
    v_mfma_f32_16x16x32_bf16 v[4:7], a[0:3], a[116:119], v[4:7]
    ds_read_b64_tr_b16 a[34:35], v224 offset:21504
    v_mfma_f32_16x16x32_bf16 v[12:15], a[4:7], a[116:119], v[12:15]
    ds_read_b64_tr_b16 a[36:37], v225 offset:20480
    s_xor_b32 s31, s7, 128
    v_mfma_f32_16x16x32_bf16 v[8:11], a[4:7], a[112:115], v[8:11]
    ds_read_b64_tr_b16 a[38:39], v225 offset:21504
    v_mfma_f32_16x16x32_bf16 v[16:19], a[8:11], a[112:115], v[16:19]
    ds_read_b64_tr_b16 a[40:41], v226 offset:20480
    s_add_u32 m0, s30, 57344
    v_mfma_f32_16x16x32_bf16 v[20:23], a[8:11], a[116:119], v[20:23]
    ds_read_b64_tr_b16 a[42:43], v226 offset:21504
    v_mfma_f32_16x16x32_bf16 v[28:31], a[12:15], a[116:119], v[28:31]
    ds_read_b64_tr_b16 a[44:45], v227 offset:20480
    v_mfma_f32_16x16x32_bf16 v[24:27], a[12:15], a[112:115], v[24:27]
    ds_read_b64_tr_b16 a[46:47], v227 offset:21504
    buffer_load_dwordx4 v249, s[40:43], s31 offen offset:0 lds
    s_waitcnt lgkmcnt(8)
    v_mfma_f32_16x16x32_bf16 v[32:35], a[16:19], a[112:115], v[32:35]
    ds_read_b64_tr_b16 a[48:49], v224 offset:28672
    v_mfma_f32_16x16x32_bf16 v[36:39], a[16:19], a[116:119], v[36:39]
    ds_read_b64_tr_b16 a[50:51], v224 offset:29696
    buffer_load_dwordx4 v250, s[40:43], s31 offen offset:1024 lds
    v_mfma_f32_16x16x32_bf16 v[44:47], a[20:23], a[116:119], v[44:47]
    ds_read_b64_tr_b16 a[52:53], v225 offset:28672
    v_mfma_f32_16x16x32_bf16 v[40:43], a[20:23], a[112:115], v[40:43]
    ds_read_b64_tr_b16 a[54:55], v225 offset:29696
    v_mfma_f32_16x16x32_bf16 v[48:51], a[24:27], a[112:115], v[48:51]
    ds_read_b64_tr_b16 a[56:57], v226 offset:28672
    buffer_load_dwordx4 a[104:107], v241, s[8:11], s33 offen offset:2048 sc1
    v_mfma_f32_16x16x32_bf16 v[52:55], a[24:27], a[116:119], v[52:55]
    ds_read_b64_tr_b16 a[58:59], v226 offset:29696
    v_mfma_f32_16x16x32_bf16 v[60:63], a[28:31], a[116:119], v[60:63]
    ds_read_b64_tr_b16 a[60:61], v227 offset:28672
    buffer_load_dwordx4 a[108:111], v241, s[8:11], s33 offen offset:3072 sc1
    v_mfma_f32_16x16x32_bf16 v[56:59], a[28:31], a[112:115], v[56:59]
    ds_read_b64_tr_b16 a[62:63], v227 offset:29696
    s_waitcnt vmcnt(29) lgkmcnt(8)
    s_barrier
    v_xor_b32 v224, 0x10000, v224
    v_xor_b32 v225, 0x10000, v225
    v_xor_b32 v226, 0x10000, v226
    v_xor_b32 v227, 0x10000, v227
    v_mfma_f32_16x16x32_bf16 v[0:3], a[32:35], a[120:123], v[0:3]
    ds_read_b64_tr_b16 a[0:1], v224 offset:32768
    v_mfma_f32_16x16x32_bf16 v[4:7], a[32:35], a[124:127], v[4:7]
    ds_read_b64_tr_b16 a[2:3], v224 offset:33792
    v_mfma_f32_16x16x32_bf16 v[12:15], a[36:39], a[124:127], v[12:15]
    ds_read_b64_tr_b16 a[4:5], v225 offset:32768
    s_add_u32 s7, s6, s50
    v_mfma_f32_16x16x32_bf16 v[8:11], a[36:39], a[120:123], v[8:11]
    ds_read_b64_tr_b16 a[6:7], v225 offset:33792
    v_mfma_f32_16x16x32_bf16 v[16:19], a[40:43], a[120:123], v[16:19]
    ds_read_b64_tr_b16 a[8:9], v226 offset:32768
    s_add_u32 m0, s30, 0
    v_mfma_f32_16x16x32_bf16 v[20:23], a[40:43], a[124:127], v[20:23]
    ds_read_b64_tr_b16 a[10:11], v226 offset:33792
    v_mfma_f32_16x16x32_bf16 v[28:31], a[44:47], a[124:127], v[28:31]
    ds_read_b64_tr_b16 a[12:13], v227 offset:32768
    buffer_load_dwordx4 v249, s[40:43], s7 offen offset:0 lds
    v_mfma_f32_16x16x32_bf16 v[24:27], a[44:47], a[120:123], v[24:27]
    ds_read_b64_tr_b16 a[14:15], v227 offset:33792
    s_waitcnt lgkmcnt(8)
    v_mfma_f32_16x16x32_bf16 v[32:35], a[48:51], a[120:123], v[32:35]
    ds_read_b64_tr_b16 a[16:17], v224 offset:40960
    buffer_load_dwordx4 v250, s[40:43], s7 offen offset:1024 lds
    v_mfma_f32_16x16x32_bf16 v[36:39], a[48:51], a[124:127], v[36:39]
    ds_read_b64_tr_b16 a[18:19], v224 offset:41984
    v_mfma_f32_16x16x32_bf16 v[44:47], a[52:55], a[124:127], v[44:47]
    ds_read_b64_tr_b16 a[20:21], v225 offset:40960
    s_add_u32 s33, s32, s55
    v_mfma_f32_16x16x32_bf16 v[40:43], a[52:55], a[120:123], v[40:43]
    ds_read_b64_tr_b16 a[22:23], v225 offset:41984
    v_mfma_f32_16x16x32_bf16 v[48:51], a[56:59], a[120:123], v[48:51]
    ds_read_b64_tr_b16 a[24:25], v226 offset:40960
    buffer_load_dwordx4 a[112:115], v241, s[8:11], s33 offen offset:0 sc1
    v_mfma_f32_16x16x32_bf16 v[52:55], a[56:59], a[124:127], v[52:55]
    ds_read_b64_tr_b16 a[26:27], v226 offset:41984
    v_mfma_f32_16x16x32_bf16 v[60:63], a[60:63], a[124:127], v[60:63]
    ds_read_b64_tr_b16 a[28:29], v227 offset:40960
    buffer_load_dwordx4 a[116:119], v241, s[8:11], s33 offen offset:1024 sc1
    v_mfma_f32_16x16x32_bf16 v[56:59], a[60:63], a[120:123], v[56:59]
    ds_read_b64_tr_b16 a[30:31], v227 offset:41984
    s_waitcnt vmcnt(31) lgkmcnt(8)
    v_mfma_f32_16x16x32_bf16 v[0:3], a[0:3], a[64:67], v[0:3]
    ds_read_b64_tr_b16 a[32:33], v224 offset:36864
    v_mfma_f32_16x16x32_bf16 v[4:7], a[0:3], a[68:71], v[4:7]
    ds_read_b64_tr_b16 a[34:35], v224 offset:37888
    v_mfma_f32_16x16x32_bf16 v[12:15], a[4:7], a[68:71], v[12:15]
    ds_read_b64_tr_b16 a[36:37], v225 offset:36864
    s_xor_b32 s31, s7, 128
    v_mfma_f32_16x16x32_bf16 v[8:11], a[4:7], a[64:67], v[8:11]
    ds_read_b64_tr_b16 a[38:39], v225 offset:37888
    v_mfma_f32_16x16x32_bf16 v[16:19], a[8:11], a[64:67], v[16:19]
    ds_read_b64_tr_b16 a[40:41], v226 offset:36864
    s_add_u32 m0, s30, 8192
    v_mfma_f32_16x16x32_bf16 v[20:23], a[8:11], a[68:71], v[20:23]
    ds_read_b64_tr_b16 a[42:43], v226 offset:37888
    v_mfma_f32_16x16x32_bf16 v[28:31], a[12:15], a[68:71], v[28:31]
    ds_read_b64_tr_b16 a[44:45], v227 offset:36864
    buffer_load_dwordx4 v249, s[40:43], s31 offen offset:0 lds
    v_mfma_f32_16x16x32_bf16 v[24:27], a[12:15], a[64:67], v[24:27]
    ds_read_b64_tr_b16 a[46:47], v227 offset:37888
    s_waitcnt lgkmcnt(8)
    v_mfma_f32_16x16x32_bf16 v[32:35], a[16:19], a[64:67], v[32:35]
    ds_read_b64_tr_b16 a[48:49], v224 offset:45056
    buffer_load_dwordx4 v250, s[40:43], s31 offen offset:1024 lds
    v_mfma_f32_16x16x32_bf16 v[36:39], a[16:19], a[68:71], v[36:39]
    ds_read_b64_tr_b16 a[50:51], v224 offset:46080
    v_mfma_f32_16x16x32_bf16 v[44:47], a[20:23], a[68:71], v[44:47]
    ds_read_b64_tr_b16 a[52:53], v225 offset:45056
    buffer_load_dwordx4 a[120:123], v241, s[8:11], s33 offen offset:2048 sc1
    v_mfma_f32_16x16x32_bf16 v[40:43], a[20:23], a[64:67], v[40:43]
    ds_read_b64_tr_b16 a[54:55], v225 offset:46080
    v_mfma_f32_16x16x32_bf16 v[48:51], a[24:27], a[64:67], v[48:51]
    ds_read_b64_tr_b16 a[56:57], v226 offset:45056
    buffer_load_dwordx4 a[124:127], v241, s[8:11], s33 offen offset:3072 sc1
    v_mfma_f32_16x16x32_bf16 v[52:55], a[24:27], a[68:71], v[52:55]
    ds_read_b64_tr_b16 a[58:59], v226 offset:46080
    v_mfma_f32_16x16x32_bf16 v[60:63], a[28:31], a[68:71], v[60:63]
    ds_read_b64_tr_b16 a[60:61], v227 offset:45056
    s_add_u32 s32, s32, 32768
    v_mfma_f32_16x16x32_bf16 v[56:59], a[28:31], a[64:67], v[56:59]
    ds_read_b64_tr_b16 a[62:63], v227 offset:46080
    s_waitcnt vmcnt(29) lgkmcnt(8)
    s_barrier
    v_mfma_f32_16x16x32_bf16 v[0:3], a[32:35], a[72:75], v[0:3]
    ds_read_b64_tr_b16 a[0:1], v224 offset:49152
    v_mfma_f32_16x16x32_bf16 v[4:7], a[32:35], a[76:79], v[4:7]
    ds_read_b64_tr_b16 a[2:3], v224 offset:50176
    v_mfma_f32_16x16x32_bf16 v[12:15], a[36:39], a[76:79], v[12:15]
    ds_read_b64_tr_b16 a[4:5], v225 offset:49152
    v_mfma_f32_16x16x32_bf16 v[8:11], a[36:39], a[72:75], v[8:11]
    ds_read_b64_tr_b16 a[6:7], v225 offset:50176
    s_add_u32 s7, s6, s51
    v_mfma_f32_16x16x32_bf16 v[16:19], a[40:43], a[72:75], v[16:19]
    ds_read_b64_tr_b16 a[8:9], v226 offset:49152
    v_mfma_f32_16x16x32_bf16 v[20:23], a[40:43], a[76:79], v[20:23]
    ds_read_b64_tr_b16 a[10:11], v226 offset:50176
    v_mfma_f32_16x16x32_bf16 v[28:31], a[44:47], a[76:79], v[28:31]
    ds_read_b64_tr_b16 a[12:13], v227 offset:49152
    v_mfma_f32_16x16x32_bf16 v[24:27], a[44:47], a[72:75], v[24:27]
    ds_read_b64_tr_b16 a[14:15], v227 offset:50176
    s_add_u32 m0, s30, 16384
    s_waitcnt lgkmcnt(8)
    v_mfma_f32_16x16x32_bf16 v[32:35], a[48:51], a[72:75], v[32:35]
    ds_read_b64_tr_b16 a[16:17], v224 offset:57344
    v_mfma_f32_16x16x32_bf16 v[36:39], a[48:51], a[76:79], v[36:39]
    ds_read_b64_tr_b16 a[18:19], v224 offset:58368
    v_mfma_f32_16x16x32_bf16 v[44:47], a[52:55], a[76:79], v[44:47]
    ds_read_b64_tr_b16 a[20:21], v225 offset:57344
    v_mfma_f32_16x16x32_bf16 v[40:43], a[52:55], a[72:75], v[40:43]
    ds_read_b64_tr_b16 a[22:23], v225 offset:58368
    buffer_load_dwordx4 v249, s[40:43], s7 offen offset:0 lds
    v_mfma_f32_16x16x32_bf16 v[48:51], a[56:59], a[72:75], v[48:51]
    ds_read_b64_tr_b16 a[24:25], v226 offset:57344
    v_mfma_f32_16x16x32_bf16 v[52:55], a[56:59], a[76:79], v[52:55]
    ds_read_b64_tr_b16 a[26:27], v226 offset:58368
    v_mfma_f32_16x16x32_bf16 v[60:63], a[60:63], a[76:79], v[60:63]
    ds_read_b64_tr_b16 a[28:29], v227 offset:57344
    buffer_load_dwordx4 v250, s[40:43], s7 offen offset:1024 lds
    v_mfma_f32_16x16x32_bf16 v[56:59], a[60:63], a[72:75], v[56:59]
    ds_read_b64_tr_b16 a[30:31], v227 offset:58368
    s_waitcnt vmcnt(23) lgkmcnt(8)
    v_mfma_f32_16x16x32_bf16 v[0:3], a[0:3], a[80:83], v[0:3]
    ds_read_b64_tr_b16 a[32:33], v224 offset:53248
    v_mfma_f32_16x16x32_bf16 v[4:7], a[0:3], a[84:87], v[4:7]
    ds_read_b64_tr_b16 a[34:35], v224 offset:54272
    v_mfma_f32_16x16x32_bf16 v[12:15], a[4:7], a[84:87], v[12:15]
    ds_read_b64_tr_b16 a[36:37], v225 offset:53248
    s_xor_b32 s31, s7, 128
    v_mfma_f32_16x16x32_bf16 v[8:11], a[4:7], a[80:83], v[8:11]
    ds_read_b64_tr_b16 a[38:39], v225 offset:54272
    v_mfma_f32_16x16x32_bf16 v[16:19], a[8:11], a[80:83], v[16:19]
    ds_read_b64_tr_b16 a[40:41], v226 offset:53248
    s_add_u32 m0, s30, 24576
    v_mfma_f32_16x16x32_bf16 v[20:23], a[8:11], a[84:87], v[20:23]
    ds_read_b64_tr_b16 a[42:43], v226 offset:54272
    v_mfma_f32_16x16x32_bf16 v[28:31], a[12:15], a[84:87], v[28:31]
    ds_read_b64_tr_b16 a[44:45], v227 offset:53248
    buffer_load_dwordx4 v249, s[40:43], s31 offen offset:0 lds
    v_mfma_f32_16x16x32_bf16 v[24:27], a[12:15], a[80:83], v[24:27]
    ds_read_b64_tr_b16 a[46:47], v227 offset:54272
    s_waitcnt lgkmcnt(8)
    v_mfma_f32_16x16x32_bf16 v[32:35], a[16:19], a[80:83], v[32:35]
    ds_read_b64_tr_b16 a[48:49], v224 offset:61440
    buffer_load_dwordx4 v250, s[40:43], s31 offen offset:1024 lds
    v_mfma_f32_16x16x32_bf16 v[36:39], a[16:19], a[84:87], v[36:39]
    ds_read_b64_tr_b16 a[50:51], v224 offset:62464
    v_mfma_f32_16x16x32_bf16 v[44:47], a[20:23], a[84:87], v[44:47]
    ds_read_b64_tr_b16 a[52:53], v225 offset:61440
    s_xor_b32 s30, s30, 0x10000
    v_mfma_f32_16x16x32_bf16 v[40:43], a[20:23], a[80:83], v[40:43]
    ds_read_b64_tr_b16 a[54:55], v225 offset:62464
    v_mfma_f32_16x16x32_bf16 v[48:51], a[24:27], a[80:83], v[48:51]
    ds_read_b64_tr_b16 a[56:57], v226 offset:61440
    s_add_u32 s6, s6, 32768
    v_mfma_f32_16x16x32_bf16 v[52:55], a[24:27], a[84:87], v[52:55]
    ds_read_b64_tr_b16 a[58:59], v226 offset:62464
    v_mfma_f32_16x16x32_bf16 v[60:63], a[28:31], a[84:87], v[60:63]
    ds_read_b64_tr_b16 a[60:61], v227 offset:61440
    buffer_load_dword v133, v245, s[8:11], s59 offen sc1
    v_mfma_f32_16x16x32_bf16 v[56:59], a[28:31], a[80:83], v[56:59]
    ds_read_b64_tr_b16 a[62:63], v227 offset:62464
    s_waitcnt vmcnt(22) lgkmcnt(8)
    s_barrier
    v_mfma_f32_16x16x32_bf16 v[0:3], a[32:35], a[88:91], v[0:3]
    ds_read_b64_tr_b16 a[0:1], v224 offset:0
    v_mfma_f32_16x16x32_bf16 v[4:7], a[32:35], a[92:95], v[4:7]
    ds_read_b64_tr_b16 a[2:3], v224 offset:1024
    v_mfma_f32_16x16x32_bf16 v[12:15], a[36:39], a[92:95], v[12:15]
    ds_read_b64_tr_b16 a[4:5], v225 offset:0
    v_mfma_f32_16x16x32_bf16 v[8:11], a[36:39], a[88:91], v[8:11]
    ds_read_b64_tr_b16 a[6:7], v225 offset:1024
    s_add_u32 s7, s6, s48
    v_mfma_f32_16x16x32_bf16 v[16:19], a[40:43], a[88:91], v[16:19]
    ds_read_b64_tr_b16 a[8:9], v226 offset:0
    v_mfma_f32_16x16x32_bf16 v[20:23], a[40:43], a[92:95], v[20:23]
    ds_read_b64_tr_b16 a[10:11], v226 offset:1024
    v_mfma_f32_16x16x32_bf16 v[28:31], a[44:47], a[92:95], v[28:31]
    ds_read_b64_tr_b16 a[12:13], v227 offset:0
    v_mfma_f32_16x16x32_bf16 v[24:27], a[44:47], a[88:91], v[24:27]
    ds_read_b64_tr_b16 a[14:15], v227 offset:1024
    s_add_u32 m0, s30, 32768
    s_waitcnt lgkmcnt(8)
    v_mfma_f32_16x16x32_bf16 v[32:35], a[48:51], a[88:91], v[32:35]
    ds_read_b64_tr_b16 a[16:17], v224 offset:8192
    v_mfma_f32_16x16x32_bf16 v[36:39], a[48:51], a[92:95], v[36:39]
    ds_read_b64_tr_b16 a[18:19], v224 offset:9216
    v_mfma_f32_16x16x32_bf16 v[44:47], a[52:55], a[92:95], v[44:47]
    ds_read_b64_tr_b16 a[20:21], v225 offset:8192
    v_mfma_f32_16x16x32_bf16 v[40:43], a[52:55], a[88:91], v[40:43]
    ds_read_b64_tr_b16 a[22:23], v225 offset:9216
    buffer_load_dwordx4 v249, s[40:43], s7 offen offset:0 lds
    v_mfma_f32_16x16x32_bf16 v[48:51], a[56:59], a[88:91], v[48:51]
    ds_read_b64_tr_b16 a[24:25], v226 offset:8192
    v_mfma_f32_16x16x32_bf16 v[52:55], a[56:59], a[92:95], v[52:55]
    ds_read_b64_tr_b16 a[26:27], v226 offset:9216
    v_mfma_f32_16x16x32_bf16 v[60:63], a[60:63], a[92:95], v[60:63]
    ds_read_b64_tr_b16 a[28:29], v227 offset:8192
    buffer_load_dwordx4 v250, s[40:43], s7 offen offset:1024 lds
    v_mfma_f32_16x16x32_bf16 v[56:59], a[60:63], a[88:91], v[56:59]
    ds_read_b64_tr_b16 a[30:31], v227 offset:9216
    s_waitcnt vmcnt(2) lgkmcnt(8)
    v_cmp_ne_u32 vcc, s29, v133
    s_cbranch_vccz bwait_ok
    s_mov_b32 s4, 0
bwait:
    buffer_load_dword v133, v245, s[8:11], s59 offen sc1
    s_add_u32 s4, s4, 1
    s_waitcnt vmcnt(0)
    v_cmp_ne_u32 vcc, s29, v133
    s_cbranch_vccz bwait_ok
    s_cmp_lt_u32 s4, 2097152
    s_cbranch_scc1 bwait
bwait_ok:
    v_mfma_f32_16x16x32_bf16 v[0:3], a[0:3], a[96:99], v[0:3]
    ds_read_b64_tr_b16 a[32:33], v224 offset:4096
    v_mfma_f32_16x16x32_bf16 v[4:7], a[0:3], a[100:103], v[4:7]
    ds_read_b64_tr_b16 a[34:35], v224 offset:5120
    s_xor_b32 s31, s7, 128
    v_mfma_f32_16x16x32_bf16 v[12:15], a[4:7], a[100:103], v[12:15]
    ds_read_b64_tr_b16 a[36:37], v225 offset:4096
    v_mfma_f32_16x16x32_bf16 v[8:11], a[4:7], a[96:99], v[8:11]
    ds_read_b64_tr_b16 a[38:39], v225 offset:5120
    s_add_u32 m0, s30, 40960
    v_mfma_f32_16x16x32_bf16 v[16:19], a[8:11], a[96:99], v[16:19]
    ds_read_b64_tr_b16 a[40:41], v226 offset:4096
    buffer_load_dwordx4 v249, s[40:43], s31 offen offset:0 lds
    v_mfma_f32_16x16x32_bf16 v[20:23], a[8:11], a[100:103], v[20:23]
    ds_read_b64_tr_b16 a[42:43], v226 offset:5120
    v_mfma_f32_16x16x32_bf16 v[28:31], a[12:15], a[100:103], v[28:31]
    ds_read_b64_tr_b16 a[44:45], v227 offset:4096
    buffer_load_dwordx4 v250, s[40:43], s31 offen offset:1024 lds
    v_mfma_f32_16x16x32_bf16 v[24:27], a[12:15], a[96:99], v[24:27]
    ds_read_b64_tr_b16 a[46:47], v227 offset:5120
    s_waitcnt lgkmcnt(8)
    v_mfma_f32_16x16x32_bf16 v[32:35], a[16:19], a[96:99], v[32:35]
    ds_read_b64_tr_b16 a[48:49], v224 offset:12288
    s_add_u32 s33, s32, s52
    v_mfma_f32_16x16x32_bf16 v[36:39], a[16:19], a[100:103], v[36:39]
    ds_read_b64_tr_b16 a[50:51], v224 offset:13312
    buffer_load_dwordx4 a[64:67], v241, s[8:11], s33 offen offset:0 sc1
    v_mfma_f32_16x16x32_bf16 v[44:47], a[20:23], a[100:103], v[44:47]
    ds_read_b64_tr_b16 a[52:53], v225 offset:12288
    v_mfma_f32_16x16x32_bf16 v[40:43], a[20:23], a[96:99], v[40:43]
    ds_read_b64_tr_b16 a[54:55], v225 offset:13312
    buffer_load_dwordx4 a[68:71], v241, s[8:11], s33 offen offset:1024 sc1
    v_mfma_f32_16x16x32_bf16 v[48:51], a[24:27], a[96:99], v[48:51]
    ds_read_b64_tr_b16 a[56:57], v226 offset:12288
    v_mfma_f32_16x16x32_bf16 v[52:55], a[24:27], a[100:103], v[52:55]
    ds_read_b64_tr_b16 a[58:59], v226 offset:13312
    buffer_load_dwordx4 a[72:75], v241, s[8:11], s33 offen offset:2048 sc1
    v_mfma_f32_16x16x32_bf16 v[60:63], a[28:31], a[100:103], v[60:63]
    ds_read_b64_tr_b16 a[60:61], v227 offset:12288
    buffer_load_dwordx4 a[76:79], v241, s[8:11], s33 offen offset:3072 sc1
    v_mfma_f32_16x16x32_bf16 v[56:59], a[28:31], a[96:99], v[56:59]
    ds_read_b64_tr_b16 a[62:63], v227 offset:13312
    s_waitcnt vmcnt(21) lgkmcnt(8)
    s_barrier
    v_mfma_f32_16x16x32_bf16 v[0:3], a[32:35], a[104:107], v[0:3]
    ds_read_b64_tr_b16 a[0:1], v224 offset:16384
    v_mfma_f32_16x16x32_bf16 v[4:7], a[32:35], a[108:111], v[4:7]
    ds_read_b64_tr_b16 a[2:3], v224 offset:17408
    s_add_u32 s7, s6, s49
    v_mfma_f32_16x16x32_bf16 v[12:15], a[36:39], a[108:111], v[12:15]
    ds_read_b64_tr_b16 a[4:5], v225 offset:16384
    v_mfma_f32_16x16x32_bf16 v[8:11], a[36:39], a[104:107], v[8:11]
    ds_read_b64_tr_b16 a[6:7], v225 offset:17408
    s_add_u32 m0, s30, 49152
    v_mfma_f32_16x16x32_bf16 v[16:19], a[40:43], a[104:107], v[16:19]
    ds_read_b64_tr_b16 a[8:9], v226 offset:16384
    buffer_load_dwordx4 v249, s[40:43], s7 offen offset:0 lds
    v_mfma_f32_16x16x32_bf16 v[20:23], a[40:43], a[108:111], v[20:23]
    ds_read_b64_tr_b16 a[10:11], v226 offset:17408
    v_mfma_f32_16x16x32_bf16 v[28:31], a[44:47], a[108:111], v[28:31]
    ds_read_b64_tr_b16 a[12:13], v227 offset:16384
    buffer_load_dwordx4 v250, s[40:43], s7 offen offset:1024 lds
    v_mfma_f32_16x16x32_bf16 v[24:27], a[44:47], a[104:107], v[24:27]
    ds_read_b64_tr_b16 a[14:15], v227 offset:17408
    s_waitcnt lgkmcnt(8)
    v_mfma_f32_16x16x32_bf16 v[32:35], a[48:51], a[104:107], v[32:35]
    ds_read_b64_tr_b16 a[16:17], v224 offset:24576
    s_add_u32 s33, s32, s53
    v_mfma_f32_16x16x32_bf16 v[36:39], a[48:51], a[108:111], v[36:39]
    ds_read_b64_tr_b16 a[18:19], v224 offset:25600
    buffer_load_dwordx4 a[80:83], v241, s[8:11], s33 offen offset:0 sc1
    v_mfma_f32_16x16x32_bf16 v[44:47], a[52:55], a[108:111], v[44:47]
    ds_read_b64_tr_b16 a[20:21], v225 offset:24576
    v_mfma_f32_16x16x32_bf16 v[40:43], a[52:55], a[104:107], v[40:43]
    ds_read_b64_tr_b16 a[22:23], v225 offset:25600
    buffer_load_dwordx4 a[84:87], v241, s[8:11], s33 offen offset:1024 sc1
    v_mfma_f32_16x16x32_bf16 v[48:51], a[56:59], a[104:107], v[48:51]
    ds_read_b64_tr_b16 a[24:25], v226 offset:24576
    v_mfma_f32_16x16x32_bf16 v[52:55], a[56:59], a[108:111], v[52:55]
    ds_read_b64_tr_b16 a[26:27], v226 offset:25600
    buffer_load_dwordx4 a[88:91], v241, s[8:11], s33 offen offset:2048 sc1
    v_mfma_f32_16x16x32_bf16 v[60:63], a[60:63], a[108:111], v[60:63]
    ds_read_b64_tr_b16 a[28:29], v227 offset:24576
    buffer_load_dwordx4 a[92:95], v241, s[8:11], s33 offen offset:3072 sc1
    v_mfma_f32_16x16x32_bf16 v[56:59], a[60:63], a[104:107], v[56:59]
    ds_read_b64_tr_b16 a[30:31], v227 offset:25600
    s_waitcnt vmcnt(23) lgkmcnt(8)
    v_mfma_f32_16x16x32_bf16 v[0:3], a[0:3], a[112:115], v[0:3]
    ds_read_b64_tr_b16 a[32:33], v224 offset:20480
    v_mfma_f32_16x16x32_bf16 v[4:7], a[0:3], a[116:119], v[4:7]
    ds_read_b64_tr_b16 a[34:35], v224 offset:21504
    s_xor_b32 s31, s7, 128
    v_mfma_f32_16x16x32_bf16 v[12:15], a[4:7], a[116:119], v[12:15]
    ds_read_b64_tr_b16 a[36:37], v225 offset:20480
    v_mfma_f32_16x16x32_bf16 v[8:11], a[4:7], a[112:115], v[8:11]
    ds_read_b64_tr_b16 a[38:39], v225 offset:21504
    s_add_u32 m0, s30, 57344
    v_mfma_f32_16x16x32_bf16 v[16:19], a[8:11], a[112:115], v[16:19]
    ds_read_b64_tr_b16 a[40:41], v226 offset:20480
    buffer_load_dwordx4 v249, s[40:43], s31 offen offset:0 lds
    v_mfma_f32_16x16x32_bf16 v[20:23], a[8:11], a[116:119], v[20:23]
    ds_read_b64_tr_b16 a[42:43], v226 offset:21504
    v_mfma_f32_16x16x32_bf16 v[28:31], a[12:15], a[116:119], v[28:31]
    ds_read_b64_tr_b16 a[44:45], v227 offset:20480
    buffer_load_dwordx4 v250, s[40:43], s31 offen offset:1024 lds
    v_mfma_f32_16x16x32_bf16 v[24:27], a[12:15], a[112:115], v[24:27]
    ds_read_b64_tr_b16 a[46:47], v227 offset:21504
    s_waitcnt lgkmcnt(8)
    v_mfma_f32_16x16x32_bf16 v[32:35], a[16:19], a[112:115], v[32:35]
    ds_read_b64_tr_b16 a[48:49], v224 offset:28672
    s_add_u32 s33, s32, s54
    v_mfma_f32_16x16x32_bf16 v[36:39], a[16:19], a[116:119], v[36:39]
    ds_read_b64_tr_b16 a[50:51], v224 offset:29696
    buffer_load_dwordx4 a[96:99], v241, s[8:11], s33 offen offset:0 sc1
    v_mfma_f32_16x16x32_bf16 v[44:47], a[20:23], a[116:119], v[44:47]
    ds_read_b64_tr_b16 a[52:53], v225 offset:28672
    v_mfma_f32_16x16x32_bf16 v[40:43], a[20:23], a[112:115], v[40:43]
    ds_read_b64_tr_b16 a[54:55], v225 offset:29696
    buffer_load_dwordx4 a[100:103], v241, s[8:11], s33 offen offset:1024 sc1
    v_mfma_f32_16x16x32_bf16 v[48:51], a[24:27], a[112:115], v[48:51]
    ds_read_b64_tr_b16 a[56:57], v226 offset:28672
    v_mfma_f32_16x16x32_bf16 v[52:55], a[24:27], a[116:119], v[52:55]
    ds_read_b64_tr_b16 a[58:59], v226 offset:29696
    buffer_load_dwordx4 a[104:107], v241, s[8:11], s33 offen offset:2048 sc1
    v_mfma_f32_16x16x32_bf16 v[60:63], a[28:31], a[116:119], v[60:63]
    ds_read_b64_tr_b16 a[60:61], v227 offset:28672
    buffer_load_dwordx4 a[108:111], v241, s[8:11], s33 offen offset:3072 sc1
    v_mfma_f32_16x16x32_bf16 v[56:59], a[28:31], a[112:115], v[56:59]
    ds_read_b64_tr_b16 a[62:63], v227 offset:29696
    s_waitcnt vmcnt(25) lgkmcnt(8)
    s_barrier
    v_xor_b32 v224, 0x10000, v224
    v_xor_b32 v225, 0x10000, v225
    v_xor_b32 v226, 0x10000, v226
    v_xor_b32 v227, 0x10000, v227
    v_mfma_f32_16x16x32_bf16 v[0:3], a[32:35], a[120:123], v[0:3]
    ds_read_b64_tr_b16 a[0:1], v224 offset:32768
    v_mfma_f32_16x16x32_bf16 v[4:7], a[32:35], a[124:127], v[4:7]
    ds_read_b64_tr_b16 a[2:3], v224 offset:33792
    v_mfma_f32_16x16x32_bf16 v[12:15], a[36:39], a[124:127], v[12:15]
    ds_read_b64_tr_b16 a[4:5], v225 offset:32768
    s_add_u32 s7, s6, s50
    v_mfma_f32_16x16x32_bf16 v[8:11], a[36:39], a[120:123], v[8:11]
    ds_read_b64_tr_b16 a[6:7], v225 offset:33792
    v_mfma_f32_16x16x32_bf16 v[16:19], a[40:43], a[120:123], v[16:19]
    ds_read_b64_tr_b16 a[8:9], v226 offset:32768
    s_add_u32 m0, s30, 0
    v_mfma_f32_16x16x32_bf16 v[20:23], a[40:43], a[124:127], v[20:23]
    ds_read_b64_tr_b16 a[10:11], v226 offset:33792
    v_mfma_f32_16x16x32_bf16 v[28:31], a[44:47], a[124:127], v[28:31]
    ds_read_b64_tr_b16 a[12:13], v227 offset:32768
    buffer_load_dwordx4 v249, s[40:43], s7 offen offset:0 lds
    v_mfma_f32_16x16x32_bf16 v[24:27], a[44:47], a[120:123], v[24:27]
    ds_read_b64_tr_b16 a[14:15], v227 offset:33792
    s_waitcnt lgkmcnt(8)
    v_mfma_f32_16x16x32_bf16 v[32:35], a[48:51], a[120:123], v[32:35]
    ds_read_b64_tr_b16 a[16:17], v224 offset:40960
    buffer_load_dwordx4 v250, s[40:43], s7 offen offset:1024 lds
    v_mfma_f32_16x16x32_bf16 v[36:39], a[48:51], a[124:127], v[36:39]
    ds_read_b64_tr_b16 a[18:19], v224 offset:41984
    v_mfma_f32_16x16x32_bf16 v[44:47], a[52:55], a[124:127], v[44:47]
    ds_read_b64_tr_b16 a[20:21], v225 offset:40960
    s_add_u32 s33, s32, s55
    v_mfma_f32_16x16x32_bf16 v[40:43], a[52:55], a[120:123], v[40:43]
    ds_read_b64_tr_b16 a[22:23], v225 offset:41984
    v_mfma_f32_16x16x32_bf16 v[48:51], a[56:59], a[120:123], v[48:51]
    ds_read_b64_tr_b16 a[24:25], v226 offset:40960
    buffer_load_dwordx4 a[112:115], v241, s[8:11], s33 offen offset:0 sc1
    v_mfma_f32_16x16x32_bf16 v[52:55], a[56:59], a[124:127], v[52:55]
    ds_read_b64_tr_b16 a[26:27], v226 offset:41984
    v_mfma_f32_16x16x32_bf16 v[60:63], a[60:63], a[124:127], v[60:63]
    ds_read_b64_tr_b16 a[28:29], v227 offset:40960
    buffer_load_dwordx4 a[116:119], v241, s[8:11], s33 offen offset:1024 sc1
    v_mfma_f32_16x16x32_bf16 v[56:59], a[60:63], a[120:123], v[56:59]
    ds_read_b64_tr_b16 a[30:31], v227 offset:41984
    s_waitcnt vmcnt(18) lgkmcnt(8)
    v_mfma_f32_16x16x32_bf16 v[0:3], a[0:3], a[64:67], v[0:3]
    ds_read_b64_tr_b16 a[32:33], v224 offset:36864
    v_mfma_f32_16x16x32_bf16 v[4:7], a[0:3], a[68:71], v[4:7]
    ds_read_b64_tr_b16 a[34:35], v224 offset:37888
    v_mfma_f32_16x16x32_bf16 v[12:15], a[4:7], a[68:71], v[12:15]
    ds_read_b64_tr_b16 a[36:37], v225 offset:36864
    s_xor_b32 s31, s7, 128
    v_mfma_f32_16x16x32_bf16 v[8:11], a[4:7], a[64:67], v[8:11]
    ds_read_b64_tr_b16 a[38:39], v225 offset:37888
    v_mfma_f32_16x16x32_bf16 v[16:19], a[8:11], a[64:67], v[16:19]
    ds_read_b64_tr_b16 a[40:41], v226 offset:36864
    s_add_u32 m0, s30, 8192
    v_mfma_f32_16x16x32_bf16 v[20:23], a[8:11], a[68:71], v[20:23]
    ds_read_b64_tr_b16 a[42:43], v226 offset:37888
    v_mfma_f32_16x16x32_bf16 v[28:31], a[12:15], a[68:71], v[28:31]
    ds_read_b64_tr_b16 a[44:45], v227 offset:36864
    buffer_load_dwordx4 v249, s[40:43], s31 offen offset:0 lds
    v_mfma_f32_16x16x32_bf16 v[24:27], a[12:15], a[64:67], v[24:27]
    ds_read_b64_tr_b16 a[46:47], v227 offset:37888
    s_waitcnt lgkmcnt(8)
    v_mfma_f32_16x16x32_bf16 v[32:35], a[16:19], a[64:67], v[32:35]
    ds_read_b64_tr_b16 a[48:49], v224 offset:45056
    buffer_load_dwordx4 v250, s[40:43], s31 offen offset:1024 lds
    v_mfma_f32_16x16x32_bf16 v[36:39], a[16:19], a[68:71], v[36:39]
    ds_read_b64_tr_b16 a[50:51], v224 offset:46080
    v_mfma_f32_16x16x32_bf16 v[44:47], a[20:23], a[68:71], v[44:47]
    ds_read_b64_tr_b16 a[52:53], v225 offset:45056
    buffer_load_dwordx4 a[120:123], v241, s[8:11], s33 offen offset:2048 sc1
    v_mfma_f32_16x16x32_bf16 v[40:43], a[20:23], a[64:67], v[40:43]
    ds_read_b64_tr_b16 a[54:55], v225 offset:46080
    v_mfma_f32_16x16x32_bf16 v[48:51], a[24:27], a[64:67], v[48:51]
    ds_read_b64_tr_b16 a[56:57], v226 offset:45056
    buffer_load_dwordx4 a[124:127], v241, s[8:11], s33 offen offset:3072 sc1
    v_mfma_f32_16x16x32_bf16 v[52:55], a[24:27], a[68:71], v[52:55]
    ds_read_b64_tr_b16 a[58:59], v226 offset:46080
    v_mfma_f32_16x16x32_bf16 v[60:63], a[28:31], a[68:71], v[60:63]
    ds_read_b64_tr_b16 a[60:61], v227 offset:45056
    s_add_u32 s32, s32, 32768
    v_mfma_f32_16x16x32_bf16 v[56:59], a[28:31], a[64:67], v[56:59]
    ds_read_b64_tr_b16 a[62:63], v227 offset:46080
    s_waitcnt vmcnt(20) lgkmcnt(8)
    s_barrier
    v_mfma_f32_16x16x32_bf16 v[0:3], a[32:35], a[72:75], v[0:3]
    ds_read_b64_tr_b16 a[0:1], v224 offset:49152
    v_mfma_f32_16x16x32_bf16 v[4:7], a[32:35], a[76:79], v[4:7]
    ds_read_b64_tr_b16 a[2:3], v224 offset:50176
    v_mfma_f32_16x16x32_bf16 v[12:15], a[36:39], a[76:79], v[12:15]
    ds_read_b64_tr_b16 a[4:5], v225 offset:49152
    s_add_u32 s7, s6, s51
    v_mfma_f32_16x16x32_bf16 v[8:11], a[36:39], a[72:75], v[8:11]
    ds_read_b64_tr_b16 a[6:7], v225 offset:50176
    v_mfma_f32_16x16x32_bf16 v[16:19], a[40:43], a[72:75], v[16:19]
    ds_read_b64_tr_b16 a[8:9], v226 offset:49152
    s_add_u32 m0, s30, 16384
    v_mfma_f32_16x16x32_bf16 v[20:23], a[40:43], a[76:79], v[20:23]
    ds_read_b64_tr_b16 a[10:11], v226 offset:50176
    v_mfma_f32_16x16x32_bf16 v[28:31], a[44:47], a[76:79], v[28:31]
    ds_read_b64_tr_b16 a[12:13], v227 offset:49152
    buffer_load_dwordx4 v249, s[40:43], s7 offen offset:0 lds
    v_mfma_f32_16x16x32_bf16 v[24:27], a[44:47], a[72:75], v[24:27]
    ds_read_b64_tr_b16 a[14:15], v227 offset:50176
    s_waitcnt lgkmcnt(8)
    v_mfma_f32_16x16x32_bf16 v[32:35], a[48:51], a[72:75], v[32:35]
    ds_read_b64_tr_b16 a[16:17], v224 offset:57344
    buffer_load_dwordx4 v250, s[40:43], s7 offen offset:1024 lds
    v_mfma_f32_16x16x32_bf16 v[36:39], a[48:51], a[76:79], v[36:39]
    ds_read_b64_tr_b16 a[18:19], v224 offset:58368
    v_mfma_f32_16x16x32_bf16 v[44:47], a[52:55], a[76:79], v[44:47]
    ds_read_b64_tr_b16 a[20:21], v225 offset:57344
    s_add_u32 s33, s32, s52
    v_mfma_f32_16x16x32_bf16 v[40:43], a[52:55], a[72:75], v[40:43]
    ds_read_b64_tr_b16 a[22:23], v225 offset:58368
    v_mfma_f32_16x16x32_bf16 v[48:51], a[56:59], a[72:75], v[48:51]
    ds_read_b64_tr_b16 a[24:25], v226 offset:57344
    buffer_load_dwordx4 a[64:67], v241, s[8:11], s33 offen offset:0 sc1
    v_mfma_f32_16x16x32_bf16 v[52:55], a[56:59], a[76:79], v[52:55]
    ds_read_b64_tr_b16 a[26:27], v226 offset:58368
    v_mfma_f32_16x16x32_bf16 v[60:63], a[60:63], a[76:79], v[60:63]
    ds_read_b64_tr_b16 a[28:29], v227 offset:57344
    buffer_load_dwordx4 a[68:71], v241, s[8:11], s33 offen offset:1024 sc1
    v_mfma_f32_16x16x32_bf16 v[56:59], a[60:63], a[72:75], v[56:59]
    ds_read_b64_tr_b16 a[30:31], v227 offset:58368
    s_mov_b32 s20, 2
.p2align 6
down_loop:
    s_waitcnt vmcnt(20) lgkmcnt(8)
    v_mfma_f32_16x16x32_bf16 v[0:3], a[0:3], a[80:83], v[0:3]
    ds_read_b64_tr_b16 a[32:33], v224 offset:53248
    v_mfma_f32_16x16x32_bf16 v[4:7], a[0:3], a[84:87], v[4:7]
    ds_read_b64_tr_b16 a[34:35], v224 offset:54272
    s_xor_b32 s31, s7, 128
    v_mfma_f32_16x16x32_bf16 v[12:15], a[4:7], a[84:87], v[12:15]
    ds_read_b64_tr_b16 a[36:37], v225 offset:53248
    v_mfma_f32_16x16x32_bf16 v[8:11], a[4:7], a[80:83], v[8:11]
    ds_read_b64_tr_b16 a[38:39], v225 offset:54272
    s_add_u32 m0, s30, 24576
    v_mfma_f32_16x16x32_bf16 v[16:19], a[8:11], a[80:83], v[16:19]
    ds_read_b64_tr_b16 a[40:41], v226 offset:53248
    v_mfma_f32_16x16x32_bf16 v[20:23], a[8:11], a[84:87], v[20:23]
    ds_read_b64_tr_b16 a[42:43], v226 offset:54272
    buffer_load_dwordx4 v249, s[40:43], s31 offen offset:0 lds
    v_mfma_f32_16x16x32_bf16 v[28:31], a[12:15], a[84:87], v[28:31]
    ds_read_b64_tr_b16 a[44:45], v227 offset:53248
    v_mfma_f32_16x16x32_bf16 v[24:27], a[12:15], a[80:83], v[24:27]
    ds_read_b64_tr_b16 a[46:47], v227 offset:54272
    buffer_load_dwordx4 v250, s[40:43], s31 offen offset:1024 lds
    s_waitcnt lgkmcnt(8)
    v_mfma_f32_16x16x32_bf16 v[32:35], a[16:19], a[80:83], v[32:35]
    ds_read_b64_tr_b16 a[48:49], v224 offset:61440
    v_mfma_f32_16x16x32_bf16 v[36:39], a[16:19], a[84:87], v[36:39]
    ds_read_b64_tr_b16 a[50:51], v224 offset:62464
    s_xor_b32 s30, s30, 0x10000
    v_mfma_f32_16x16x32_bf16 v[44:47], a[20:23], a[84:87], v[44:47]
    ds_read_b64_tr_b16 a[52:53], v225 offset:61440
    v_mfma_f32_16x16x32_bf16 v[40:43], a[20:23], a[80:83], v[40:43]
    ds_read_b64_tr_b16 a[54:55], v225 offset:62464
    s_add_u32 s6, s6, 32768
    v_mfma_f32_16x16x32_bf16 v[48:51], a[24:27], a[80:83], v[48:51]
    ds_read_b64_tr_b16 a[56:57], v226 offset:61440
    v_mfma_f32_16x16x32_bf16 v[52:55], a[24:27], a[84:87], v[52:55]
    ds_read_b64_tr_b16 a[58:59], v226 offset:62464
    buffer_load_dwordx4 a[72:75], v241, s[8:11], s33 offen offset:2048 sc1
    v_mfma_f32_16x16x32_bf16 v[60:63], a[28:31], a[84:87], v[60:63]
    ds_read_b64_tr_b16 a[60:61], v227 offset:61440
    buffer_load_dwordx4 a[76:79], v241, s[8:11], s33 offen offset:3072 sc1
    v_mfma_f32_16x16x32_bf16 v[56:59], a[28:31], a[80:83], v[56:59]
    ds_read_b64_tr_b16 a[62:63], v227 offset:62464
    s_waitcnt vmcnt(22) lgkmcnt(8)
    s_barrier
    v_mfma_f32_16x16x32_bf16 v[0:3], a[32:35], a[88:91], v[0:3]
    ds_read_b64_tr_b16 a[0:1], v224 offset:0
    v_mfma_f32_16x16x32_bf16 v[4:7], a[32:35], a[92:95], v[4:7]
    ds_read_b64_tr_b16 a[2:3], v224 offset:1024
    v_mfma_f32_16x16x32_bf16 v[12:15], a[36:39], a[92:95], v[12:15]
    ds_read_b64_tr_b16 a[4:5], v225 offset:0
    s_add_u32 s7, s6, s48
    v_mfma_f32_16x16x32_bf16 v[8:11], a[36:39], a[88:91], v[8:11]
    ds_read_b64_tr_b16 a[6:7], v225 offset:1024
    v_mfma_f32_16x16x32_bf16 v[16:19], a[40:43], a[88:91], v[16:19]
    ds_read_b64_tr_b16 a[8:9], v226 offset:0
    s_add_u32 m0, s30, 32768
    v_mfma_f32_16x16x32_bf16 v[20:23], a[40:43], a[92:95], v[20:23]
    ds_read_b64_tr_b16 a[10:11], v226 offset:1024
    v_mfma_f32_16x16x32_bf16 v[28:31], a[44:47], a[92:95], v[28:31]
    ds_read_b64_tr_b16 a[12:13], v227 offset:0
    buffer_load_dwordx4 v249, s[40:43], s7 offen offset:0 lds
    v_mfma_f32_16x16x32_bf16 v[24:27], a[44:47], a[88:91], v[24:27]
    ds_read_b64_tr_b16 a[14:15], v227 offset:1024
    s_waitcnt lgkmcnt(8)
    v_mfma_f32_16x16x32_bf16 v[32:35], a[48:51], a[88:91], v[32:35]
    ds_read_b64_tr_b16 a[16:17], v224 offset:8192
    buffer_load_dwordx4 v250, s[40:43], s7 offen offset:1024 lds
    v_mfma_f32_16x16x32_bf16 v[36:39], a[48:51], a[92:95], v[36:39]
    ds_read_b64_tr_b16 a[18:19], v224 offset:9216
    v_mfma_f32_16x16x32_bf16 v[44:47], a[52:55], a[92:95], v[44:47]
    ds_read_b64_tr_b16 a[20:21], v225 offset:8192
    s_add_u32 s33, s32, s53
    v_mfma_f32_16x16x32_bf16 v[40:43], a[52:55], a[88:91], v[40:43]
    ds_read_b64_tr_b16 a[22:23], v225 offset:9216
    v_mfma_f32_16x16x32_bf16 v[48:51], a[56:59], a[88:91], v[48:51]
    ds_read_b64_tr_b16 a[24:25], v226 offset:8192
    buffer_load_dwordx4 a[80:83], v241, s[8:11], s33 offen offset:0 sc1
    v_mfma_f32_16x16x32_bf16 v[52:55], a[56:59], a[92:95], v[52:55]
    ds_read_b64_tr_b16 a[26:27], v226 offset:9216
    v_mfma_f32_16x16x32_bf16 v[60:63], a[60:63], a[92:95], v[60:63]
    ds_read_b64_tr_b16 a[28:29], v227 offset:8192
    buffer_load_dwordx4 a[84:87], v241, s[8:11], s33 offen offset:1024 sc1
    v_mfma_f32_16x16x32_bf16 v[56:59], a[60:63], a[88:91], v[56:59]
    ds_read_b64_tr_b16 a[30:31], v227 offset:9216
    s_waitcnt vmcnt(22) lgkmcnt(8)
    v_mfma_f32_16x16x32_bf16 v[0:3], a[0:3], a[96:99], v[0:3]
    ds_read_b64_tr_b16 a[32:33], v224 offset:4096
    v_mfma_f32_16x16x32_bf16 v[4:7], a[0:3], a[100:103], v[4:7]
    ds_read_b64_tr_b16 a[34:35], v224 offset:5120
    v_mfma_f32_16x16x32_bf16 v[12:15], a[4:7], a[100:103], v[12:15]
    ds_read_b64_tr_b16 a[36:37], v225 offset:4096
    s_xor_b32 s31, s7, 128
    v_mfma_f32_16x16x32_bf16 v[8:11], a[4:7], a[96:99], v[8:11]
    ds_read_b64_tr_b16 a[38:39], v225 offset:5120
    v_mfma_f32_16x16x32_bf16 v[16:19], a[8:11], a[96:99], v[16:19]
    ds_read_b64_tr_b16 a[40:41], v226 offset:4096
    s_add_u32 m0, s30, 40960
    v_mfma_f32_16x16x32_bf16 v[20:23], a[8:11], a[100:103], v[20:23]
    ds_read_b64_tr_b16 a[42:43], v226 offset:5120
    v_mfma_f32_16x16x32_bf16 v[28:31], a[12:15], a[100:103], v[28:31]
    ds_read_b64_tr_b16 a[44:45], v227 offset:4096
    v_mfma_f32_16x16x32_bf16 v[24:27], a[12:15], a[96:99], v[24:27]
    ds_read_b64_tr_b16 a[46:47], v227 offset:5120
    buffer_load_dwordx4 v249, s[40:43], s31 offen offset:0 lds
    s_waitcnt lgkmcnt(8)
    v_mfma_f32_16x16x32_bf16 v[32:35], a[16:19], a[96:99], v[32:35]
    ds_read_b64_tr_b16 a[48:49], v224 offset:12288
    v_mfma_f32_16x16x32_bf16 v[36:39], a[16:19], a[100:103], v[36:39]
    ds_read_b64_tr_b16 a[50:51], v224 offset:13312
    buffer_load_dwordx4 v250, s[40:43], s31 offen offset:1024 lds
    v_mfma_f32_16x16x32_bf16 v[44:47], a[20:23], a[100:103], v[44:47]
    ds_read_b64_tr_b16 a[52:53], v225 offset:12288
    v_mfma_f32_16x16x32_bf16 v[40:43], a[20:23], a[96:99], v[40:43]
    ds_read_b64_tr_b16 a[54:55], v225 offset:13312
    v_mfma_f32_16x16x32_bf16 v[48:51], a[24:27], a[96:99], v[48:51]
    ds_read_b64_tr_b16 a[56:57], v226 offset:12288
    buffer_load_dwordx4 a[88:91], v241, s[8:11], s33 offen offset:2048 sc1
    v_mfma_f32_16x16x32_bf16 v[52:55], a[24:27], a[100:103], v[52:55]
    ds_read_b64_tr_b16 a[58:59], v226 offset:13312
    v_mfma_f32_16x16x32_bf16 v[60:63], a[28:31], a[100:103], v[60:63]
    ds_read_b64_tr_b16 a[60:61], v227 offset:12288
    buffer_load_dwordx4 a[92:95], v241, s[8:11], s33 offen offset:3072 sc1
    v_mfma_f32_16x16x32_bf16 v[56:59], a[28:31], a[96:99], v[56:59]
    ds_read_b64_tr_b16 a[62:63], v227 offset:13312
    s_waitcnt vmcnt(24) lgkmcnt(8)
    s_barrier
    v_mfma_f32_16x16x32_bf16 v[0:3], a[32:35], a[104:107], v[0:3]
    ds_read_b64_tr_b16 a[0:1], v224 offset:16384
    v_mfma_f32_16x16x32_bf16 v[4:7], a[32:35], a[108:111], v[4:7]
    ds_read_b64_tr_b16 a[2:3], v224 offset:17408
    v_mfma_f32_16x16x32_bf16 v[12:15], a[36:39], a[108:111], v[12:15]
    ds_read_b64_tr_b16 a[4:5], v225 offset:16384
    s_add_u32 s7, s6, s49
    v_mfma_f32_16x16x32_bf16 v[8:11], a[36:39], a[104:107], v[8:11]
    ds_read_b64_tr_b16 a[6:7], v225 offset:17408
    v_mfma_f32_16x16x32_bf16 v[16:19], a[40:43], a[104:107], v[16:19]
    ds_read_b64_tr_b16 a[8:9], v226 offset:16384
    s_add_u32 m0, s30, 49152
    v_mfma_f32_16x16x32_bf16 v[20:23], a[40:43], a[108:111], v[20:23]
    ds_read_b64_tr_b16 a[10:11], v226 offset:17408
    v_mfma_f32_16x16x32_bf16 v[28:31], a[44:47], a[108:111], v[28:31]
    ds_read_b64_tr_b16 a[12:13], v227 offset:16384
    buffer_load_dwordx4 v249, s[40:43], s7 offen offset:0 lds
    v_mfma_f32_16x16x32_bf16 v[24:27], a[44:47], a[104:107], v[24:27]
    ds_read_b64_tr_b16 a[14:15], v227 offset:17408
    s_waitcnt lgkmcnt(8)
    v_mfma_f32_16x16x32_bf16 v[32:35], a[48:51], a[104:107], v[32:35]
    ds_read_b64_tr_b16 a[16:17], v224 offset:24576
    buffer_load_dwordx4 v250, s[40:43], s7 offen offset:1024 lds
    v_mfma_f32_16x16x32_bf16 v[36:39], a[48:51], a[108:111], v[36:39]
    ds_read_b64_tr_b16 a[18:19], v224 offset:25600
    v_mfma_f32_16x16x32_bf16 v[44:47], a[52:55], a[108:111], v[44:47]
    ds_read_b64_tr_b16 a[20:21], v225 offset:24576
    s_add_u32 s33, s32, s54
    v_mfma_f32_16x16x32_bf16 v[40:43], a[52:55], a[104:107], v[40:43]
    ds_read_b64_tr_b16 a[22:23], v225 offset:25600
    v_mfma_f32_16x16x32_bf16 v[48:51], a[56:59], a[104:107], v[48:51]
    ds_read_b64_tr_b16 a[24:25], v226 offset:24576
    buffer_load_dwordx4 a[96:99], v241, s[8:11], s33 offen offset:0 sc1
    v_mfma_f32_16x16x32_bf16 v[52:55], a[56:59], a[108:111], v[52:55]
    ds_read_b64_tr_b16 a[26:27], v226 offset:25600
    v_mfma_f32_16x16x32_bf16 v[60:63], a[60:63], a[108:111], v[60:63]
    ds_read_b64_tr_b16 a[28:29], v227 offset:24576
    buffer_load_dwordx4 a[100:103], v241, s[8:11], s33 offen offset:1024 sc1
    v_mfma_f32_16x16x32_bf16 v[56:59], a[60:63], a[104:107], v[56:59]
    ds_read_b64_tr_b16 a[30:31], v227 offset:25600
    s_waitcnt vmcnt(24) lgkmcnt(8)
    v_mfma_f32_16x16x32_bf16 v[0:3], a[0:3], a[112:115], v[0:3]
    ds_read_b64_tr_b16 a[32:33], v224 offset:20480
    v_mfma_f32_16x16x32_bf16 v[4:7], a[0:3], a[116:119], v[4:7]
    ds_read_b64_tr_b16 a[34:35], v224 offset:21504
    v_mfma_f32_16x16x32_bf16 v[12:15], a[4:7], a[116:119], v[12:15]
    ds_read_b64_tr_b16 a[36:37], v225 offset:20480
    s_xor_b32 s31, s7, 128
    v_mfma_f32_16x16x32_bf16 v[8:11], a[4:7], a[112:115], v[8:11]
    ds_read_b64_tr_b16 a[38:39], v225 offset:21504
    v_mfma_f32_16x16x32_bf16 v[16:19], a[8:11], a[112:115], v[16:19]
    ds_read_b64_tr_b16 a[40:41], v226 offset:20480
    s_add_u32 m0, s30, 57344
    v_mfma_f32_16x16x32_bf16 v[20:23], a[8:11], a[116:119], v[20:23]
    ds_read_b64_tr_b16 a[42:43], v226 offset:21504
    v_mfma_f32_16x16x32_bf16 v[28:31], a[12:15], a[116:119], v[28:31]
    ds_read_b64_tr_b16 a[44:45], v227 offset:20480
    v_mfma_f32_16x16x32_bf16 v[24:27], a[12:15], a[112:115], v[24:27]
    ds_read_b64_tr_b16 a[46:47], v227 offset:21504
    buffer_load_dwordx4 v249, s[40:43], s31 offen offset:0 lds
    s_waitcnt lgkmcnt(8)
    v_mfma_f32_16x16x32_bf16 v[32:35], a[16:19], a[112:115], v[32:35]
    ds_read_b64_tr_b16 a[48:49], v224 offset:28672
    v_mfma_f32_16x16x32_bf16 v[36:39], a[16:19], a[116:119], v[36:39]
    ds_read_b64_tr_b16 a[50:51], v224 offset:29696
    buffer_load_dwordx4 v250, s[40:43], s31 offen offset:1024 lds
    v_mfma_f32_16x16x32_bf16 v[44:47], a[20:23], a[116:119], v[44:47]
    ds_read_b64_tr_b16 a[52:53], v225 offset:28672
    v_mfma_f32_16x16x32_bf16 v[40:43], a[20:23], a[112:115], v[40:43]
    ds_read_b64_tr_b16 a[54:55], v225 offset:29696
    v_mfma_f32_16x16x32_bf16 v[48:51], a[24:27], a[112:115], v[48:51]
    ds_read_b64_tr_b16 a[56:57], v226 offset:28672
    buffer_load_dwordx4 a[104:107], v241, s[8:11], s33 offen offset:2048 sc1
    v_mfma_f32_16x16x32_bf16 v[52:55], a[24:27], a[116:119], v[52:55]
    ds_read_b64_tr_b16 a[58:59], v226 offset:29696
    v_mfma_f32_16x16x32_bf16 v[60:63], a[28:31], a[116:119], v[60:63]
    ds_read_b64_tr_b16 a[60:61], v227 offset:28672
    buffer_load_dwordx4 a[108:111], v241, s[8:11], s33 offen offset:3072 sc1
    v_mfma_f32_16x16x32_bf16 v[56:59], a[28:31], a[112:115], v[56:59]
    ds_read_b64_tr_b16 a[62:63], v227 offset:29696
    s_waitcnt vmcnt(24) lgkmcnt(8)
    s_barrier
    v_xor_b32 v224, 0x10000, v224
    v_xor_b32 v225, 0x10000, v225
    v_xor_b32 v226, 0x10000, v226
    v_xor_b32 v227, 0x10000, v227
    v_mfma_f32_16x16x32_bf16 v[0:3], a[32:35], a[120:123], v[0:3]
    ds_read_b64_tr_b16 a[0:1], v224 offset:32768
    v_mfma_f32_16x16x32_bf16 v[4:7], a[32:35], a[124:127], v[4:7]
    ds_read_b64_tr_b16 a[2:3], v224 offset:33792
    v_mfma_f32_16x16x32_bf16 v[12:15], a[36:39], a[124:127], v[12:15]
    ds_read_b64_tr_b16 a[4:5], v225 offset:32768
    s_add_u32 s7, s6, s50
    v_mfma_f32_16x16x32_bf16 v[8:11], a[36:39], a[120:123], v[8:11]
    ds_read_b64_tr_b16 a[6:7], v225 offset:33792
    v_mfma_f32_16x16x32_bf16 v[16:19], a[40:43], a[120:123], v[16:19]
    ds_read_b64_tr_b16 a[8:9], v226 offset:32768
    s_add_u32 m0, s30, 0
    v_mfma_f32_16x16x32_bf16 v[20:23], a[40:43], a[124:127], v[20:23]
    ds_read_b64_tr_b16 a[10:11], v226 offset:33792
    v_mfma_f32_16x16x32_bf16 v[28:31], a[44:47], a[124:127], v[28:31]
    ds_read_b64_tr_b16 a[12:13], v227 offset:32768
    buffer_load_dwordx4 v249, s[40:43], s7 offen offset:0 lds
    v_mfma_f32_16x16x32_bf16 v[24:27], a[44:47], a[120:123], v[24:27]
    ds_read_b64_tr_b16 a[14:15], v227 offset:33792
    s_waitcnt lgkmcnt(8)
    v_mfma_f32_16x16x32_bf16 v[32:35], a[48:51], a[120:123], v[32:35]
    ds_read_b64_tr_b16 a[16:17], v224 offset:40960
    buffer_load_dwordx4 v250, s[40:43], s7 offen offset:1024 lds
    v_mfma_f32_16x16x32_bf16 v[36:39], a[48:51], a[124:127], v[36:39]
    ds_read_b64_tr_b16 a[18:19], v224 offset:41984
    v_mfma_f32_16x16x32_bf16 v[44:47], a[52:55], a[124:127], v[44:47]
    ds_read_b64_tr_b16 a[20:21], v225 offset:40960
    s_add_u32 s33, s32, s55
    v_mfma_f32_16x16x32_bf16 v[40:43], a[52:55], a[120:123], v[40:43]
    ds_read_b64_tr_b16 a[22:23], v225 offset:41984
    v_mfma_f32_16x16x32_bf16 v[48:51], a[56:59], a[120:123], v[48:51]
    ds_read_b64_tr_b16 a[24:25], v226 offset:40960
    buffer_load_dwordx4 a[112:115], v241, s[8:11], s33 offen offset:0 sc1
    v_mfma_f32_16x16x32_bf16 v[52:55], a[56:59], a[124:127], v[52:55]
    ds_read_b64_tr_b16 a[26:27], v226 offset:41984
    v_mfma_f32_16x16x32_bf16 v[60:63], a[60:63], a[124:127], v[60:63]
    ds_read_b64_tr_b16 a[28:29], v227 offset:40960
    buffer_load_dwordx4 a[116:119], v241, s[8:11], s33 offen offset:1024 sc1
    v_mfma_f32_16x16x32_bf16 v[56:59], a[60:63], a[120:123], v[56:59]
    ds_read_b64_tr_b16 a[30:31], v227 offset:41984
    s_waitcnt vmcnt(24) lgkmcnt(8)
    v_mfma_f32_16x16x32_bf16 v[0:3], a[0:3], a[64:67], v[0:3]
    ds_read_b64_tr_b16 a[32:33], v224 offset:36864
    v_mfma_f32_16x16x32_bf16 v[4:7], a[0:3], a[68:71], v[4:7]
    ds_read_b64_tr_b16 a[34:35], v224 offset:37888
    v_mfma_f32_16x16x32_bf16 v[12:15], a[4:7], a[68:71], v[12:15]
    ds_read_b64_tr_b16 a[36:37], v225 offset:36864
    s_xor_b32 s31, s7, 128
    v_mfma_f32_16x16x32_bf16 v[8:11], a[4:7], a[64:67], v[8:11]
    ds_read_b64_tr_b16 a[38:39], v225 offset:37888
    v_mfma_f32_16x16x32_bf16 v[16:19], a[8:11], a[64:67], v[16:19]
    ds_read_b64_tr_b16 a[40:41], v226 offset:36864
    s_add_u32 m0, s30, 8192
    v_mfma_f32_16x16x32_bf16 v[20:23], a[8:11], a[68:71], v[20:23]
    ds_read_b64_tr_b16 a[42:43], v226 offset:37888
    v_mfma_f32_16x16x32_bf16 v[28:31], a[12:15], a[68:71], v[28:31]
    ds_read_b64_tr_b16 a[44:45], v227 offset:36864
    buffer_load_dwordx4 v249, s[40:43], s31 offen offset:0 lds
    v_mfma_f32_16x16x32_bf16 v[24:27], a[12:15], a[64:67], v[24:27]
    ds_read_b64_tr_b16 a[46:47], v227 offset:37888
    s_waitcnt lgkmcnt(8)
    v_mfma_f32_16x16x32_bf16 v[32:35], a[16:19], a[64:67], v[32:35]
    ds_read_b64_tr_b16 a[48:49], v224 offset:45056
    buffer_load_dwordx4 v250, s[40:43], s31 offen offset:1024 lds
    v_mfma_f32_16x16x32_bf16 v[36:39], a[16:19], a[68:71], v[36:39]
    ds_read_b64_tr_b16 a[50:51], v224 offset:46080
    v_mfma_f32_16x16x32_bf16 v[44:47], a[20:23], a[68:71], v[44:47]
    ds_read_b64_tr_b16 a[52:53], v225 offset:45056
    buffer_load_dwordx4 a[120:123], v241, s[8:11], s33 offen offset:2048 sc1
    v_mfma_f32_16x16x32_bf16 v[40:43], a[20:23], a[64:67], v[40:43]
    ds_read_b64_tr_b16 a[54:55], v225 offset:46080
    v_mfma_f32_16x16x32_bf16 v[48:51], a[24:27], a[64:67], v[48:51]
    ds_read_b64_tr_b16 a[56:57], v226 offset:45056
    buffer_load_dwordx4 a[124:127], v241, s[8:11], s33 offen offset:3072 sc1
    v_mfma_f32_16x16x32_bf16 v[52:55], a[24:27], a[68:71], v[52:55]
    ds_read_b64_tr_b16 a[58:59], v226 offset:46080
    v_mfma_f32_16x16x32_bf16 v[60:63], a[28:31], a[68:71], v[60:63]
    ds_read_b64_tr_b16 a[60:61], v227 offset:45056
    s_add_u32 s32, s32, 32768
    v_mfma_f32_16x16x32_bf16 v[56:59], a[28:31], a[64:67], v[56:59]
    ds_read_b64_tr_b16 a[62:63], v227 offset:46080
    s_waitcnt vmcnt(24) lgkmcnt(8)
    s_barrier
    v_mfma_f32_16x16x32_bf16 v[0:3], a[32:35], a[72:75], v[0:3]
    ds_read_b64_tr_b16 a[0:1], v224 offset:49152
    v_mfma_f32_16x16x32_bf16 v[4:7], a[32:35], a[76:79], v[4:7]
    ds_read_b64_tr_b16 a[2:3], v224 offset:50176
    v_mfma_f32_16x16x32_bf16 v[12:15], a[36:39], a[76:79], v[12:15]
    ds_read_b64_tr_b16 a[4:5], v225 offset:49152
    s_add_u32 s7, s6, s51
    v_mfma_f32_16x16x32_bf16 v[8:11], a[36:39], a[72:75], v[8:11]
    ds_read_b64_tr_b16 a[6:7], v225 offset:50176
    v_mfma_f32_16x16x32_bf16 v[16:19], a[40:43], a[72:75], v[16:19]
    ds_read_b64_tr_b16 a[8:9], v226 offset:49152
    s_add_u32 m0, s30, 16384
    v_mfma_f32_16x16x32_bf16 v[20:23], a[40:43], a[76:79], v[20:23]
    ds_read_b64_tr_b16 a[10:11], v226 offset:50176
    v_mfma_f32_16x16x32_bf16 v[28:31], a[44:47], a[76:79], v[28:31]
    ds_read_b64_tr_b16 a[12:13], v227 offset:49152
    buffer_load_dwordx4 v249, s[40:43], s7 offen offset:0 lds
    v_mfma_f32_16x16x32_bf16 v[24:27], a[44:47], a[72:75], v[24:27]
    ds_read_b64_tr_b16 a[14:15], v227 offset:50176
    s_waitcnt lgkmcnt(8)
    v_mfma_f32_16x16x32_bf16 v[32:35], a[48:51], a[72:75], v[32:35]
    ds_read_b64_tr_b16 a[16:17], v224 offset:57344
    buffer_load_dwordx4 v250, s[40:43], s7 offen offset:1024 lds
    v_mfma_f32_16x16x32_bf16 v[36:39], a[48:51], a[76:79], v[36:39]
    ds_read_b64_tr_b16 a[18:19], v224 offset:58368
    v_mfma_f32_16x16x32_bf16 v[44:47], a[52:55], a[76:79], v[44:47]
    ds_read_b64_tr_b16 a[20:21], v225 offset:57344
    s_add_u32 s33, s32, s52
    v_mfma_f32_16x16x32_bf16 v[40:43], a[52:55], a[72:75], v[40:43]
    ds_read_b64_tr_b16 a[22:23], v225 offset:58368
    v_mfma_f32_16x16x32_bf16 v[48:51], a[56:59], a[72:75], v[48:51]
    ds_read_b64_tr_b16 a[24:25], v226 offset:57344
    buffer_load_dwordx4 a[64:67], v241, s[8:11], s33 offen offset:0 sc1
    v_mfma_f32_16x16x32_bf16 v[52:55], a[56:59], a[76:79], v[52:55]
    ds_read_b64_tr_b16 a[26:27], v226 offset:58368
    v_mfma_f32_16x16x32_bf16 v[60:63], a[60:63], a[76:79], v[60:63]
    s_sub_u32 s20, s20, 1
    ds_read_b64_tr_b16 a[28:29], v227 offset:57344
    buffer_load_dwordx4 a[68:71], v241, s[8:11], s33 offen offset:1024 sc1
    v_mfma_f32_16x16x32_bf16 v[56:59], a[60:63], a[72:75], v[56:59]
    s_cmp_lg_u32 s20, 0
    ds_read_b64_tr_b16 a[30:31], v227 offset:58368
    s_cbranch_scc1 down_loop
    s_waitcnt vmcnt(24) lgkmcnt(8)
    v_mfma_f32_16x16x32_bf16 v[0:3], a[0:3], a[80:83], v[0:3]
    ds_read_b64_tr_b16 a[32:33], v224 offset:53248
    v_mfma_f32_16x16x32_bf16 v[4:7], a[0:3], a[84:87], v[4:7]
    ds_read_b64_tr_b16 a[34:35], v224 offset:54272
    s_xor_b32 s31, s7, 128
    v_mfma_f32_16x16x32_bf16 v[12:15], a[4:7], a[84:87], v[12:15]
    ds_read_b64_tr_b16 a[36:37], v225 offset:53248
    v_mfma_f32_16x16x32_bf16 v[8:11], a[4:7], a[80:83], v[8:11]
    ds_read_b64_tr_b16 a[38:39], v225 offset:54272
    s_add_u32 m0, s30, 24576
    v_mfma_f32_16x16x32_bf16 v[16:19], a[8:11], a[80:83], v[16:19]
    ds_read_b64_tr_b16 a[40:41], v226 offset:53248
    v_mfma_f32_16x16x32_bf16 v[20:23], a[8:11], a[84:87], v[20:23]
    ds_read_b64_tr_b16 a[42:43], v226 offset:54272
    buffer_load_dwordx4 v249, s[40:43], s31 offen offset:0 lds
    v_mfma_f32_16x16x32_bf16 v[28:31], a[12:15], a[84:87], v[28:31]
    ds_read_b64_tr_b16 a[44:45], v227 offset:53248
    v_mfma_f32_16x16x32_bf16 v[24:27], a[12:15], a[80:83], v[24:27]
    ds_read_b64_tr_b16 a[46:47], v227 offset:54272
    buffer_load_dwordx4 v250, s[40:43], s31 offen offset:1024 lds
    s_waitcnt lgkmcnt(8)
    v_mfma_f32_16x16x32_bf16 v[32:35], a[16:19], a[80:83], v[32:35]
    ds_read_b64_tr_b16 a[48:49], v224 offset:61440
    v_mfma_f32_16x16x32_bf16 v[36:39], a[16:19], a[84:87], v[36:39]
    ds_read_b64_tr_b16 a[50:51], v224 offset:62464
    s_xor_b32 s30, s30, 0x10000
    v_mfma_f32_16x16x32_bf16 v[44:47], a[20:23], a[84:87], v[44:47]
    ds_read_b64_tr_b16 a[52:53], v225 offset:61440
    v_mfma_f32_16x16x32_bf16 v[40:43], a[20:23], a[80:83], v[40:43]
    ds_read_b64_tr_b16 a[54:55], v225 offset:62464
    s_add_u32 s6, s6, 32768
    v_mfma_f32_16x16x32_bf16 v[48:51], a[24:27], a[80:83], v[48:51]
    ds_read_b64_tr_b16 a[56:57], v226 offset:61440
    v_mfma_f32_16x16x32_bf16 v[52:55], a[24:27], a[84:87], v[52:55]
    ds_read_b64_tr_b16 a[58:59], v226 offset:62464
    buffer_load_dwordx4 a[72:75], v241, s[8:11], s33 offen offset:2048 sc1
    v_mfma_f32_16x16x32_bf16 v[60:63], a[28:31], a[84:87], v[60:63]
    ds_read_b64_tr_b16 a[60:61], v227 offset:61440
    buffer_load_dwordx4 a[76:79], v241, s[8:11], s33 offen offset:3072 sc1
    v_mfma_f32_16x16x32_bf16 v[56:59], a[28:31], a[80:83], v[56:59]
    ds_read_b64_tr_b16 a[62:63], v227 offset:62464
    s_waitcnt vmcnt(24) lgkmcnt(8)
    s_barrier
    v_mfma_f32_16x16x32_bf16 v[0:3], a[32:35], a[88:91], v[0:3]
    ds_read_b64_tr_b16 a[0:1], v224 offset:0
    v_mfma_f32_16x16x32_bf16 v[4:7], a[32:35], a[92:95], v[4:7]
    ds_read_b64_tr_b16 a[2:3], v224 offset:1024
    v_mfma_f32_16x16x32_bf16 v[12:15], a[36:39], a[92:95], v[12:15]
    ds_read_b64_tr_b16 a[4:5], v225 offset:0
    s_mov_b32 s7, s34
    v_mfma_f32_16x16x32_bf16 v[8:11], a[36:39], a[88:91], v[8:11]
    ds_read_b64_tr_b16 a[6:7], v225 offset:1024
    v_mfma_f32_16x16x32_bf16 v[16:19], a[40:43], a[88:91], v[16:19]
    ds_read_b64_tr_b16 a[8:9], v226 offset:0
    s_add_u32 m0, s30, 32768
    v_mfma_f32_16x16x32_bf16 v[20:23], a[40:43], a[92:95], v[20:23]
    ds_read_b64_tr_b16 a[10:11], v226 offset:1024
    v_mfma_f32_16x16x32_bf16 v[28:31], a[44:47], a[92:95], v[28:31]
    ds_read_b64_tr_b16 a[12:13], v227 offset:0
    buffer_load_dwordx4 v249, s[40:43], s7 offen offset:0 lds
    v_mfma_f32_16x16x32_bf16 v[24:27], a[44:47], a[88:91], v[24:27]
    ds_read_b64_tr_b16 a[14:15], v227 offset:1024
    s_waitcnt lgkmcnt(8)
    v_mfma_f32_16x16x32_bf16 v[32:35], a[48:51], a[88:91], v[32:35]
    ds_read_b64_tr_b16 a[16:17], v224 offset:8192
    buffer_load_dwordx4 v250, s[40:43], s7 offen offset:1024 lds
    v_mfma_f32_16x16x32_bf16 v[36:39], a[48:51], a[92:95], v[36:39]
    ds_read_b64_tr_b16 a[18:19], v224 offset:9216
    v_mfma_f32_16x16x32_bf16 v[44:47], a[52:55], a[92:95], v[44:47]
    ds_read_b64_tr_b16 a[20:21], v225 offset:8192
    s_add_u32 s33, s32, s53
    v_mfma_f32_16x16x32_bf16 v[40:43], a[52:55], a[88:91], v[40:43]
    ds_read_b64_tr_b16 a[22:23], v225 offset:9216
    v_mfma_f32_16x16x32_bf16 v[48:51], a[56:59], a[88:91], v[48:51]
    ds_read_b64_tr_b16 a[24:25], v226 offset:8192
    buffer_load_dwordx4 a[80:83], v241, s[8:11], s33 offen offset:0 sc1
    v_mfma_f32_16x16x32_bf16 v[52:55], a[56:59], a[92:95], v[52:55]
    ds_read_b64_tr_b16 a[26:27], v226 offset:9216
    v_mfma_f32_16x16x32_bf16 v[60:63], a[60:63], a[92:95], v[60:63]
    ds_read_b64_tr_b16 a[28:29], v227 offset:8192
    buffer_load_dwordx4 a[84:87], v241, s[8:11], s33 offen offset:1024 sc1
    v_mfma_f32_16x16x32_bf16 v[56:59], a[60:63], a[88:91], v[56:59]
    ds_read_b64_tr_b16 a[30:31], v227 offset:9216
    s_waitcnt vmcnt(24) lgkmcnt(8)
    v_mfma_f32_16x16x32_bf16 v[0:3], a[0:3], a[96:99], v[0:3]
    ds_read_b64_tr_b16 a[32:33], v224 offset:4096
    v_mfma_f32_16x16x32_bf16 v[4:7], a[0:3], a[100:103], v[4:7]
    ds_read_b64_tr_b16 a[34:35], v224 offset:5120
    v_mfma_f32_16x16x32_bf16 v[12:15], a[4:7], a[100:103], v[12:15]
    ds_read_b64_tr_b16 a[36:37], v225 offset:4096
    v_mfma_f32_16x16x32_bf16 v[8:11], a[4:7], a[96:99], v[8:11]
    ds_read_b64_tr_b16 a[38:39], v225 offset:5120
    v_mfma_f32_16x16x32_bf16 v[16:19], a[8:11], a[96:99], v[16:19]
    ds_read_b64_tr_b16 a[40:41], v226 offset:4096
    v_mfma_f32_16x16x32_bf16 v[20:23], a[8:11], a[100:103], v[20:23]
    ds_read_b64_tr_b16 a[42:43], v226 offset:5120
    v_mfma_f32_16x16x32_bf16 v[28:31], a[12:15], a[100:103], v[28:31]
    ds_read_b64_tr_b16 a[44:45], v227 offset:4096
    v_mfma_f32_16x16x32_bf16 v[24:27], a[12:15], a[96:99], v[24:27]
    ds_read_b64_tr_b16 a[46:47], v227 offset:5120
    buffer_load_dwordx4 a[88:91], v241, s[8:11], s33 offen offset:2048 sc1
    s_waitcnt lgkmcnt(8)
    v_mfma_f32_16x16x32_bf16 v[32:35], a[16:19], a[96:99], v[32:35]
    ds_read_b64_tr_b16 a[48:49], v224 offset:12288
    v_mfma_f32_16x16x32_bf16 v[36:39], a[16:19], a[100:103], v[36:39]
    ds_read_b64_tr_b16 a[50:51], v224 offset:13312
    v_mfma_f32_16x16x32_bf16 v[44:47], a[20:23], a[100:103], v[44:47]
    ds_read_b64_tr_b16 a[52:53], v225 offset:12288
    v_mfma_f32_16x16x32_bf16 v[40:43], a[20:23], a[96:99], v[40:43]
    ds_read_b64_tr_b16 a[54:55], v225 offset:13312
    v_mfma_f32_16x16x32_bf16 v[48:51], a[24:27], a[96:99], v[48:51]
    ds_read_b64_tr_b16 a[56:57], v226 offset:12288
    v_mfma_f32_16x16x32_bf16 v[52:55], a[24:27], a[100:103], v[52:55]
    ds_read_b64_tr_b16 a[58:59], v226 offset:13312
    v_mfma_f32_16x16x32_bf16 v[60:63], a[28:31], a[100:103], v[60:63]
    ds_read_b64_tr_b16 a[60:61], v227 offset:12288
    buffer_load_dwordx4 a[92:95], v241, s[8:11], s33 offen offset:3072 sc1
    v_mfma_f32_16x16x32_bf16 v[56:59], a[28:31], a[96:99], v[56:59]
    ds_read_b64_tr_b16 a[62:63], v227 offset:13312
    s_waitcnt vmcnt(22) lgkmcnt(8)
    s_barrier
    v_mfma_f32_16x16x32_bf16 v[0:3], a[32:35], a[104:107], v[0:3]
    ds_read_b64_tr_b16 a[0:1], v224 offset:16384
    v_mfma_f32_16x16x32_bf16 v[4:7], a[32:35], a[108:111], v[4:7]
    ds_read_b64_tr_b16 a[2:3], v224 offset:17408
    v_mfma_f32_16x16x32_bf16 v[12:15], a[36:39], a[108:111], v[12:15]
    ds_read_b64_tr_b16 a[4:5], v225 offset:16384
    s_add_u32 s7, s7, 917504
    v_mfma_f32_16x16x32_bf16 v[8:11], a[36:39], a[104:107], v[8:11]
    ds_read_b64_tr_b16 a[6:7], v225 offset:17408
    v_mfma_f32_16x16x32_bf16 v[16:19], a[40:43], a[104:107], v[16:19]
    ds_read_b64_tr_b16 a[8:9], v226 offset:16384
    s_add_u32 m0, s30, 49152
    v_mfma_f32_16x16x32_bf16 v[20:23], a[40:43], a[108:111], v[20:23]
    ds_read_b64_tr_b16 a[10:11], v226 offset:17408
    v_mfma_f32_16x16x32_bf16 v[28:31], a[44:47], a[108:111], v[28:31]
    ds_read_b64_tr_b16 a[12:13], v227 offset:16384
    buffer_load_dwordx4 v249, s[40:43], s7 offen offset:0 lds
    v_mfma_f32_16x16x32_bf16 v[24:27], a[44:47], a[104:107], v[24:27]
    ds_read_b64_tr_b16 a[14:15], v227 offset:17408
    s_waitcnt lgkmcnt(8)
    v_mfma_f32_16x16x32_bf16 v[32:35], a[48:51], a[104:107], v[32:35]
    ds_read_b64_tr_b16 a[16:17], v224 offset:24576
    buffer_load_dwordx4 v250, s[40:43], s7 offen offset:1024 lds
    v_mfma_f32_16x16x32_bf16 v[36:39], a[48:51], a[108:111], v[36:39]
    ds_read_b64_tr_b16 a[18:19], v224 offset:25600
    v_mfma_f32_16x16x32_bf16 v[44:47], a[52:55], a[108:111], v[44:47]
    ds_read_b64_tr_b16 a[20:21], v225 offset:24576
    s_add_u32 s33, s32, s54
    v_mfma_f32_16x16x32_bf16 v[40:43], a[52:55], a[104:107], v[40:43]
    ds_read_b64_tr_b16 a[22:23], v225 offset:25600
    v_mfma_f32_16x16x32_bf16 v[48:51], a[56:59], a[104:107], v[48:51]
    ds_read_b64_tr_b16 a[24:25], v226 offset:24576
    buffer_load_dwordx4 a[96:99], v241, s[8:11], s33 offen offset:0 sc1
    v_mfma_f32_16x16x32_bf16 v[52:55], a[56:59], a[108:111], v[52:55]
    ds_read_b64_tr_b16 a[26:27], v226 offset:25600
    v_mfma_f32_16x16x32_bf16 v[60:63], a[60:63], a[108:111], v[60:63]
    ds_read_b64_tr_b16 a[28:29], v227 offset:24576
    buffer_load_dwordx4 a[100:103], v241, s[8:11], s33 offen offset:1024 sc1
    v_mfma_f32_16x16x32_bf16 v[56:59], a[60:63], a[104:107], v[56:59]
    ds_read_b64_tr_b16 a[30:31], v227 offset:25600
    s_waitcnt vmcnt(22) lgkmcnt(8)
    v_mfma_f32_16x16x32_bf16 v[0:3], a[0:3], a[112:115], v[0:3]
    ds_read_b64_tr_b16 a[32:33], v224 offset:20480
    v_mfma_f32_16x16x32_bf16 v[4:7], a[0:3], a[116:119], v[4:7]
    ds_read_b64_tr_b16 a[34:35], v224 offset:21504
    v_mfma_f32_16x16x32_bf16 v[12:15], a[4:7], a[116:119], v[12:15]
    ds_read_b64_tr_b16 a[36:37], v225 offset:20480
    v_mfma_f32_16x16x32_bf16 v[8:11], a[4:7], a[112:115], v[8:11]
    ds_read_b64_tr_b16 a[38:39], v225 offset:21504
    v_mfma_f32_16x16x32_bf16 v[16:19], a[8:11], a[112:115], v[16:19]
    ds_read_b64_tr_b16 a[40:41], v226 offset:20480
    v_mfma_f32_16x16x32_bf16 v[20:23], a[8:11], a[116:119], v[20:23]
    ds_read_b64_tr_b16 a[42:43], v226 offset:21504
    v_mfma_f32_16x16x32_bf16 v[28:31], a[12:15], a[116:119], v[28:31]
    ds_read_b64_tr_b16 a[44:45], v227 offset:20480
    v_mfma_f32_16x16x32_bf16 v[24:27], a[12:15], a[112:115], v[24:27]
    ds_read_b64_tr_b16 a[46:47], v227 offset:21504
    buffer_load_dwordx4 a[104:107], v241, s[8:11], s33 offen offset:2048 sc1
    s_waitcnt lgkmcnt(8)
    v_mfma_f32_16x16x32_bf16 v[32:35], a[16:19], a[112:115], v[32:35]
    ds_read_b64_tr_b16 a[48:49], v224 offset:28672
    v_mfma_f32_16x16x32_bf16 v[36:39], a[16:19], a[116:119], v[36:39]
    ds_read_b64_tr_b16 a[50:51], v224 offset:29696
    v_mfma_f32_16x16x32_bf16 v[44:47], a[20:23], a[116:119], v[44:47]
    ds_read_b64_tr_b16 a[52:53], v225 offset:28672
    v_mfma_f32_16x16x32_bf16 v[40:43], a[20:23], a[112:115], v[40:43]
    ds_read_b64_tr_b16 a[54:55], v225 offset:29696
    v_mfma_f32_16x16x32_bf16 v[48:51], a[24:27], a[112:115], v[48:51]
    ds_read_b64_tr_b16 a[56:57], v226 offset:28672
    v_mfma_f32_16x16x32_bf16 v[52:55], a[24:27], a[116:119], v[52:55]
    ds_read_b64_tr_b16 a[58:59], v226 offset:29696
    v_mfma_f32_16x16x32_bf16 v[60:63], a[28:31], a[116:119], v[60:63]
    ds_read_b64_tr_b16 a[60:61], v227 offset:28672
    buffer_load_dwordx4 a[108:111], v241, s[8:11], s33 offen offset:3072 sc1
    v_mfma_f32_16x16x32_bf16 v[56:59], a[28:31], a[112:115], v[56:59]
    ds_read_b64_tr_b16 a[62:63], v227 offset:29696
    s_waitcnt vmcnt(20) lgkmcnt(8)
    s_barrier
    v_xor_b32 v224, 0x10000, v224
    v_xor_b32 v225, 0x10000, v225
    v_xor_b32 v226, 0x10000, v226
    v_xor_b32 v227, 0x10000, v227
    v_mfma_f32_16x16x32_bf16 v[0:3], a[32:35], a[120:123], v[0:3]
    v_mfma_f32_16x16x32_bf16 v[4:7], a[32:35], a[124:127], v[4:7]
    ds_read_b64_tr_b16 a[16:17], v224 offset:40960
    v_mfma_f32_16x16x32_bf16 v[12:15], a[36:39], a[124:127], v[12:15]
    s_add_u32 s7, s7, 917504
    v_mfma_f32_16x16x32_bf16 v[8:11], a[36:39], a[120:123], v[8:11]
    ds_read_b64_tr_b16 a[18:19], v224 offset:41984
    v_mfma_f32_16x16x32_bf16 v[16:19], a[40:43], a[120:123], v[16:19]
    s_add_u32 m0, s30, 0
    v_mfma_f32_16x16x32_bf16 v[20:23], a[40:43], a[124:127], v[20:23]
    ds_read_b64_tr_b16 a[20:21], v225 offset:40960
    v_mfma_f32_16x16x32_bf16 v[28:31], a[44:47], a[124:127], v[28:31]
    buffer_load_dwordx4 v249, s[40:43], s7 offen offset:0 lds
    v_mfma_f32_16x16x32_bf16 v[24:27], a[44:47], a[120:123], v[24:27]
    ds_read_b64_tr_b16 a[22:23], v225 offset:41984
    s_waitcnt lgkmcnt(4)
    v_mfma_f32_16x16x32_bf16 v[32:35], a[48:51], a[120:123], v[32:35]
    buffer_load_dwordx4 v250, s[40:43], s7 offen offset:1024 lds
    v_mfma_f32_16x16x32_bf16 v[36:39], a[48:51], a[124:127], v[36:39]
    ds_read_b64_tr_b16 a[24:25], v226 offset:40960
    v_mfma_f32_16x16x32_bf16 v[44:47], a[52:55], a[124:127], v[44:47]
    s_add_u32 s33, s32, s55
    v_mfma_f32_16x16x32_bf16 v[40:43], a[52:55], a[120:123], v[40:43]
    ds_read_b64_tr_b16 a[26:27], v226 offset:41984
    v_mfma_f32_16x16x32_bf16 v[48:51], a[56:59], a[120:123], v[48:51]
    buffer_load_dwordx4 a[112:115], v241, s[8:11], s33 offen offset:0 sc1
    v_mfma_f32_16x16x32_bf16 v[52:55], a[56:59], a[124:127], v[52:55]
    ds_read_b64_tr_b16 a[28:29], v227 offset:40960
    v_mfma_f32_16x16x32_bf16 v[60:63], a[60:63], a[124:127], v[60:63]
    buffer_load_dwordx4 a[116:119], v241, s[8:11], s33 offen offset:1024 sc1
    v_mfma_f32_16x16x32_bf16 v[56:59], a[60:63], a[120:123], v[56:59]
    ds_read_b64_tr_b16 a[30:31], v227 offset:41984
    s_waitcnt vmcnt(20) lgkmcnt(4)
    v_mfma_f32_16x16x32_bf16 v[32:35], a[16:19], a[64:67], v[32:35]
    ds_read_b64_tr_b16 a[48:49], v224 offset:45056
    v_mfma_f32_16x16x32_bf16 v[36:39], a[16:19], a[68:71], v[36:39]
    ds_read_b64_tr_b16 a[50:51], v224 offset:46080
    v_mfma_f32_16x16x32_bf16 v[44:47], a[20:23], a[68:71], v[44:47]
    ds_read_b64_tr_b16 a[52:53], v225 offset:45056
    buffer_load_dwordx4 a[120:123], v241, s[8:11], s33 offen offset:2048 sc1
    v_mfma_f32_16x16x32_bf16 v[40:43], a[20:23], a[64:67], v[40:43]
    ds_read_b64_tr_b16 a[54:55], v225 offset:46080
    s_waitcnt lgkmcnt(4)
    v_mfma_f32_16x16x32_bf16 v[48:51], a[24:27], a[64:67], v[48:51]
    ds_read_b64_tr_b16 a[56:57], v226 offset:45056
    buffer_load_dwordx4 a[124:127], v241, s[8:11], s33 offen offset:3072 sc1
    v_mfma_f32_16x16x32_bf16 v[52:55], a[24:27], a[68:71], v[52:55]
    ds_read_b64_tr_b16 a[58:59], v226 offset:46080
    v_mfma_f32_16x16x32_bf16 v[60:63], a[28:31], a[68:71], v[60:63]
    ds_read_b64_tr_b16 a[60:61], v227 offset:45056
    s_add_u32 s32, s32, 32768
    v_mfma_f32_16x16x32_bf16 v[56:59], a[28:31], a[64:67], v[56:59]
    ds_read_b64_tr_b16 a[62:63], v227 offset:46080
    s_waitcnt vmcnt(18) lgkmcnt(4)
    s_barrier
    v_mfma_f32_16x16x32_bf16 v[32:35], a[48:51], a[72:75], v[32:35]
    ds_read_b64_tr_b16 a[16:17], v224 offset:57344
    s_add_u32 s7, s7, 917504
    v_mfma_f32_16x16x32_bf16 v[36:39], a[48:51], a[76:79], v[36:39]
    ds_read_b64_tr_b16 a[18:19], v224 offset:58368
    s_add_u32 m0, s30, 16384
    v_mfma_f32_16x16x32_bf16 v[44:47], a[52:55], a[76:79], v[44:47]
    ds_read_b64_tr_b16 a[20:21], v225 offset:57344
    buffer_load_dwordx4 v249, s[40:43], s7 offen offset:0 lds
    v_mfma_f32_16x16x32_bf16 v[40:43], a[52:55], a[72:75], v[40:43]
    ds_read_b64_tr_b16 a[22:23], v225 offset:58368
    buffer_load_dwordx4 v250, s[40:43], s7 offen offset:1024 lds
    s_waitcnt lgkmcnt(4)
    v_mfma_f32_16x16x32_bf16 v[48:51], a[56:59], a[72:75], v[48:51]
    ds_read_b64_tr_b16 a[24:25], v226 offset:57344
    s_mov_b32 s33, s56
    v_mfma_f32_16x16x32_bf16 v[52:55], a[56:59], a[76:79], v[52:55]
    ds_read_b64_tr_b16 a[26:27], v226 offset:58368
    buffer_load_dwordx4 a[128:131], v241, s[8:11], s33 offen offset:0 sc1
    v_mfma_f32_16x16x32_bf16 v[60:63], a[60:63], a[76:79], v[60:63]
    ds_read_b64_tr_b16 a[28:29], v227 offset:57344
    buffer_load_dwordx4 a[132:135], v241, s[8:11], s33 offen offset:1024 sc1
    v_mfma_f32_16x16x32_bf16 v[56:59], a[60:63], a[72:75], v[56:59]
    ds_read_b64_tr_b16 a[30:31], v227 offset:58368
    s_waitcnt vmcnt(18) lgkmcnt(4)
    v_mfma_f32_16x16x32_bf16 v[32:35], a[16:19], a[80:83], v[32:35]
    ds_read_b64_tr_b16 a[48:49], v224 offset:61440
    v_mfma_f32_16x16x32_bf16 v[36:39], a[16:19], a[84:87], v[36:39]
    ds_read_b64_tr_b16 a[50:51], v224 offset:62464
    s_xor_b32 s30, s30, 0x10000
    v_mfma_f32_16x16x32_bf16 v[44:47], a[20:23], a[84:87], v[44:47]
    ds_read_b64_tr_b16 a[52:53], v225 offset:61440
    v_mfma_f32_16x16x32_bf16 v[40:43], a[20:23], a[80:83], v[40:43]
    ds_read_b64_tr_b16 a[54:55], v225 offset:62464
    s_add_u32 s6, s6, 32768
    s_waitcnt lgkmcnt(4)
    v_mfma_f32_16x16x32_bf16 v[48:51], a[24:27], a[80:83], v[48:51]
    ds_read_b64_tr_b16 a[56:57], v226 offset:61440
    v_mfma_f32_16x16x32_bf16 v[52:55], a[24:27], a[84:87], v[52:55]
    ds_read_b64_tr_b16 a[58:59], v226 offset:62464
    buffer_load_dwordx4 a[136:139], v241, s[8:11], s33 offen offset:2048 sc1
    v_mfma_f32_16x16x32_bf16 v[60:63], a[28:31], a[84:87], v[60:63]
    ds_read_b64_tr_b16 a[60:61], v227 offset:61440
    buffer_load_dwordx4 a[140:143], v241, s[8:11], s33 offen offset:3072 sc1
    v_mfma_f32_16x16x32_bf16 v[56:59], a[28:31], a[80:83], v[56:59]
    ds_read_b64_tr_b16 a[62:63], v227 offset:62464
    s_waitcnt vmcnt(18) lgkmcnt(4)
    s_barrier
    v_mfma_f32_16x16x32_bf16 v[32:35], a[48:51], a[88:91], v[32:35]
    ds_read_b64_tr_b16 a[16:17], v224 offset:8192
    v_mfma_f32_16x16x32_bf16 v[36:39], a[48:51], a[92:95], v[36:39]
    ds_read_b64_tr_b16 a[18:19], v224 offset:9216
    v_mfma_f32_16x16x32_bf16 v[44:47], a[52:55], a[92:95], v[44:47]
    ds_read_b64_tr_b16 a[20:21], v225 offset:8192
    s_add_u32 s33, s33, 4096
    v_mfma_f32_16x16x32_bf16 v[40:43], a[52:55], a[88:91], v[40:43]
    ds_read_b64_tr_b16 a[22:23], v225 offset:9216
    s_waitcnt lgkmcnt(4)
    v_mfma_f32_16x16x32_bf16 v[48:51], a[56:59], a[88:91], v[48:51]
    ds_read_b64_tr_b16 a[24:25], v226 offset:8192
    buffer_load_dwordx4 a[144:147], v241, s[8:11], s33 offen offset:0 sc1
    v_mfma_f32_16x16x32_bf16 v[52:55], a[56:59], a[92:95], v[52:55]
    ds_read_b64_tr_b16 a[26:27], v226 offset:9216
    v_mfma_f32_16x16x32_bf16 v[60:63], a[60:63], a[92:95], v[60:63]
    ds_read_b64_tr_b16 a[28:29], v227 offset:8192
    buffer_load_dwordx4 a[148:151], v241, s[8:11], s33 offen offset:1024 sc1
    v_mfma_f32_16x16x32_bf16 v[56:59], a[60:63], a[88:91], v[56:59]
    ds_read_b64_tr_b16 a[30:31], v227 offset:9216
    s_waitcnt vmcnt(16) lgkmcnt(4)
    v_mfma_f32_16x16x32_bf16 v[32:35], a[16:19], a[96:99], v[32:35]
    ds_read_b64_tr_b16 a[48:49], v224 offset:12288
    v_mfma_f32_16x16x32_bf16 v[36:39], a[16:19], a[100:103], v[36:39]
    ds_read_b64_tr_b16 a[50:51], v224 offset:13312
    v_mfma_f32_16x16x32_bf16 v[44:47], a[20:23], a[100:103], v[44:47]
    ds_read_b64_tr_b16 a[52:53], v225 offset:12288
    v_mfma_f32_16x16x32_bf16 v[40:43], a[20:23], a[96:99], v[40:43]
    ds_read_b64_tr_b16 a[54:55], v225 offset:13312
    buffer_load_dwordx4 a[152:155], v241, s[8:11], s33 offen offset:2048 sc1
    s_waitcnt lgkmcnt(4)
    v_mfma_f32_16x16x32_bf16 v[48:51], a[24:27], a[96:99], v[48:51]
    ds_read_b64_tr_b16 a[56:57], v226 offset:12288
    v_mfma_f32_16x16x32_bf16 v[52:55], a[24:27], a[100:103], v[52:55]
    ds_read_b64_tr_b16 a[58:59], v226 offset:13312
    v_mfma_f32_16x16x32_bf16 v[60:63], a[28:31], a[100:103], v[60:63]
    ds_read_b64_tr_b16 a[60:61], v227 offset:12288
    buffer_load_dwordx4 a[156:159], v241, s[8:11], s33 offen offset:3072 sc1
    v_mfma_f32_16x16x32_bf16 v[56:59], a[28:31], a[96:99], v[56:59]
    ds_read_b64_tr_b16 a[62:63], v227 offset:13312
    s_waitcnt vmcnt(16) lgkmcnt(4)
    s_barrier
    v_mfma_f32_16x16x32_bf16 v[32:35], a[48:51], a[104:107], v[32:35]
    ds_read_b64_tr_b16 a[16:17], v224 offset:24576
    v_mfma_f32_16x16x32_bf16 v[36:39], a[48:51], a[108:111], v[36:39]
    ds_read_b64_tr_b16 a[18:19], v224 offset:25600
    v_mfma_f32_16x16x32_bf16 v[44:47], a[52:55], a[108:111], v[44:47]
    ds_read_b64_tr_b16 a[20:21], v225 offset:24576
    s_add_u32 s33, s33, 4096
    v_mfma_f32_16x16x32_bf16 v[40:43], a[52:55], a[104:107], v[40:43]
    ds_read_b64_tr_b16 a[22:23], v225 offset:25600
    s_waitcnt lgkmcnt(4)
    v_mfma_f32_16x16x32_bf16 v[48:51], a[56:59], a[104:107], v[48:51]
    ds_read_b64_tr_b16 a[24:25], v226 offset:24576
    buffer_load_dwordx4 a[160:163], v241, s[8:11], s33 offen offset:0 sc1
    v_mfma_f32_16x16x32_bf16 v[52:55], a[56:59], a[108:111], v[52:55]
    ds_read_b64_tr_b16 a[26:27], v226 offset:25600
    v_mfma_f32_16x16x32_bf16 v[60:63], a[60:63], a[108:111], v[60:63]
    ds_read_b64_tr_b16 a[28:29], v227 offset:24576
    buffer_load_dwordx4 a[164:167], v241, s[8:11], s33 offen offset:1024 sc1
    v_mfma_f32_16x16x32_bf16 v[56:59], a[60:63], a[104:107], v[56:59]
    ds_read_b64_tr_b16 a[30:31], v227 offset:25600
    s_waitcnt vmcnt(14) lgkmcnt(4)
    v_mfma_f32_16x16x32_bf16 v[32:35], a[16:19], a[112:115], v[32:35]
    ds_read_b64_tr_b16 a[48:49], v224 offset:28672
    v_mfma_f32_16x16x32_bf16 v[36:39], a[16:19], a[116:119], v[36:39]
    ds_read_b64_tr_b16 a[50:51], v224 offset:29696
    v_mfma_f32_16x16x32_bf16 v[44:47], a[20:23], a[116:119], v[44:47]
    ds_read_b64_tr_b16 a[52:53], v225 offset:28672
    v_mfma_f32_16x16x32_bf16 v[40:43], a[20:23], a[112:115], v[40:43]
    ds_read_b64_tr_b16 a[54:55], v225 offset:29696
    buffer_load_dwordx4 a[168:171], v241, s[8:11], s33 offen offset:2048 sc1
    s_waitcnt lgkmcnt(4)
    v_mfma_f32_16x16x32_bf16 v[48:51], a[24:27], a[112:115], v[48:51]
    ds_read_b64_tr_b16 a[56:57], v226 offset:28672
    v_mfma_f32_16x16x32_bf16 v[52:55], a[24:27], a[116:119], v[52:55]
    ds_read_b64_tr_b16 a[58:59], v226 offset:29696
    v_mfma_f32_16x16x32_bf16 v[60:63], a[28:31], a[116:119], v[60:63]
    ds_read_b64_tr_b16 a[60:61], v227 offset:28672
    buffer_load_dwordx4 a[172:175], v241, s[8:11], s33 offen offset:3072 sc1
    v_mfma_f32_16x16x32_bf16 v[56:59], a[28:31], a[112:115], v[56:59]
    ds_read_b64_tr_b16 a[62:63], v227 offset:29696
    s_waitcnt vmcnt(14) lgkmcnt(4)
    s_barrier
    v_mfma_f32_16x16x32_bf16 v[32:35], a[48:51], a[120:123], v[32:35]
    ds_read_b64_tr_b16 a[0:1], v224 offset:32768
    v_mfma_f32_16x16x32_bf16 v[36:39], a[48:51], a[124:127], v[36:39]
    ds_read_b64_tr_b16 a[2:3], v224 offset:33792
    v_mfma_f32_16x16x32_bf16 v[44:47], a[52:55], a[124:127], v[44:47]
    ds_read_b64_tr_b16 a[4:5], v225 offset:32768
    s_add_u32 s33, s33, 4096
    v_mfma_f32_16x16x32_bf16 v[40:43], a[52:55], a[120:123], v[40:43]
    ds_read_b64_tr_b16 a[6:7], v225 offset:33792
    s_waitcnt lgkmcnt(4)
    v_mfma_f32_16x16x32_bf16 v[48:51], a[56:59], a[120:123], v[48:51]
    ds_read_b64_tr_b16 a[8:9], v226 offset:32768
    buffer_load_dwordx4 a[176:179], v241, s[8:11], s33 offen offset:0 sc1
    v_mfma_f32_16x16x32_bf16 v[52:55], a[56:59], a[124:127], v[52:55]
    ds_read_b64_tr_b16 a[10:11], v226 offset:33792
    v_mfma_f32_16x16x32_bf16 v[60:63], a[60:63], a[124:127], v[60:63]
    ds_read_b64_tr_b16 a[12:13], v227 offset:32768
    buffer_load_dwordx4 a[180:183], v241, s[8:11], s33 offen offset:1024 sc1
    v_mfma_f32_16x16x32_bf16 v[56:59], a[60:63], a[120:123], v[56:59]
    ds_read_b64_tr_b16 a[14:15], v227 offset:33792
    s_waitcnt vmcnt(38) lgkmcnt(4)
    v_mfma_f32_16x16x32_bf16 v[0:3], a[0:3], a[64:67], v[0:3]
    ds_read_b64_tr_b16 a[32:33], v224 offset:36864
    v_mfma_f32_16x16x32_bf16 v[4:7], a[0:3], a[68:71], v[4:7]
    ds_read_b64_tr_b16 a[34:35], v224 offset:37888
    v_mfma_f32_16x16x32_bf16 v[12:15], a[4:7], a[68:71], v[12:15]
    ds_read_b64_tr_b16 a[36:37], v225 offset:36864
    v_mfma_f32_16x16x32_bf16 v[8:11], a[4:7], a[64:67], v[8:11]
    ds_read_b64_tr_b16 a[38:39], v225 offset:37888
    v_cvt_pk_bf16_f32 v136, v32, v33
    s_waitcnt lgkmcnt(4)
    v_mfma_f32_16x16x32_bf16 v[16:19], a[8:11], a[64:67], v[16:19]
    ds_read_b64_tr_b16 a[40:41], v226 offset:36864
    v_cvt_pk_bf16_f32 v137, v34, v35
    v_cvt_pk_bf16_f32 v138, v36, v37
    v_mfma_f32_16x16x32_bf16 v[20:23], a[8:11], a[68:71], v[20:23]
    ds_read_b64_tr_b16 a[42:43], v226 offset:37888
    v_mov_b32 v139, v247
    buffer_load_dwordx4 a[184:187], v241, s[8:11], s33 offen offset:2048 sc1
    v_mfma_f32_16x16x32_bf16 v[28:31], a[12:15], a[68:71], v[28:31]
    ds_read_b64_tr_b16 a[44:45], v227 offset:36864
    buffer_load_dwordx4 a[188:191], v241, s[8:11], s33 offen offset:3072 sc1
    buffer_store_dwordx4 v[136:139], v241, s[8:11], s23 offen offset:0 sc1
    v_mfma_f32_16x16x32_bf16 v[24:27], a[12:15], a[64:67], v[24:27]
    ds_read_b64_tr_b16 a[46:47], v227 offset:37888
    s_waitcnt vmcnt(37) lgkmcnt(4)
    s_barrier
    v_mfma_f32_16x16x32_bf16 v[0:3], a[32:35], a[72:75], v[0:3]
    ds_read_b64_tr_b16 a[0:1], v224 offset:49152
    v_cvt_pk_bf16_f32 v140, v38, v39
    v_mfma_f32_16x16x32_bf16 v[4:7], a[32:35], a[76:79], v[4:7]
    ds_read_b64_tr_b16 a[2:3], v224 offset:50176
    v_cvt_pk_bf16_f32 v141, v40, v41
    v_mfma_f32_16x16x32_bf16 v[12:15], a[36:39], a[76:79], v[12:15]
    ds_read_b64_tr_b16 a[4:5], v225 offset:49152
    v_cvt_pk_bf16_f32 v142, v42, v43
    v_mfma_f32_16x16x32_bf16 v[8:11], a[36:39], a[72:75], v[8:11]
    ds_read_b64_tr_b16 a[6:7], v225 offset:50176
    v_mov_b32 v143, v247
    s_waitcnt lgkmcnt(4)
    v_mfma_f32_16x16x32_bf16 v[16:19], a[40:43], a[72:75], v[16:19]
    ds_read_b64_tr_b16 a[8:9], v226 offset:49152
    s_add_u32 s33, s33, 4096
    v_mfma_f32_16x16x32_bf16 v[20:23], a[40:43], a[76:79], v[20:23]
    ds_read_b64_tr_b16 a[10:11], v226 offset:50176
    buffer_load_dwordx4 a[64:67], v241, s[8:11], s33 offen offset:0 sc1
    v_mfma_f32_16x16x32_bf16 v[28:31], a[44:47], a[76:79], v[28:31]
    ds_read_b64_tr_b16 a[12:13], v227 offset:49152
    buffer_load_dwordx4 a[68:71], v241, s[8:11], s33 offen offset:1024 sc1
    buffer_store_dwordx4 v[140:143], v241, s[8:11], s23 offen offset:1024 sc1
    v_mfma_f32_16x16x32_bf16 v[24:27], a[44:47], a[72:75], v[24:27]
    ds_read_b64_tr_b16 a[14:15], v227 offset:50176
    s_waitcnt vmcnt(36) lgkmcnt(4)
    v_mfma_f32_16x16x32_bf16 v[0:3], a[0:3], a[80:83], v[0:3]
    ds_read_b64_tr_b16 a[32:33], v224 offset:53248
    v_mfma_f32_16x16x32_bf16 v[4:7], a[0:3], a[84:87], v[4:7]
    ds_read_b64_tr_b16 a[34:35], v224 offset:54272
    v_mfma_f32_16x16x32_bf16 v[12:15], a[4:7], a[84:87], v[12:15]
    ds_read_b64_tr_b16 a[36:37], v225 offset:53248
    v_mfma_f32_16x16x32_bf16 v[8:11], a[4:7], a[80:83], v[8:11]
    ds_read_b64_tr_b16 a[38:39], v225 offset:54272
    buffer_load_dwordx4 a[72:75], v241, s[8:11], s33 offen offset:2048 sc1
    s_waitcnt lgkmcnt(4)
    v_mfma_f32_16x16x32_bf16 v[16:19], a[8:11], a[80:83], v[16:19]
    ds_read_b64_tr_b16 a[40:41], v226 offset:53248
    v_mfma_f32_16x16x32_bf16 v[20:23], a[8:11], a[84:87], v[20:23]
    ds_read_b64_tr_b16 a[42:43], v226 offset:54272
    v_mfma_f32_16x16x32_bf16 v[28:31], a[12:15], a[84:87], v[28:31]
    ds_read_b64_tr_b16 a[44:45], v227 offset:53248
    buffer_load_dwordx4 a[76:79], v241, s[8:11], s33 offen offset:3072 sc1
    v_mfma_f32_16x16x32_bf16 v[24:27], a[12:15], a[80:83], v[24:27]
    ds_read_b64_tr_b16 a[46:47], v227 offset:54272
    s_waitcnt vmcnt(36) lgkmcnt(4)
    s_barrier
    v_mfma_f32_16x16x32_bf16 v[0:3], a[32:35], a[88:91], v[0:3]
    ds_read_b64_tr_b16 a[0:1], v224 offset:0
    v_cvt_pk_bf16_f32 v144, v44, v45
    v_mfma_f32_16x16x32_bf16 v[4:7], a[32:35], a[92:95], v[4:7]
    ds_read_b64_tr_b16 a[2:3], v224 offset:1024
    v_cvt_pk_bf16_f32 v145, v46, v47
    v_cvt_pk_bf16_f32 v146, v48, v49
    v_mfma_f32_16x16x32_bf16 v[12:15], a[36:39], a[92:95], v[12:15]
    ds_read_b64_tr_b16 a[4:5], v225 offset:0
    v_mov_b32 v147, v247
    s_add_u32 s7, s7, 917504
    v_mfma_f32_16x16x32_bf16 v[8:11], a[36:39], a[88:91], v[8:11]
    ds_read_b64_tr_b16 a[6:7], v225 offset:1024
    s_add_u32 m0, s30, 32768
    s_waitcnt lgkmcnt(4)
    v_mfma_f32_16x16x32_bf16 v[16:19], a[40:43], a[88:91], v[16:19]
    ds_read_b64_tr_b16 a[8:9], v226 offset:0
    buffer_load_dwordx4 v249, s[40:43], s7 offen offset:0 lds
    buffer_load_dwordx4 v250, s[40:43], s7 offen offset:1024 lds
    v_mfma_f32_16x16x32_bf16 v[20:23], a[40:43], a[92:95], v[20:23]
    ds_read_b64_tr_b16 a[10:11], v226 offset:1024
    s_add_u32 s33, s33, 4096
    buffer_load_dwordx4 a[80:83], v241, s[8:11], s33 offen offset:0 sc1
    v_mfma_f32_16x16x32_bf16 v[28:31], a[44:47], a[92:95], v[28:31]
    ds_read_b64_tr_b16 a[12:13], v227 offset:0
    buffer_load_dwordx4 a[84:87], v241, s[8:11], s33 offen offset:1024 sc1
    buffer_store_dwordx4 v[144:147], v241, s[8:11], s23 offen offset:2048 sc1
    v_mfma_f32_16x16x32_bf16 v[24:27], a[44:47], a[88:91], v[24:27]
    ds_read_b64_tr_b16 a[14:15], v227 offset:1024
    s_waitcnt vmcnt(37) lgkmcnt(4)
    v_mfma_f32_16x16x32_bf16 v[0:3], a[0:3], a[96:99], v[0:3]
    ds_read_b64_tr_b16 a[32:33], v224 offset:4096
    v_cvt_pk_bf16_f32 v148, v50, v51
    v_mfma_f32_16x16x32_bf16 v[4:7], a[0:3], a[100:103], v[4:7]
    ds_read_b64_tr_b16 a[34:35], v224 offset:5120
    v_cvt_pk_bf16_f32 v149, v52, v53
    v_mfma_f32_16x16x32_bf16 v[12:15], a[4:7], a[100:103], v[12:15]
    ds_read_b64_tr_b16 a[36:37], v225 offset:4096
    v_cvt_pk_bf16_f32 v150, v54, v55
    v_mfma_f32_16x16x32_bf16 v[8:11], a[4:7], a[96:99], v[8:11]
    ds_read_b64_tr_b16 a[38:39], v225 offset:5120
    v_mov_b32 v151, v247
    s_waitcnt lgkmcnt(4)
    v_mfma_f32_16x16x32_bf16 v[16:19], a[8:11], a[96:99], v[16:19]
    ds_read_b64_tr_b16 a[40:41], v226 offset:4096
    buffer_load_dwordx4 a[88:91], v241, s[8:11], s33 offen offset:2048 sc1
    v_mfma_f32_16x16x32_bf16 v[20:23], a[8:11], a[100:103], v[20:23]
    ds_read_b64_tr_b16 a[42:43], v226 offset:5120
    buffer_load_dwordx4 a[92:95], v241, s[8:11], s33 offen offset:3072 sc1
    v_mfma_f32_16x16x32_bf16 v[28:31], a[12:15], a[100:103], v[28:31]
    ds_read_b64_tr_b16 a[44:45], v227 offset:4096
    buffer_store_dwordx4 v[148:151], v241, s[8:11], s23 offen offset:3072 sc1
    v_mfma_f32_16x16x32_bf16 v[24:27], a[12:15], a[96:99], v[24:27]
    ds_read_b64_tr_b16 a[46:47], v227 offset:5120
    s_waitcnt vmcnt(38) lgkmcnt(4)
    s_barrier
    v_mfma_f32_16x16x32_bf16 v[0:3], a[32:35], a[104:107], v[0:3]
    ds_read_b64_tr_b16 a[0:1], v224 offset:16384
    s_add_u32 s7, s7, 917504
    v_mfma_f32_16x16x32_bf16 v[4:7], a[32:35], a[108:111], v[4:7]
    ds_read_b64_tr_b16 a[2:3], v224 offset:17408
    s_add_u32 m0, s30, 49152
    v_mfma_f32_16x16x32_bf16 v[12:15], a[36:39], a[108:111], v[12:15]
    ds_read_b64_tr_b16 a[4:5], v225 offset:16384
    buffer_load_dwordx4 v249, s[40:43], s7 offen offset:0 lds
    v_mfma_f32_16x16x32_bf16 v[8:11], a[36:39], a[104:107], v[8:11]
    ds_read_b64_tr_b16 a[6:7], v225 offset:17408
    buffer_load_dwordx4 v250, s[40:43], s7 offen offset:1024 lds
    s_waitcnt lgkmcnt(4)
    v_mfma_f32_16x16x32_bf16 v[16:19], a[40:43], a[104:107], v[16:19]
    ds_read_b64_tr_b16 a[8:9], v226 offset:16384
    s_add_u32 s33, s33, 4096
    v_mfma_f32_16x16x32_bf16 v[20:23], a[40:43], a[108:111], v[20:23]
    ds_read_b64_tr_b16 a[10:11], v226 offset:17408
    buffer_load_dwordx4 a[96:99], v241, s[8:11], s33 offen offset:0 sc1
    v_mfma_f32_16x16x32_bf16 v[28:31], a[44:47], a[108:111], v[28:31]
    ds_read_b64_tr_b16 a[12:13], v227 offset:16384
    buffer_load_dwordx4 a[100:103], v241, s[8:11], s33 offen offset:1024 sc1
    v_mfma_f32_16x16x32_bf16 v[24:27], a[44:47], a[104:107], v[24:27]
    ds_read_b64_tr_b16 a[14:15], v227 offset:17408
    s_waitcnt vmcnt(38) lgkmcnt(4)
    v_mfma_f32_16x16x32_bf16 v[0:3], a[0:3], a[112:115], v[0:3]
    ds_read_b64_tr_b16 a[32:33], v224 offset:20480
    v_cvt_pk_bf16_f32 v152, v56, v57
    v_mfma_f32_16x16x32_bf16 v[4:7], a[0:3], a[116:119], v[4:7]
    ds_read_b64_tr_b16 a[34:35], v224 offset:21504
    v_cvt_pk_bf16_f32 v153, v58, v59
    v_mfma_f32_16x16x32_bf16 v[12:15], a[4:7], a[116:119], v[12:15]
    ds_read_b64_tr_b16 a[36:37], v225 offset:20480
    v_cvt_pk_bf16_f32 v154, v60, v61
    v_mfma_f32_16x16x32_bf16 v[8:11], a[4:7], a[112:115], v[8:11]
    ds_read_b64_tr_b16 a[38:39], v225 offset:21504
    v_mov_b32 v155, v247
    s_waitcnt lgkmcnt(4)
    v_mfma_f32_16x16x32_bf16 v[16:19], a[8:11], a[112:115], v[16:19]
    ds_read_b64_tr_b16 a[40:41], v226 offset:20480
    buffer_load_dwordx4 a[104:107], v241, s[8:11], s33 offen offset:2048 sc1
    v_mfma_f32_16x16x32_bf16 v[20:23], a[8:11], a[116:119], v[20:23]
    ds_read_b64_tr_b16 a[42:43], v226 offset:21504
    buffer_load_dwordx4 a[108:111], v241, s[8:11], s33 offen offset:3072 sc1
    v_mfma_f32_16x16x32_bf16 v[28:31], a[12:15], a[116:119], v[28:31]
    ds_read_b64_tr_b16 a[44:45], v227 offset:20480
    buffer_store_dwordx4 v[152:155], v242, s[8:11], s23 offen offset:0 sc1
    v_mfma_f32_16x16x32_bf16 v[24:27], a[12:15], a[112:115], v[24:27]
    ds_read_b64_tr_b16 a[46:47], v227 offset:21504
    s_waitcnt vmcnt(39) lgkmcnt(4)
    s_barrier
    v_xor_b32 v224, 0x10000, v224
    v_xor_b32 v225, 0x10000, v225
    v_xor_b32 v226, 0x10000, v226
    v_xor_b32 v227, 0x10000, v227
    v_mfma_f32_16x16x32_bf16 v[0:3], a[32:35], a[120:123], v[0:3]
    ds_read_b64_tr_b16 a[0:1], v224 offset:32768
    v_cvt_pk_bf16_f32 v156, v62, v63
    v_mfma_f32_16x16x32_bf16 v[4:7], a[32:35], a[124:127], v[4:7]
    ds_read_b64_tr_b16 a[2:3], v224 offset:33792
    v_mov_b32 v159, v247
    v_mfma_f32_16x16x32_bf16 v[12:15], a[36:39], a[124:127], v[12:15]
    ds_read_b64_tr_b16 a[4:5], v225 offset:32768
    s_add_u32 s7, s7, 917504
    s_add_u32 m0, s30, 0
    v_mfma_f32_16x16x32_bf16 v[8:11], a[36:39], a[120:123], v[8:11]
    ds_read_b64_tr_b16 a[6:7], v225 offset:33792
    buffer_load_dwordx4 v249, s[40:43], s7 offen offset:0 lds
    s_waitcnt lgkmcnt(4)
    v_mfma_f32_16x16x32_bf16 v[16:19], a[40:43], a[120:123], v[16:19]
    ds_read_b64_tr_b16 a[8:9], v226 offset:32768
    buffer_load_dwordx4 v250, s[40:43], s7 offen offset:1024 lds
    s_add_u32 s33, s33, 4096
    v_mfma_f32_16x16x32_bf16 v[20:23], a[40:43], a[124:127], v[20:23]
    ds_read_b64_tr_b16 a[10:11], v226 offset:33792
    buffer_load_dwordx4 a[112:115], v241, s[8:11], s33 offen offset:0 sc1
    v_mfma_f32_16x16x32_bf16 v[28:31], a[44:47], a[124:127], v[28:31]
    ds_read_b64_tr_b16 a[12:13], v227 offset:32768
    buffer_load_dwordx4 a[116:119], v241, s[8:11], s33 offen offset:1024 sc1
    buffer_store_dwordx4 v[156:159], v242, s[8:11], s23 offen offset:1024 sc1
    v_mfma_f32_16x16x32_bf16 v[24:27], a[44:47], a[120:123], v[24:27]
    ds_read_b64_tr_b16 a[14:15], v227 offset:33792
    s_waitcnt vmcnt(40) lgkmcnt(4)
    v_mfma_f32_16x16x32_bf16 v[0:3], a[0:3], a[128:131], v[0:3]
    ds_read_b64_tr_b16 a[32:33], v224 offset:36864
    v_mfma_f32_16x16x32_bf16 v[4:7], a[0:3], a[132:135], v[4:7]
    ds_read_b64_tr_b16 a[34:35], v224 offset:37888
    v_mfma_f32_16x16x32_bf16 v[12:15], a[4:7], a[132:135], v[12:15]
    ds_read_b64_tr_b16 a[36:37], v225 offset:36864
    v_mfma_f32_16x16x32_bf16 v[8:11], a[4:7], a[128:131], v[8:11]
    ds_read_b64_tr_b16 a[38:39], v225 offset:37888
    buffer_load_dwordx4 a[120:123], v241, s[8:11], s33 offen offset:2048 sc1
    s_waitcnt lgkmcnt(4)
    v_mfma_f32_16x16x32_bf16 v[16:19], a[8:11], a[128:131], v[16:19]
    ds_read_b64_tr_b16 a[40:41], v226 offset:36864
    v_mfma_f32_16x16x32_bf16 v[20:23], a[8:11], a[132:135], v[20:23]
    ds_read_b64_tr_b16 a[42:43], v226 offset:37888
    v_mfma_f32_16x16x32_bf16 v[28:31], a[12:15], a[132:135], v[28:31]
    ds_read_b64_tr_b16 a[44:45], v227 offset:36864
    buffer_load_dwordx4 a[124:127], v241, s[8:11], s33 offen offset:3072 sc1
    v_mfma_f32_16x16x32_bf16 v[24:27], a[12:15], a[128:131], v[24:27]
    ds_read_b64_tr_b16 a[46:47], v227 offset:37888
    s_waitcnt vmcnt(40) lgkmcnt(4)
    s_barrier
    v_mfma_f32_16x16x32_bf16 v[0:3], a[32:35], a[136:139], v[0:3]
    ds_read_b64_tr_b16 a[0:1], v224 offset:49152
    v_mfma_f32_16x16x32_bf16 v[4:7], a[32:35], a[140:143], v[4:7]
    ds_read_b64_tr_b16 a[2:3], v224 offset:50176
    s_add_u32 s7, s7, 917504
    v_mfma_f32_16x16x32_bf16 v[12:15], a[36:39], a[140:143], v[12:15]
    ds_read_b64_tr_b16 a[4:5], v225 offset:49152
    v_mfma_f32_16x16x32_bf16 v[8:11], a[36:39], a[136:139], v[8:11]
    ds_read_b64_tr_b16 a[6:7], v225 offset:50176
    s_add_u32 m0, s30, 16384
    s_waitcnt lgkmcnt(4)
    v_mfma_f32_16x16x32_bf16 v[16:19], a[40:43], a[136:139], v[16:19]
    ds_read_b64_tr_b16 a[8:9], v226 offset:49152
    v_mfma_f32_16x16x32_bf16 v[20:23], a[40:43], a[140:143], v[20:23]
    ds_read_b64_tr_b16 a[10:11], v226 offset:50176
    buffer_load_dwordx4 v249, s[40:43], s7 offen offset:0 lds
    v_mfma_f32_16x16x32_bf16 v[28:31], a[44:47], a[140:143], v[28:31]
    ds_read_b64_tr_b16 a[12:13], v227 offset:49152
    buffer_load_dwordx4 v250, s[40:43], s7 offen offset:1024 lds
    v_mfma_f32_16x16x32_bf16 v[24:27], a[44:47], a[136:139], v[24:27]
    ds_read_b64_tr_b16 a[14:15], v227 offset:50176
    s_waitcnt vmcnt(40) lgkmcnt(4)
    v_mfma_f32_16x16x32_bf16 v[0:3], a[0:3], a[144:147], v[0:3]
    ds_read_b64_tr_b16 a[32:33], v224 offset:53248
    v_mfma_f32_16x16x32_bf16 v[4:7], a[0:3], a[148:151], v[4:7]
    ds_read_b64_tr_b16 a[34:35], v224 offset:54272
    v_mfma_f32_16x16x32_bf16 v[12:15], a[4:7], a[148:151], v[12:15]
    ds_read_b64_tr_b16 a[36:37], v225 offset:53248
    v_mfma_f32_16x16x32_bf16 v[8:11], a[4:7], a[144:147], v[8:11]
    ds_read_b64_tr_b16 a[38:39], v225 offset:54272
    s_xor_b32 s30, s30, 0x10000
    s_waitcnt lgkmcnt(4)
    v_mfma_f32_16x16x32_bf16 v[16:19], a[8:11], a[144:147], v[16:19]
    ds_read_b64_tr_b16 a[40:41], v226 offset:53248
    v_mfma_f32_16x16x32_bf16 v[20:23], a[8:11], a[148:151], v[20:23]
    ds_read_b64_tr_b16 a[42:43], v226 offset:54272
    v_mfma_f32_16x16x32_bf16 v[28:31], a[12:15], a[148:151], v[28:31]
    ds_read_b64_tr_b16 a[44:45], v227 offset:53248
    s_add_u32 s6, s6, 32768
    v_mfma_f32_16x16x32_bf16 v[24:27], a[12:15], a[144:147], v[24:27]
    ds_read_b64_tr_b16 a[46:47], v227 offset:54272
    s_waitcnt vmcnt(38) lgkmcnt(4)
    s_barrier
    v_mfma_f32_16x16x32_bf16 v[0:3], a[32:35], a[152:155], v[0:3]
    ds_read_b64_tr_b16 a[0:1], v224 offset:0
    v_mfma_f32_16x16x32_bf16 v[4:7], a[32:35], a[156:159], v[4:7]
    ds_read_b64_tr_b16 a[2:3], v224 offset:1024
    v_mfma_f32_16x16x32_bf16 v[12:15], a[36:39], a[156:159], v[12:15]
    ds_read_b64_tr_b16 a[4:5], v225 offset:0
    v_mfma_f32_16x16x32_bf16 v[8:11], a[36:39], a[152:155], v[8:11]
    ds_read_b64_tr_b16 a[6:7], v225 offset:1024
    s_waitcnt lgkmcnt(4)
    v_mfma_f32_16x16x32_bf16 v[16:19], a[40:43], a[152:155], v[16:19]
    ds_read_b64_tr_b16 a[8:9], v226 offset:0
    v_mfma_f32_16x16x32_bf16 v[20:23], a[40:43], a[156:159], v[20:23]
    ds_read_b64_tr_b16 a[10:11], v226 offset:1024
    v_mfma_f32_16x16x32_bf16 v[28:31], a[44:47], a[156:159], v[28:31]
    ds_read_b64_tr_b16 a[12:13], v227 offset:0
    v_mfma_f32_16x16x32_bf16 v[24:27], a[44:47], a[152:155], v[24:27]
    ds_read_b64_tr_b16 a[14:15], v227 offset:1024
    s_waitcnt vmcnt(36) lgkmcnt(4)
    v_mfma_f32_16x16x32_bf16 v[0:3], a[0:3], a[160:163], v[0:3]
    ds_read_b64_tr_b16 a[32:33], v224 offset:4096
    v_mfma_f32_16x16x32_bf16 v[4:7], a[0:3], a[164:167], v[4:7]
    ds_read_b64_tr_b16 a[34:35], v224 offset:5120
    buffer_load_dword v112, v135, s[8:11], s22 offen offset:0 sc1
    v_mfma_f32_16x16x32_bf16 v[12:15], a[4:7], a[164:167], v[12:15]
    ds_read_b64_tr_b16 a[36:37], v225 offset:4096
    v_mfma_f32_16x16x32_bf16 v[8:11], a[4:7], a[160:163], v[8:11]
    ds_read_b64_tr_b16 a[38:39], v225 offset:5120
    buffer_load_dword v113, v135, s[8:11], s22 offen offset:128 sc1
    s_waitcnt lgkmcnt(4)
    v_mfma_f32_16x16x32_bf16 v[16:19], a[8:11], a[160:163], v[16:19]
    ds_read_b64_tr_b16 a[40:41], v226 offset:4096
    v_mfma_f32_16x16x32_bf16 v[20:23], a[8:11], a[164:167], v[20:23]
    ds_read_b64_tr_b16 a[42:43], v226 offset:5120
    buffer_load_dword v114, v135, s[8:11], s22 offen offset:256 sc1
    v_mfma_f32_16x16x32_bf16 v[28:31], a[12:15], a[164:167], v[28:31]
    ds_read_b64_tr_b16 a[44:45], v227 offset:4096
    buffer_load_dword v115, v135, s[8:11], s22 offen offset:384 sc1
    v_mfma_f32_16x16x32_bf16 v[24:27], a[12:15], a[160:163], v[24:27]
    ds_read_b64_tr_b16 a[46:47], v227 offset:5120
    s_waitcnt vmcnt(38) lgkmcnt(4)
    s_barrier
    v_mfma_f32_16x16x32_bf16 v[0:3], a[32:35], a[168:171], v[0:3]
    ds_read_b64_tr_b16 a[0:1], v224 offset:16384
    v_mfma_f32_16x16x32_bf16 v[4:7], a[32:35], a[172:175], v[4:7]
    ds_read_b64_tr_b16 a[2:3], v224 offset:17408
    buffer_load_dword v116, v135, s[8:11], s22 offen offset:64 sc1
    v_mfma_f32_16x16x32_bf16 v[12:15], a[36:39], a[172:175], v[12:15]
    ds_read_b64_tr_b16 a[4:5], v225 offset:16384
    v_mfma_f32_16x16x32_bf16 v[8:11], a[36:39], a[168:171], v[8:11]
    ds_read_b64_tr_b16 a[6:7], v225 offset:17408
    buffer_load_dword v117, v135, s[8:11], s22 offen offset:192 sc1
    s_waitcnt lgkmcnt(4)
    v_mfma_f32_16x16x32_bf16 v[16:19], a[40:43], a[168:171], v[16:19]
    ds_read_b64_tr_b16 a[8:9], v226 offset:16384
    v_mfma_f32_16x16x32_bf16 v[20:23], a[40:43], a[172:175], v[20:23]
    ds_read_b64_tr_b16 a[10:11], v226 offset:17408
    buffer_load_dword v118, v135, s[8:11], s22 offen offset:320 sc1
    v_mfma_f32_16x16x32_bf16 v[28:31], a[44:47], a[172:175], v[28:31]
    ds_read_b64_tr_b16 a[12:13], v227 offset:16384
    buffer_load_dword v119, v135, s[8:11], s22 offen offset:448 sc1
    v_mfma_f32_16x16x32_bf16 v[24:27], a[44:47], a[168:171], v[24:27]
    ds_read_b64_tr_b16 a[14:15], v227 offset:17408
    s_waitcnt vmcnt(40) lgkmcnt(4)
    v_mfma_f32_16x16x32_bf16 v[0:3], a[0:3], a[176:179], v[0:3]
    ds_read_b64_tr_b16 a[32:33], v224 offset:20480
    v_mfma_f32_16x16x32_bf16 v[4:7], a[0:3], a[180:183], v[4:7]
    ds_read_b64_tr_b16 a[34:35], v224 offset:21504
    v_mfma_f32_16x16x32_bf16 v[12:15], a[4:7], a[180:183], v[12:15]
    ds_read_b64_tr_b16 a[36:37], v225 offset:20480
    buffer_load_dword v228, v134, s[8:11], s46 offen offset:0 sc1
    v_mfma_f32_16x16x32_bf16 v[8:11], a[4:7], a[176:179], v[8:11]
    ds_read_b64_tr_b16 a[38:39], v225 offset:21504
    s_waitcnt lgkmcnt(4)
    v_mfma_f32_16x16x32_bf16 v[16:19], a[8:11], a[176:179], v[16:19]
    ds_read_b64_tr_b16 a[40:41], v226 offset:20480
    buffer_load_dwordx4 v[96:99], v241, s[8:11], s44 offen offset:0 sc1
    v_mfma_f32_16x16x32_bf16 v[20:23], a[8:11], a[180:183], v[20:23]
    ds_read_b64_tr_b16 a[42:43], v226 offset:21504
    v_mfma_f32_16x16x32_bf16 v[28:31], a[12:15], a[180:183], v[28:31]
    ds_read_b64_tr_b16 a[44:45], v227 offset:20480
    buffer_load_dwordx4 v[100:103], v241, s[8:11], s45 offen offset:0 sc1
    v_mfma_f32_16x16x32_bf16 v[24:27], a[12:15], a[176:179], v[24:27]
    ds_read_b64_tr_b16 a[46:47], v227 offset:21504
    s_waitcnt vmcnt(33) lgkmcnt(4)
    s_barrier
    v_xor_b32 v224, 0x10000, v224
    v_xor_b32 v225, 0x10000, v225
    v_xor_b32 v226, 0x10000, v226
    v_xor_b32 v227, 0x10000, v227
    v_mfma_f32_16x16x32_bf16 v[0:3], a[32:35], a[184:187], v[0:3]
    ds_read_b64_tr_b16 a[0:1], v224 offset:32768
    v_mfma_f32_16x16x32_bf16 v[4:7], a[32:35], a[188:191], v[4:7]
    ds_read_b64_tr_b16 a[2:3], v224 offset:33792
    v_mfma_f32_16x16x32_bf16 v[12:15], a[36:39], a[188:191], v[12:15]
    ds_read_b64_tr_b16 a[4:5], v225 offset:32768
    buffer_load_dword v229, v134, s[8:11], s46 offen offset:64 sc1
    v_mfma_f32_16x16x32_bf16 v[8:11], a[36:39], a[184:187], v[8:11]
    ds_read_b64_tr_b16 a[6:7], v225 offset:33792
    s_waitcnt lgkmcnt(4)
    v_mfma_f32_16x16x32_bf16 v[16:19], a[40:43], a[184:187], v[16:19]
    ds_read_b64_tr_b16 a[8:9], v226 offset:32768
    buffer_load_dwordx4 v[104:107], v241, s[8:11], s44 offen offset:1024 sc1
    v_mfma_f32_16x16x32_bf16 v[20:23], a[40:43], a[188:191], v[20:23]
    ds_read_b64_tr_b16 a[10:11], v226 offset:33792
    v_mfma_f32_16x16x32_bf16 v[28:31], a[44:47], a[188:191], v[28:31]
    ds_read_b64_tr_b16 a[12:13], v227 offset:32768
    buffer_load_dwordx4 v[108:111], v241, s[8:11], s45 offen offset:1024 sc1
    v_mfma_f32_16x16x32_bf16 v[24:27], a[44:47], a[184:187], v[24:27]
    ds_read_b64_tr_b16 a[14:15], v227 offset:33792
    s_waitcnt vmcnt(41) lgkmcnt(4)
    v_mfma_f32_16x16x32_bf16 v[0:3], a[0:3], a[64:67], v[0:3]
    ds_read_b64_tr_b16 a[32:33], v224 offset:36864
    v_mfma_f32_16x16x32_bf16 v[4:7], a[0:3], a[68:71], v[4:7]
    ds_read_b64_tr_b16 a[34:35], v224 offset:37888
    v_mfma_f32_16x16x32_bf16 v[12:15], a[4:7], a[68:71], v[12:15]
    ds_read_b64_tr_b16 a[36:37], v225 offset:36864
    v_mfma_f32_16x16x32_bf16 v[8:11], a[4:7], a[64:67], v[8:11]
    ds_read_b64_tr_b16 a[38:39], v225 offset:37888
    s_waitcnt lgkmcnt(4)
    v_mfma_f32_16x16x32_bf16 v[16:19], a[8:11], a[64:67], v[16:19]
    ds_read_b64_tr_b16 a[40:41], v226 offset:36864
    v_mfma_f32_16x16x32_bf16 v[20:23], a[8:11], a[68:71], v[20:23]
    ds_read_b64_tr_b16 a[42:43], v226 offset:37888
    v_mfma_f32_16x16x32_bf16 v[28:31], a[12:15], a[68:71], v[28:31]
    ds_read_b64_tr_b16 a[44:45], v227 offset:36864
    v_mfma_f32_16x16x32_bf16 v[24:27], a[12:15], a[64:67], v[24:27]
    ds_read_b64_tr_b16 a[46:47], v227 offset:37888
    s_waitcnt vmcnt(28) lgkmcnt(4)
    s_barrier
    v_mfma_f32_16x16x32_bf16 v[0:3], a[32:35], a[72:75], v[0:3]
    ds_read_b64_tr_b16 a[0:1], v224 offset:49152
    v_mfma_f32_16x16x32_bf16 v[4:7], a[32:35], a[76:79], v[4:7]
    ds_read_b64_tr_b16 a[2:3], v224 offset:50176
    v_mfma_f32_16x16x32_bf16 v[12:15], a[36:39], a[76:79], v[12:15]
    ds_read_b64_tr_b16 a[4:5], v225 offset:49152
    v_mfma_f32_16x16x32_bf16 v[8:11], a[36:39], a[72:75], v[8:11]
    ds_read_b64_tr_b16 a[6:7], v225 offset:50176
    buffer_load_dwordx4 v[64:67], v241, s[8:11], s35 offen offset:0 sc1
    s_waitcnt lgkmcnt(4)
    v_mfma_f32_16x16x32_bf16 v[16:19], a[40:43], a[72:75], v[16:19]
    ds_read_b64_tr_b16 a[8:9], v226 offset:49152
    v_mfma_f32_16x16x32_bf16 v[20:23], a[40:43], a[76:79], v[20:23]
    ds_read_b64_tr_b16 a[10:11], v226 offset:50176
    v_mfma_f32_16x16x32_bf16 v[28:31], a[44:47], a[76:79], v[28:31]
    ds_read_b64_tr_b16 a[12:13], v227 offset:49152
    buffer_load_dwordx4 v[68:71], v241, s[8:11], s35 offen offset:1024 sc1
    v_mfma_f32_16x16x32_bf16 v[24:27], a[44:47], a[72:75], v[24:27]
    ds_read_b64_tr_b16 a[14:15], v227 offset:50176
    s_waitcnt vmcnt(36) lgkmcnt(4)
    v_mfma_f32_16x16x32_bf16 v[0:3], a[0:3], a[80:83], v[0:3]
    ds_read_b64_tr_b16 a[32:33], v224 offset:53248
    v_mfma_f32_16x16x32_bf16 v[4:7], a[0:3], a[84:87], v[4:7]
    ds_read_b64_tr_b16 a[34:35], v224 offset:54272
    v_mfma_f32_16x16x32_bf16 v[12:15], a[4:7], a[84:87], v[12:15]
    ds_read_b64_tr_b16 a[36:37], v225 offset:53248
    v_mfma_f32_16x16x32_bf16 v[8:11], a[4:7], a[80:83], v[8:11]
    ds_read_b64_tr_b16 a[38:39], v225 offset:54272
    buffer_load_dwordx4 v[72:75], v241, s[8:11], s35 offen offset:2048 sc1
    s_waitcnt lgkmcnt(4)
    v_mfma_f32_16x16x32_bf16 v[16:19], a[8:11], a[80:83], v[16:19]
    ds_read_b64_tr_b16 a[40:41], v226 offset:53248
    v_mfma_f32_16x16x32_bf16 v[20:23], a[8:11], a[84:87], v[20:23]
    ds_read_b64_tr_b16 a[42:43], v226 offset:54272
    v_mfma_f32_16x16x32_bf16 v[28:31], a[12:15], a[84:87], v[28:31]
    ds_read_b64_tr_b16 a[44:45], v227 offset:53248
    buffer_load_dwordx4 v[76:79], v241, s[8:11], s35 offen offset:3072 sc1
    v_mfma_f32_16x16x32_bf16 v[24:27], a[12:15], a[80:83], v[24:27]
    ds_read_b64_tr_b16 a[46:47], v227 offset:54272
    s_waitcnt vmcnt(25) lgkmcnt(4)
    s_barrier
    v_mfma_f32_16x16x32_bf16 v[0:3], a[32:35], a[88:91], v[0:3]
    ds_read_b64_tr_b16 a[0:1], v224 offset:0
    v_mfma_f32_16x16x32_bf16 v[4:7], a[32:35], a[92:95], v[4:7]
    ds_read_b64_tr_b16 a[2:3], v224 offset:1024
    v_mfma_f32_16x16x32_bf16 v[12:15], a[36:39], a[92:95], v[12:15]
    ds_read_b64_tr_b16 a[4:5], v225 offset:0
    v_mfma_f32_16x16x32_bf16 v[8:11], a[36:39], a[88:91], v[8:11]
    ds_read_b64_tr_b16 a[6:7], v225 offset:1024
    buffer_load_dwordx4 v[80:83], v242, s[8:11], s35 offen offset:0 sc1
    s_waitcnt lgkmcnt(4)
    v_mfma_f32_16x16x32_bf16 v[16:19], a[40:43], a[88:91], v[16:19]
    ds_read_b64_tr_b16 a[8:9], v226 offset:0
    v_mfma_f32_16x16x32_bf16 v[20:23], a[40:43], a[92:95], v[20:23]
    ds_read_b64_tr_b16 a[10:11], v226 offset:1024
    v_mfma_f32_16x16x32_bf16 v[28:31], a[44:47], a[92:95], v[28:31]
    ds_read_b64_tr_b16 a[12:13], v227 offset:0
    buffer_load_dwordx4 v[84:87], v242, s[8:11], s35 offen offset:1024 sc1
    v_mfma_f32_16x16x32_bf16 v[24:27], a[44:47], a[88:91], v[24:27]
    ds_read_b64_tr_b16 a[14:15], v227 offset:1024
    s_waitcnt vmcnt(32) lgkmcnt(4)
    v_mfma_f32_16x16x32_bf16 v[0:3], a[0:3], a[96:99], v[0:3]
    ds_read_b64_tr_b16 a[32:33], v224 offset:4096
    v_mfma_f32_16x16x32_bf16 v[4:7], a[0:3], a[100:103], v[4:7]
    ds_read_b64_tr_b16 a[34:35], v224 offset:5120
    v_mfma_f32_16x16x32_bf16 v[12:15], a[4:7], a[100:103], v[12:15]
    ds_read_b64_tr_b16 a[36:37], v225 offset:4096
    v_mfma_f32_16x16x32_bf16 v[8:11], a[4:7], a[96:99], v[8:11]
    ds_read_b64_tr_b16 a[38:39], v225 offset:5120
    s_waitcnt lgkmcnt(4)
    v_mfma_f32_16x16x32_bf16 v[16:19], a[8:11], a[96:99], v[16:19]
    ds_read_b64_tr_b16 a[40:41], v226 offset:4096
    v_mfma_f32_16x16x32_bf16 v[20:23], a[8:11], a[100:103], v[20:23]
    ds_read_b64_tr_b16 a[42:43], v226 offset:5120
    v_mfma_f32_16x16x32_bf16 v[28:31], a[12:15], a[100:103], v[28:31]
    ds_read_b64_tr_b16 a[44:45], v227 offset:4096
    v_mfma_f32_16x16x32_bf16 v[24:27], a[12:15], a[96:99], v[24:27]
    ds_read_b64_tr_b16 a[46:47], v227 offset:5120
    s_waitcnt vmcnt(20) lgkmcnt(4)
    s_barrier
    v_mfma_f32_16x16x32_bf16 v[0:3], a[32:35], a[104:107], v[0:3]
    ds_read_b64_tr_b16 a[0:1], v224 offset:16384
    v_mfma_f32_16x16x32_bf16 v[4:7], a[32:35], a[108:111], v[4:7]
    ds_read_b64_tr_b16 a[2:3], v224 offset:17408
    v_mfma_f32_16x16x32_bf16 v[12:15], a[36:39], a[108:111], v[12:15]
    ds_read_b64_tr_b16 a[4:5], v225 offset:16384
    v_mfma_f32_16x16x32_bf16 v[8:11], a[36:39], a[104:107], v[8:11]
    ds_read_b64_tr_b16 a[6:7], v225 offset:17408
    s_waitcnt lgkmcnt(4)
    v_mfma_f32_16x16x32_bf16 v[16:19], a[40:43], a[104:107], v[16:19]
    ds_read_b64_tr_b16 a[8:9], v226 offset:16384
    v_mfma_f32_16x16x32_bf16 v[20:23], a[40:43], a[108:111], v[20:23]
    ds_read_b64_tr_b16 a[10:11], v226 offset:17408
    v_mfma_f32_16x16x32_bf16 v[28:31], a[44:47], a[108:111], v[28:31]
    ds_read_b64_tr_b16 a[12:13], v227 offset:16384
    v_mfma_f32_16x16x32_bf16 v[24:27], a[44:47], a[104:107], v[24:27]
    ds_read_b64_tr_b16 a[14:15], v227 offset:17408
    s_waitcnt vmcnt(25) lgkmcnt(4)
    v_mfma_f32_16x16x32_bf16 v[0:3], a[0:3], a[112:115], v[0:3]
    ds_read_b64_tr_b16 a[32:33], v224 offset:20480
    v_mfma_f32_16x16x32_bf16 v[4:7], a[0:3], a[116:119], v[4:7]
    ds_read_b64_tr_b16 a[34:35], v224 offset:21504
    v_mfma_f32_16x16x32_bf16 v[12:15], a[4:7], a[116:119], v[12:15]
    ds_read_b64_tr_b16 a[36:37], v225 offset:20480
    v_mfma_f32_16x16x32_bf16 v[8:11], a[4:7], a[112:115], v[8:11]
    ds_read_b64_tr_b16 a[38:39], v225 offset:21504
    s_waitcnt lgkmcnt(4)
    v_mfma_f32_16x16x32_bf16 v[16:19], a[8:11], a[112:115], v[16:19]
    ds_read_b64_tr_b16 a[40:41], v226 offset:20480
    v_mfma_f32_16x16x32_bf16 v[20:23], a[8:11], a[116:119], v[20:23]
    ds_read_b64_tr_b16 a[42:43], v226 offset:21504
    v_mfma_f32_16x16x32_bf16 v[28:31], a[12:15], a[116:119], v[28:31]
    ds_read_b64_tr_b16 a[44:45], v227 offset:20480
    v_mfma_f32_16x16x32_bf16 v[24:27], a[12:15], a[112:115], v[24:27]
    ds_read_b64_tr_b16 a[46:47], v227 offset:21504
    s_waitcnt vmcnt(22) lgkmcnt(4)
    v_mfma_f32_16x16x32_bf16 v[0:3], a[32:35], a[120:123], v[0:3]
    v_mfma_f32_16x16x32_bf16 v[4:7], a[32:35], a[124:127], v[4:7]
    v_mfma_f32_16x16x32_bf16 v[12:15], a[36:39], a[124:127], v[12:15]
    v_mfma_f32_16x16x32_bf16 v[8:11], a[36:39], a[120:123], v[8:11]
    s_waitcnt lgkmcnt(0)
    v_mfma_f32_16x16x32_bf16 v[16:19], a[40:43], a[120:123], v[16:19]
    v_mfma_f32_16x16x32_bf16 v[20:23], a[40:43], a[124:127], v[20:23]
    v_mfma_f32_16x16x32_bf16 v[28:31], a[44:47], a[124:127], v[28:31]
    v_mfma_f32_16x16x32_bf16 v[24:27], a[44:47], a[120:123], v[24:27]
    s_lshl_b32 s27, s21, 12
    v_and_b32 v128, 15, v240
    v_and_b32 v129, 7, v240
    v_lshrrev_b32 v130, 5, v240
    v_xor_b32 v129, v129, v130
    v_lshlrev_b32 v128, 7, v128
    v_bfe_u32 v130, v240, 4, 1
    v_lshl_add_u32 v128, v130, 3, v128
    v_add_u32 v128, s27, v128
    v_xor_b32 v130, 0, v129
    v_lshl_add_u32 v224, v130, 4, v128
    v_xor_b32 v130, 2, v129
    v_lshl_add_u32 v225, v130, 4, v128
    v_xor_b32 v130, 4, v129
    v_lshl_add_u32 v226, v130, 4, v128
    v_xor_b32 v130, 6, v129
    v_lshl_add_u32 v227, v130, 4, v128
    s_waitcnt vmcnt(6)
    v_add_f32 v112, v112, v113
    v_add_f32 v114, v114, v115
    v_add_f32 v112, v112, v114
    v_mov_b32 v128, v112
    s_nop 1
    v_permlane16_swap_b32 v112, v128
    v_add_f32 v112, v112, v128
    v_mov_b32 v128, v112
    s_nop 1
    v_permlane32_swap_b32 v112, v128
    v_add_f32 v112, v112, v128
    v_mov_b32 v113, 0x3727c5ac
    v_fmac_f32 v113, 0x3a800000, v112
    v_rcp_f32 v112, v113
    v_add_f32 v116, v116, v117
    v_add_f32 v118, v118, v119
    v_add_f32 v116, v116, v118
    v_mov_b32 v128, v116
    s_nop 1
    v_permlane16_swap_b32 v116, v128
    v_add_f32 v116, v116, v128
    v_mov_b32 v128, v116
    s_nop 1
    v_permlane32_swap_b32 v116, v128
    v_add_f32 v116, v116, v128
    v_mov_b32 v117, 0x3727c5ac
    v_fmac_f32 v117, 0x3a800000, v116
    v_rcp_f32 v116, v117
    v_lshlrev_b32 v128, 16, v96
    v_and_b32 v129, 0xffff0000, v96
    v_lshlrev_b32 v130, 16, v97
    v_and_b32 v131, 0xffff0000, v97
    v_pk_add_f32 v[128:129], v[128:129], v[228:229] op_sel:[0,0] op_sel_hi:[1,0]
    v_pk_add_f32 v[130:131], v[130:131], v[228:229] op_sel:[0,0] op_sel_hi:[1,0]
    v_pk_fma_f32 v[0:1], v[0:1], v[112:113], v[128:129] op_sel:[0,0,0] op_sel_hi:[1,0,1]
    v_pk_fma_f32 v[2:3], v[2:3], v[112:113], v[130:131] op_sel:[0,0,0] op_sel_hi:[1,0,1]
    v_lshlrev_b32 v128, 16, v104
    v_and_b32 v129, 0xffff0000, v104
    v_lshlrev_b32 v130, 16, v105
    v_and_b32 v131, 0xffff0000, v105
    v_pk_add_f32 v[128:129], v[128:129], v[228:229] op_sel:[0,1] op_sel_hi:[1,1]
    v_pk_add_f32 v[130:131], v[130:131], v[228:229] op_sel:[0,1] op_sel_hi:[1,1]
    v_pk_fma_f32 v[4:5], v[4:5], v[116:117], v[128:129] op_sel:[0,0,0] op_sel_hi:[1,0,1]
    v_pk_fma_f32 v[6:7], v[6:7], v[116:117], v[130:131] op_sel:[0,0,0] op_sel_hi:[1,0,1]
    v_lshlrev_b32 v128, 16, v98
    v_and_b32 v129, 0xffff0000, v98
    v_lshlrev_b32 v130, 16, v99
    v_and_b32 v131, 0xffff0000, v99
    v_pk_add_f32 v[128:129], v[128:129], v[228:229] op_sel:[0,0] op_sel_hi:[1,0]
    v_pk_add_f32 v[130:131], v[130:131], v[228:229] op_sel:[0,0] op_sel_hi:[1,0]
    v_pk_fma_f32 v[8:9], v[8:9], v[112:113], v[128:129] op_sel:[0,0,0] op_sel_hi:[1,0,1]
    v_pk_fma_f32 v[10:11], v[10:11], v[112:113], v[130:131] op_sel:[0,0,0] op_sel_hi:[1,0,1]
    v_lshlrev_b32 v128, 16, v106
    v_and_b32 v129, 0xffff0000, v106
    v_lshlrev_b32 v130, 16, v107
    v_and_b32 v131, 0xffff0000, v107
    v_pk_add_f32 v[128:129], v[128:129], v[228:229] op_sel:[0,1] op_sel_hi:[1,1]
    v_pk_add_f32 v[130:131], v[130:131], v[228:229] op_sel:[0,1] op_sel_hi:[1,1]
    v_pk_fma_f32 v[12:13], v[12:13], v[116:117], v[128:129] op_sel:[0,0,0] op_sel_hi:[1,0,1]
    v_pk_fma_f32 v[14:15], v[14:15], v[116:117], v[130:131] op_sel:[0,0,0] op_sel_hi:[1,0,1]
    v_lshlrev_b32 v128, 16, v100
    v_and_b32 v129, 0xffff0000, v100
    v_lshlrev_b32 v130, 16, v101
    v_and_b32 v131, 0xffff0000, v101
    v_pk_add_f32 v[128:129], v[128:129], v[228:229] op_sel:[0,0] op_sel_hi:[1,0]
    v_pk_add_f32 v[130:131], v[130:131], v[228:229] op_sel:[0,0] op_sel_hi:[1,0]
    v_pk_fma_f32 v[16:17], v[16:17], v[112:113], v[128:129] op_sel:[0,0,0] op_sel_hi:[1,0,1]
    v_pk_fma_f32 v[18:19], v[18:19], v[112:113], v[130:131] op_sel:[0,0,0] op_sel_hi:[1,0,1]
    v_lshlrev_b32 v128, 16, v108
    v_and_b32 v129, 0xffff0000, v108
    v_lshlrev_b32 v130, 16, v109
    v_and_b32 v131, 0xffff0000, v109
    v_pk_add_f32 v[128:129], v[128:129], v[228:229] op_sel:[0,1] op_sel_hi:[1,1]
    v_pk_add_f32 v[130:131], v[130:131], v[228:229] op_sel:[0,1] op_sel_hi:[1,1]
    v_pk_fma_f32 v[20:21], v[20:21], v[116:117], v[128:129] op_sel:[0,0,0] op_sel_hi:[1,0,1]
    v_pk_fma_f32 v[22:23], v[22:23], v[116:117], v[130:131] op_sel:[0,0,0] op_sel_hi:[1,0,1]
    v_lshlrev_b32 v128, 16, v102
    v_and_b32 v129, 0xffff0000, v102
    v_lshlrev_b32 v130, 16, v103
    v_and_b32 v131, 0xffff0000, v103
    v_pk_add_f32 v[128:129], v[128:129], v[228:229] op_sel:[0,0] op_sel_hi:[1,0]
    v_pk_add_f32 v[130:131], v[130:131], v[228:229] op_sel:[0,0] op_sel_hi:[1,0]
    v_pk_fma_f32 v[24:25], v[24:25], v[112:113], v[128:129] op_sel:[0,0,0] op_sel_hi:[1,0,1]
    v_pk_fma_f32 v[26:27], v[26:27], v[112:113], v[130:131] op_sel:[0,0,0] op_sel_hi:[1,0,1]
    v_lshlrev_b32 v128, 16, v110
    v_and_b32 v129, 0xffff0000, v110
    v_lshlrev_b32 v130, 16, v111
    v_and_b32 v131, 0xffff0000, v111
    v_pk_add_f32 v[128:129], v[128:129], v[228:229] op_sel:[0,1] op_sel_hi:[1,1]
    v_pk_add_f32 v[130:131], v[130:131], v[228:229] op_sel:[0,1] op_sel_hi:[1,1]
    v_pk_fma_f32 v[28:29], v[28:29], v[116:117], v[128:129] op_sel:[0,0,0] op_sel_hi:[1,0,1]
    v_pk_fma_f32 v[30:31], v[30:31], v[116:117], v[130:131] op_sel:[0,0,0] op_sel_hi:[1,0,1]
    s_mov_b32 s4, 0
xwait:
    s_waitcnt vmcnt(0)
    v_xor_b32 v130, v67, v247
    v_bitop3_b32 v130, v71, v247, v130 bitop3:0xbe
    v_bitop3_b32 v130, v75, v247, v130 bitop3:0xbe
    v_bitop3_b32 v130, v79, v247, v130 bitop3:0xbe
    v_bitop3_b32 v130, v83, v247, v130 bitop3:0xbe
    v_bitop3_b32 v130, v87, v247, v130 bitop3:0xbe
    v_cmp_ne_u32 vcc, 0, v130
    s_cbranch_vccz xwait_ok
xwait_last:
    buffer_load_dwordx4 v[84:87], v242, s[8:11], s35 offen offset:1024 sc1
    s_add_u32 s4, s4, 1
    s_cmp_ge_u32 s4, 2097152
    s_cbranch_scc1 xwait_give
    s_waitcnt vmcnt(0)
    v_xor_b32 v130, v87, v247
    v_cmp_ne_u32 vcc, 0, v130
    s_cbranch_vccnz xwait_last
    buffer_load_dwordx4 v[64:67], v241, s[8:11], s35 offen offset:0 sc1
    buffer_load_dwordx4 v[68:71], v241, s[8:11], s35 offen offset:1024 sc1
    buffer_load_dwordx4 v[72:75], v241, s[8:11], s35 offen offset:2048 sc1
    buffer_load_dwordx4 v[76:79], v241, s[8:11], s35 offen offset:3072 sc1
    buffer_load_dwordx4 v[80:83], v242, s[8:11], s35 offen offset:0 sc1
    s_branch xwait
xwait_give:
    s_waitcnt vmcnt(0)
xwait_ok:
    v_lshlrev_b32 v128, 16, v64
    v_and_b32 v129, 0xffff0000, v64
    v_lshlrev_b32 v130, 16, v65
    v_and_b32 v131, 0xffff0000, v65
    v_pk_fma_f32 v[0:1], v[128:129], v[112:113], v[0:1] op_sel:[0,0,0] op_sel_hi:[1,0,1]
    v_pk_fma_f32 v[2:3], v[130:131], v[112:113], v[2:3] op_sel:[0,0,0] op_sel_hi:[1,0,1]
    v_cvt_pk_bf16_f32 v0, v0, v1
    v_cvt_pk_bf16_f32 v1, v2, v3
    ds_write_b64 v224, v[0:1] offset:0
    v_lshlrev_b32 v128, 16, v66
    v_and_b32 v129, 0xffff0000, v66
    v_lshlrev_b32 v130, 16, v68
    v_and_b32 v131, 0xffff0000, v68
    v_pk_fma_f32 v[4:5], v[128:129], v[116:117], v[4:5] op_sel:[0,0,0] op_sel_hi:[1,0,1]
    v_pk_fma_f32 v[6:7], v[130:131], v[116:117], v[6:7] op_sel:[0,0,0] op_sel_hi:[1,0,1]
    v_cvt_pk_bf16_f32 v4, v4, v5
    v_cvt_pk_bf16_f32 v5, v6, v7
    ds_write_b64 v224, v[4:5] offset:2048
    v_lshlrev_b32 v128, 16, v69
    v_and_b32 v129, 0xffff0000, v69
    v_lshlrev_b32 v130, 16, v70
    v_and_b32 v131, 0xffff0000, v70
    v_pk_fma_f32 v[8:9], v[128:129], v[112:113], v[8:9] op_sel:[0,0,0] op_sel_hi:[1,0,1]
    v_pk_fma_f32 v[10:11], v[130:131], v[112:113], v[10:11] op_sel:[0,0,0] op_sel_hi:[1,0,1]
    v_cvt_pk_bf16_f32 v8, v8, v9
    v_cvt_pk_bf16_f32 v9, v10, v11
    ds_write_b64 v225, v[8:9] offset:0
    v_lshlrev_b32 v128, 16, v72
    v_and_b32 v129, 0xffff0000, v72
    v_lshlrev_b32 v130, 16, v73
    v_and_b32 v131, 0xffff0000, v73
    v_pk_fma_f32 v[12:13], v[128:129], v[116:117], v[12:13] op_sel:[0,0,0] op_sel_hi:[1,0,1]
    v_pk_fma_f32 v[14:15], v[130:131], v[116:117], v[14:15] op_sel:[0,0,0] op_sel_hi:[1,0,1]
    v_cvt_pk_bf16_f32 v12, v12, v13
    v_cvt_pk_bf16_f32 v13, v14, v15
    ds_write_b64 v225, v[12:13] offset:2048
    v_lshlrev_b32 v128, 16, v74
    v_and_b32 v129, 0xffff0000, v74
    v_lshlrev_b32 v130, 16, v76
    v_and_b32 v131, 0xffff0000, v76
    v_pk_fma_f32 v[16:17], v[128:129], v[112:113], v[16:17] op_sel:[0,0,0] op_sel_hi:[1,0,1]
    v_pk_fma_f32 v[18:19], v[130:131], v[112:113], v[18:19] op_sel:[0,0,0] op_sel_hi:[1,0,1]
    v_cvt_pk_bf16_f32 v16, v16, v17
    v_cvt_pk_bf16_f32 v17, v18, v19
    ds_write_b64 v226, v[16:17] offset:0
    v_lshlrev_b32 v128, 16, v77
    v_and_b32 v129, 0xffff0000, v77
    v_lshlrev_b32 v130, 16, v78
    v_and_b32 v131, 0xffff0000, v78
    v_pk_fma_f32 v[20:21], v[128:129], v[116:117], v[20:21] op_sel:[0,0,0] op_sel_hi:[1,0,1]
    v_pk_fma_f32 v[22:23], v[130:131], v[116:117], v[22:23] op_sel:[0,0,0] op_sel_hi:[1,0,1]
    v_cvt_pk_bf16_f32 v20, v20, v21
    v_cvt_pk_bf16_f32 v21, v22, v23
    ds_write_b64 v226, v[20:21] offset:2048
    v_lshlrev_b32 v128, 16, v80
    v_and_b32 v129, 0xffff0000, v80
    v_lshlrev_b32 v130, 16, v81
    v_and_b32 v131, 0xffff0000, v81
    v_pk_fma_f32 v[24:25], v[128:129], v[112:113], v[24:25] op_sel:[0,0,0] op_sel_hi:[1,0,1]
    v_pk_fma_f32 v[26:27], v[130:131], v[112:113], v[26:27] op_sel:[0,0,0] op_sel_hi:[1,0,1]
    v_cvt_pk_bf16_f32 v24, v24, v25
    v_cvt_pk_bf16_f32 v25, v26, v27
    ds_write_b64 v227, v[24:25] offset:0
    v_lshlrev_b32 v128, 16, v82
    v_and_b32 v129, 0xffff0000, v82
    v_lshlrev_b32 v130, 16, v84
    v_and_b32 v131, 0xffff0000, v84
    v_pk_fma_f32 v[28:29], v[128:129], v[116:117], v[28:29] op_sel:[0,0,0] op_sel_hi:[1,0,1]
    v_pk_fma_f32 v[30:31], v[130:131], v[116:117], v[30:31] op_sel:[0,0,0] op_sel_hi:[1,0,1]
    v_cvt_pk_bf16_f32 v28, v28, v29
    v_cvt_pk_bf16_f32 v29, v30, v31
    ds_write_b64 v227, v[28:29] offset:2048
    v_lshrrev_b32 v128, 3, v240
    v_and_b32 v129, 7, v240
    v_xor_b32 v130, v129, v128
    v_lshlrev_b32 v130, 4, v130
    v_lshl_add_u32 v130, v128, 7, v130
    v_add_u32 v130, s27, v130
    v_lshlrev_b32 v129, 4, v129
    v_lshl_add_u32 v129, v128, 11, v129
    s_lshl_b32 s28, s15, 16
    s_lshl_b32 s4, s13, 7
    s_add_u32 s28, s28, s4
    s_waitcnt lgkmcnt(0)
    ds_read_b128 v[96:99], v130 offset:0
    ds_read_b128 v[100:103], v130 offset:1024
    ds_read_b128 v[104:107], v130 offset:2048
    ds_read_b128 v[108:111], v130 offset:3072
    s_waitcnt lgkmcnt(3)
    buffer_store_dwordx4 v[96:99], v129, s[16:19], s28 offen
    s_add_u32 s28, s28, 16384
    s_waitcnt lgkmcnt(2)
    buffer_store_dwordx4 v[100:103], v129, s[16:19], s28 offen
    s_add_u32 s28, s28, 16384
    s_waitcnt lgkmcnt(1)
    buffer_store_dwordx4 v[104:107], v129, s[16:19], s28 offen
    s_add_u32 s28, s28, 16384
    s_waitcnt lgkmcnt(0)
    buffer_store_dwordx4 v[108:111], v129, s[16:19], s28 offen
all_done:
    s_endpgm
code_end:
attn_slow:
    s_waitcnt vmcnt(0) lgkmcnt(0)
    v_mov_b32 v176, 0xff800000
    v_mov_b32 v177, 0xff800000
    v_mov_b32 v178, 0xff800000
    v_mov_b32 v179, 0xff800000
    s_mov_b32 s4, 0
attn_slow_max:
    s_lshr_b32 s3, s4, 1
    s_lshl_b32 s3, s3, 14
    s_and_b32 s5, s4, 1
    s_lshl_b32 s5, s5, 12
    s_add_u32 s3, s3, s5
    s_add_u32 s24, s35, s3
    buffer_load_dwordx4 a[0:3], v241, s[8:11], s24 offen offset:0 sc1
    buffer_load_dwordx4 a[4:7], v241, s[8:11], s24 offen offset:1024 sc1
    s_waitcnt vmcnt(0)
    v_mfma_f32_32x32x16_bf16 v[112:127], a[0:3], a[64:67], 0
    v_mfma_f32_32x32x16_bf16 v[112:127], a[4:7], a[68:71], v[112:127]
    v_mfma_f32_32x32x16_bf16 v[128:143], a[0:3], a[72:75], 0
    v_mfma_f32_32x32x16_bf16 v[128:143], a[4:7], a[76:79], v[128:143]
    v_mfma_f32_32x32x16_bf16 v[144:159], a[0:3], a[80:83], 0
    v_mfma_f32_32x32x16_bf16 v[144:159], a[4:7], a[84:87], v[144:159]
    v_mfma_f32_32x32x16_bf16 v[160:175], a[0:3], a[88:91], 0
    v_mfma_f32_32x32x16_bf16 v[160:175], a[4:7], a[92:95], v[160:175]
    s_nop 15
    v_max3_f32 v176, v112, v113, v176
    v_max3_f32 v176, v114, v115, v176
    v_max3_f32 v176, v116, v117, v176
    v_max3_f32 v176, v118, v119, v176
    v_max3_f32 v176, v120, v121, v176
    v_max3_f32 v176, v122, v123, v176
    v_max3_f32 v176, v124, v125, v176
    v_max3_f32 v176, v126, v127, v176
    v_max3_f32 v177, v128, v129, v177
    v_max3_f32 v177, v130, v131, v177
    v_max3_f32 v177, v132, v133, v177
    v_max3_f32 v177, v134, v135, v177
    v_max3_f32 v177, v136, v137, v177
    v_max3_f32 v177, v138, v139, v177
    v_max3_f32 v177, v140, v141, v177
    v_max3_f32 v177, v142, v143, v177
    v_max3_f32 v178, v144, v145, v178
    v_max3_f32 v178, v146, v147, v178
    v_max3_f32 v178, v148, v149, v178
    v_max3_f32 v178, v150, v151, v178
    v_max3_f32 v178, v152, v153, v178
    v_max3_f32 v178, v154, v155, v178
    v_max3_f32 v178, v156, v157, v178
    v_max3_f32 v178, v158, v159, v178
    v_max3_f32 v179, v160, v161, v179
    v_max3_f32 v179, v162, v163, v179
    v_max3_f32 v179, v164, v165, v179
    v_max3_f32 v179, v166, v167, v179
    v_max3_f32 v179, v168, v169, v179
    v_max3_f32 v179, v170, v171, v179
    v_max3_f32 v179, v172, v173, v179
    v_max3_f32 v179, v174, v175, v179
    s_add_u32 s4, s4, 1
    s_cmp_lt_u32 s4, 32
    s_cbranch_scc1 attn_slow_max
    v_mov_b32 v180, v176
    v_mov_b32 v181, v177
    v_mov_b32 v182, v178
    v_mov_b32 v183, v179
    s_nop 1
    v_permlane32_swap_b32 v176, v180
    v_permlane32_swap_b32 v177, v181
    v_permlane32_swap_b32 v178, v182
    v_permlane32_swap_b32 v179, v183
    v_max_f32 v176, v176, v180
    v_max_f32 v177, v177, v181
    v_max_f32 v178, v178, v182
    v_max_f32 v179, v179, v183
    v_pk_mul_f32 v[48:49], v[176:177], -1.0 op_sel:[0,0] op_sel_hi:[0,0]
    v_pk_mul_f32 v[50:51], v[176:177], -1.0 op_sel:[0,0] op_sel_hi:[0,0]
    v_pk_mul_f32 v[52:53], v[176:177], -1.0 op_sel:[0,0] op_sel_hi:[0,0]
    v_pk_mul_f32 v[54:55], v[176:177], -1.0 op_sel:[0,0] op_sel_hi:[0,0]
    v_pk_mul_f32 v[56:57], v[176:177], -1.0 op_sel:[0,0] op_sel_hi:[0,0]
    v_pk_mul_f32 v[58:59], v[176:177], -1.0 op_sel:[0,0] op_sel_hi:[0,0]
    v_pk_mul_f32 v[60:61], v[176:177], -1.0 op_sel:[0,0] op_sel_hi:[0,0]
    v_pk_mul_f32 v[62:63], v[176:177], -1.0 op_sel:[0,0] op_sel_hi:[0,0]
    v_pk_mul_f32 v[64:65], v[176:177], -1.0 op_sel:[1,0] op_sel_hi:[1,0]
    v_pk_mul_f32 v[66:67], v[176:177], -1.0 op_sel:[1,0] op_sel_hi:[1,0]
    v_pk_mul_f32 v[68:69], v[176:177], -1.0 op_sel:[1,0] op_sel_hi:[1,0]
    v_pk_mul_f32 v[70:71], v[176:177], -1.0 op_sel:[1,0] op_sel_hi:[1,0]
    v_pk_mul_f32 v[72:73], v[176:177], -1.0 op_sel:[1,0] op_sel_hi:[1,0]
    v_pk_mul_f32 v[74:75], v[176:177], -1.0 op_sel:[1,0] op_sel_hi:[1,0]
    v_pk_mul_f32 v[76:77], v[176:177], -1.0 op_sel:[1,0] op_sel_hi:[1,0]
    v_pk_mul_f32 v[78:79], v[176:177], -1.0 op_sel:[1,0] op_sel_hi:[1,0]
    v_pk_mul_f32 v[80:81], v[178:179], -1.0 op_sel:[0,0] op_sel_hi:[0,0]
    v_pk_mul_f32 v[82:83], v[178:179], -1.0 op_sel:[0,0] op_sel_hi:[0,0]
    v_pk_mul_f32 v[84:85], v[178:179], -1.0 op_sel:[0,0] op_sel_hi:[0,0]
    v_pk_mul_f32 v[86:87], v[178:179], -1.0 op_sel:[0,0] op_sel_hi:[0,0]
    v_pk_mul_f32 v[88:89], v[178:179], -1.0 op_sel:[0,0] op_sel_hi:[0,0]
    v_pk_mul_f32 v[90:91], v[178:179], -1.0 op_sel:[0,0] op_sel_hi:[0,0]
    v_pk_mul_f32 v[92:93], v[178:179], -1.0 op_sel:[0,0] op_sel_hi:[0,0]
    v_pk_mul_f32 v[94:95], v[178:179], -1.0 op_sel:[0,0] op_sel_hi:[0,0]
    v_pk_mul_f32 v[96:97], v[178:179], -1.0 op_sel:[1,0] op_sel_hi:[1,0]
    v_pk_mul_f32 v[98:99], v[178:179], -1.0 op_sel:[1,0] op_sel_hi:[1,0]
    v_pk_mul_f32 v[100:101], v[178:179], -1.0 op_sel:[1,0] op_sel_hi:[1,0]
    v_pk_mul_f32 v[102:103], v[178:179], -1.0 op_sel:[1,0] op_sel_hi:[1,0]
    v_pk_mul_f32 v[104:105], v[178:179], -1.0 op_sel:[1,0] op_sel_hi:[1,0]
    v_pk_mul_f32 v[106:107], v[178:179], -1.0 op_sel:[1,0] op_sel_hi:[1,0]
    v_pk_mul_f32 v[108:109], v[178:179], -1.0 op_sel:[1,0] op_sel_hi:[1,0]
    v_pk_mul_f32 v[110:111], v[178:179], -1.0 op_sel:[1,0] op_sel_hi:[1,0]
    v_mov_b32 v112, 0
    v_mov_b32 v113, 0
    v_mov_b32 v114, 0
    v_mov_b32 v115, 0
    v_mov_b32 v116, 0
    v_mov_b32 v117, 0
    v_mov_b32 v118, 0
    v_mov_b32 v119, 0
    v_mov_b32 v120, 0
    v_mov_b32 v121, 0
    v_mov_b32 v122, 0
    v_mov_b32 v123, 0
    v_mov_b32 v124, 0
    v_mov_b32 v125, 0
    v_mov_b32 v126, 0
    v_mov_b32 v127, 0
    v_accvgpr_write_b32 a96, 0
    v_accvgpr_write_b32 a97, 0
    v_accvgpr_write_b32 a98, 0
    v_accvgpr_write_b32 a99, 0
    v_mov_b32 v128, 0
    v_mov_b32 v129, 0
    v_mov_b32 v130, 0
    v_mov_b32 v131, 0
    v_mov_b32 v132, 0
    v_mov_b32 v133, 0
    v_mov_b32 v134, 0
    v_mov_b32 v135, 0
    v_mov_b32 v136, 0
    v_mov_b32 v137, 0
    v_mov_b32 v138, 0
    v_mov_b32 v139, 0
    v_mov_b32 v140, 0
    v_mov_b32 v141, 0
    v_mov_b32 v142, 0
    v_mov_b32 v143, 0
    v_accvgpr_write_b32 a100, 0
    v_accvgpr_write_b32 a101, 0
    v_accvgpr_write_b32 a102, 0
    v_accvgpr_write_b32 a103, 0
    v_mov_b32 v144, 0
    v_mov_b32 v145, 0
    v_mov_b32 v146, 0
    v_mov_b32 v147, 0
    v_mov_b32 v148, 0
    v_mov_b32 v149, 0
    v_mov_b32 v150, 0
    v_mov_b32 v151, 0
    v_mov_b32 v152, 0
    v_mov_b32 v153, 0
    v_mov_b32 v154, 0
    v_mov_b32 v155, 0
    v_mov_b32 v156, 0
    v_mov_b32 v157, 0
    v_mov_b32 v158, 0
    v_mov_b32 v159, 0
    v_accvgpr_write_b32 a104, 0
    v_accvgpr_write_b32 a105, 0
    v_accvgpr_write_b32 a106, 0
    v_accvgpr_write_b32 a107, 0
    v_mov_b32 v160, 0
    v_mov_b32 v161, 0
    v_mov_b32 v162, 0
    v_mov_b32 v163, 0
    v_mov_b32 v164, 0
    v_mov_b32 v165, 0
    v_mov_b32 v166, 0
    v_mov_b32 v167, 0
    v_mov_b32 v168, 0
    v_mov_b32 v169, 0
    v_mov_b32 v170, 0
    v_mov_b32 v171, 0
    v_mov_b32 v172, 0
    v_mov_b32 v173, 0
    v_mov_b32 v174, 0
    v_mov_b32 v175, 0
    v_accvgpr_write_b32 a108, 0
    v_accvgpr_write_b32 a109, 0
    v_accvgpr_write_b32 a110, 0
    v_accvgpr_write_b32 a111, 0
    s_mov_b32 s4, 0
attn_slow_acc:
    s_lshr_b32 s3, s4, 1
    s_lshl_b32 s3, s3, 14
    s_and_b32 s5, s4, 1
    s_lshl_b32 s5, s5, 12
    s_add_u32 s3, s3, s5
    s_add_u32 s24, s35, s3
    buffer_load_dwordx4 a[0:3], v241, s[8:11], s24 offen offset:0 sc1
    buffer_load_dwordx4 a[4:7], v241, s[8:11], s24 offen offset:1024 sc1
    buffer_load_dwordx4 a[8:11], v241, s[8:11], s24 offen offset:2048 sc1
    buffer_load_dwordx4 a[12:15], v241, s[8:11], s24 offen offset:3072 sc1
    s_waitcnt vmcnt(0)
    v_mfma_f32_32x32x16_bf16 v[0:15], a[0:3], a[64:67], v[48:63]
    v_mfma_f32_32x32x16_bf16 v[0:15], a[4:7], a[68:71], v[0:15]
    s_nop 15
    v_exp_f32 v0, v0
    v_exp_f32 v1, v1
    v_exp_f32 v2, v2
    v_exp_f32 v3, v3
    v_exp_f32 v4, v4
    v_exp_f32 v5, v5
    v_exp_f32 v6, v6
    v_exp_f32 v7, v7
    v_exp_f32 v8, v8
    v_exp_f32 v9, v9
    v_exp_f32 v10, v10
    v_exp_f32 v11, v11
    v_exp_f32 v12, v12
    v_exp_f32 v13, v13
    v_exp_f32 v14, v14
    v_exp_f32 v15, v15
    s_nop 0
    v_cvt_pk_bf16_f32 v32, v0, v1
    v_cvt_pk_bf16_f32 v33, v2, v3
    v_cvt_pk_bf16_f32 v34, v4, v5
    v_cvt_pk_bf16_f32 v35, v6, v7
    v_cvt_pk_bf16_f32 v36, v8, v9
    v_cvt_pk_bf16_f32 v37, v10, v11
    v_cvt_pk_bf16_f32 v38, v12, v13
    v_cvt_pk_bf16_f32 v39, v14, v15
    s_nop 1
    v_mfma_f32_32x32x16_bf16 v[112:127], a[8:11], v[32:35], v[112:127]
    v_mfma_f32_32x32x16_bf16 v[112:127], a[12:15], v[36:39], v[112:127]
    v_mfma_f32_16x16x32_bf16 a[96:99], a[112:115], v[32:35], a[96:99]
    v_mfma_f32_16x16x32_bf16 a[96:99], a[112:115], v[36:39], a[96:99]
    v_mfma_f32_32x32x16_bf16 v[0:15], a[0:3], a[72:75], v[64:79]
    v_mfma_f32_32x32x16_bf16 v[0:15], a[4:7], a[76:79], v[0:15]
    s_nop 15
    v_exp_f32 v0, v0
    v_exp_f32 v1, v1
    v_exp_f32 v2, v2
    v_exp_f32 v3, v3
    v_exp_f32 v4, v4
    v_exp_f32 v5, v5
    v_exp_f32 v6, v6
    v_exp_f32 v7, v7
    v_exp_f32 v8, v8
    v_exp_f32 v9, v9
    v_exp_f32 v10, v10
    v_exp_f32 v11, v11
    v_exp_f32 v12, v12
    v_exp_f32 v13, v13
    v_exp_f32 v14, v14
    v_exp_f32 v15, v15
    s_nop 0
    v_cvt_pk_bf16_f32 v32, v0, v1
    v_cvt_pk_bf16_f32 v33, v2, v3
    v_cvt_pk_bf16_f32 v34, v4, v5
    v_cvt_pk_bf16_f32 v35, v6, v7
    v_cvt_pk_bf16_f32 v36, v8, v9
    v_cvt_pk_bf16_f32 v37, v10, v11
    v_cvt_pk_bf16_f32 v38, v12, v13
    v_cvt_pk_bf16_f32 v39, v14, v15
    s_nop 1
    v_mfma_f32_32x32x16_bf16 v[128:143], a[8:11], v[32:35], v[128:143]
    v_mfma_f32_32x32x16_bf16 v[128:143], a[12:15], v[36:39], v[128:143]
    v_mfma_f32_16x16x32_bf16 a[100:103], a[112:115], v[32:35], a[100:103]
    v_mfma_f32_16x16x32_bf16 a[100:103], a[112:115], v[36:39], a[100:103]
    v_mfma_f32_32x32x16_bf16 v[0:15], a[0:3], a[80:83], v[80:95]
    v_mfma_f32_32x32x16_bf16 v[0:15], a[4:7], a[84:87], v[0:15]
    s_nop 15
    v_exp_f32 v0, v0
    v_exp_f32 v1, v1
    v_exp_f32 v2, v2
    v_exp_f32 v3, v3
    v_exp_f32 v4, v4
    v_exp_f32 v5, v5
    v_exp_f32 v6, v6
    v_exp_f32 v7, v7
    v_exp_f32 v8, v8
    v_exp_f32 v9, v9
    v_exp_f32 v10, v10
    v_exp_f32 v11, v11
    v_exp_f32 v12, v12
    v_exp_f32 v13, v13
    v_exp_f32 v14, v14
    v_exp_f32 v15, v15
    s_nop 0
    v_cvt_pk_bf16_f32 v32, v0, v1
    v_cvt_pk_bf16_f32 v33, v2, v3
    v_cvt_pk_bf16_f32 v34, v4, v5
    v_cvt_pk_bf16_f32 v35, v6, v7
    v_cvt_pk_bf16_f32 v36, v8, v9
    v_cvt_pk_bf16_f32 v37, v10, v11
    v_cvt_pk_bf16_f32 v38, v12, v13
    v_cvt_pk_bf16_f32 v39, v14, v15
    s_nop 1
    v_mfma_f32_32x32x16_bf16 v[144:159], a[8:11], v[32:35], v[144:159]
    v_mfma_f32_32x32x16_bf16 v[144:159], a[12:15], v[36:39], v[144:159]
    v_mfma_f32_16x16x32_bf16 a[104:107], a[112:115], v[32:35], a[104:107]
    v_mfma_f32_16x16x32_bf16 a[104:107], a[112:115], v[36:39], a[104:107]
    v_mfma_f32_32x32x16_bf16 v[0:15], a[0:3], a[88:91], v[96:111]
    v_mfma_f32_32x32x16_bf16 v[0:15], a[4:7], a[92:95], v[0:15]
    s_nop 15
    v_exp_f32 v0, v0
    v_exp_f32 v1, v1
    v_exp_f32 v2, v2
    v_exp_f32 v3, v3
    v_exp_f32 v4, v4
    v_exp_f32 v5, v5
    v_exp_f32 v6, v6
    v_exp_f32 v7, v7
    v_exp_f32 v8, v8
    v_exp_f32 v9, v9
    v_exp_f32 v10, v10
    v_exp_f32 v11, v11
    v_exp_f32 v12, v12
    v_exp_f32 v13, v13
    v_exp_f32 v14, v14
    v_exp_f32 v15, v15
    s_nop 0
    v_cvt_pk_bf16_f32 v32, v0, v1
    v_cvt_pk_bf16_f32 v33, v2, v3
    v_cvt_pk_bf16_f32 v34, v4, v5
    v_cvt_pk_bf16_f32 v35, v6, v7
    v_cvt_pk_bf16_f32 v36, v8, v9
    v_cvt_pk_bf16_f32 v37, v10, v11
    v_cvt_pk_bf16_f32 v38, v12, v13
    v_cvt_pk_bf16_f32 v39, v14, v15
    s_nop 1
    v_mfma_f32_32x32x16_bf16 v[160:175], a[8:11], v[32:35], v[160:175]
    v_mfma_f32_32x32x16_bf16 v[160:175], a[12:15], v[36:39], v[160:175]
    v_mfma_f32_16x16x32_bf16 a[108:111], a[112:115], v[32:35], a[108:111]
    v_mfma_f32_16x16x32_bf16 a[108:111], a[112:115], v[36:39], a[108:111]
    s_nop 15
    s_add_u32 s4, s4, 1
    s_cmp_lt_u32 s4, 32
    s_cbranch_scc1 attn_slow_acc
    v_accvgpr_read_b32 v180, a96
    v_accvgpr_read_b32 v181, a100
    v_accvgpr_read_b32 v182, a104
    v_accvgpr_read_b32 v183, a108
    s_branch attn_merge
.section .rodata,"a"
.p2align 6
.amdhsa_kernel sequential_preLN__softmax_full_mha__glu_gated_bilinear__prompt_kernel
  .amdhsa_next_free_vgpr 480
  .amdhsa_next_free_sgpr 102
  .amdhsa_accum_offset 256
  .amdhsa_group_segment_fixed_size 0
  .amdhsa_kernarg_size 80
  .amdhsa_user_sgpr_count 2
  .amdhsa_user_sgpr_kernarg_segment_ptr 1
  .amdhsa_system_sgpr_workgroup_id_x 1
  .amdhsa_float_denorm_mode_32 3
  .amdhsa_ieee_mode 0
.end_amdhsa_kernel
```
